```python
import torch

def _softmax(x, axis=-1):
    return torch.softmax(x, dim=axis)
def _gelu(x):
    return torch.nn.functional.gelu(x, approximate="tanh")
def _silu(x):
    return torch.nn.functional.silu(x)
def _sigmoid(x):
    return torch.sigmoid(x)
def _layernorm(x, axis=-1, eps=1e-5):
    m = x.mean(dim=axis, keepdim=True)
    v = x.var(dim=axis, keepdim=True, unbiased=False)
    return (x - m) / torch.sqrt(v + eps)
def _scatter_add(tgt, idx, src, axis=0):
    return tgt.clone().index_add_(axis, idx, src)
def _segment_sum(src, seg, n):
    out = torch.zeros((n,) + src.shape[1:], dtype=src.dtype)
    return out.index_add_(0, seg, src)
def _pad(x, pw):
    flat = tuple(v for pair in reversed(pw) for v in pair)
    return torch.nn.functional.pad(x, flat)

kernel_name = 'gated_mix__sliding_block__dense_activation_silu__prompt'

def setup_inputs():

    _w = (lambda a: (lambda t: t.to(torch.bfloat16) if t.is_floating_point() else t)(torch.as_tensor(a)))
    def _A_setup():
        B, S, D = 1, 2048, 640
        return {
            "x": _w((lambda *s: torch.randn(*s, dtype=torch.bfloat16) * 0.2)(B, S, D)),
            "wqkv": _w((lambda *s: torch.randn(*s, dtype=torch.bfloat16) * 0.2)(D, 3 * D)),
            "wo": _w((lambda *s: torch.randn(*s, dtype=torch.bfloat16) * 0.2)(D, D)),
        }
    _A_in = _A_setup()

    def _B_setup():
        B, S, D, F = 1, 2048, 640, 1536
        return {
            "x": _w((lambda *s: torch.randn(*s, dtype=torch.bfloat16) * 0.2)(B, S, D)),
            "w1": _w((lambda *s: torch.randn(*s, dtype=torch.bfloat16) * 3.2)(D, F) * (D ** -0.5)),
            "w2": _w((lambda *s: torch.randn(*s, dtype=torch.bfloat16) * 3.2)(F, D) * (F ** -0.5)),
        }
    _B_in = _B_setup()

    return {
        "A_x": _A_in["x"],
        "A_wqkv": _A_in["wqkv"],
        "A_wo": _A_in["wo"],
        "B_x": _B_in["x"],
        "B_w1": _B_in["w1"],
        "B_w2": _B_in["w2"],
        "gate_w": _w((lambda *s: torch.randn(*s, dtype=torch.bfloat16) * 0.2)(640) * 16.0),
    }

def reference(A_x, A_wqkv, A_wo, B_x, B_w1, B_w2, gate_w):
    def _A_ref(x, wqkv, wo):
        B, S, D = x.shape
        H = 32; Dh = D // H; W = 256
        qkv = (lambda x, *d: x.permute(*d))((x @ wqkv).reshape(B, S, 3, H, Dh), 2, 0, 3, 1, 4)
        q, k, v = qkv[0], qkv[1], qkv[2]
        scores = torch.einsum("bhqd,bhkd->bhqk", q, k) * (Dh ** -0.5)
        idx = torch.arange(S)
        mask = (idx[:, None] - idx[None, :] >= 0) & (idx[:, None] - idx[None, :] < W)
        scores = torch.where(mask[None, None], scores, -1e9)
        p = _softmax(scores, axis=-1)
        o = torch.einsum("bhqk,bhkd->bhqd", p, v)
        return (lambda x, *d: x.permute(*d))(o, 0, 2, 1, 3).reshape(B, S, D) @ wo

    def _B_ref(x, w1, w2):
        h = torch.einsum("bsd,df->bsf", x, w1)
        h = _silu(h)
        out = torch.einsum("bsf,fd->bsd", h, w2)
        return out

    x = A_x
    g = _sigmoid((x * gate_w).sum(-1, keepdims=True))
    a = _A_ref(x, A_wqkv, A_wo)
    b = _B_ref(x, B_w1, B_w2)
    return g * a + (1 - g) * b
```

```asm
; @launch grid=(256,1,1) block=(512,1,1) lds=163840
.amdgcn_target "amdgcn-amd-amdhsa--gfx950"
.text
.globl gated_mix__sliding_block__dense_activation_silu__prompt_kernel
.p2align 8
.type gated_mix__sliding_block__dense_activation_silu__prompt_kernel,@function
gated_mix__sliding_block__dense_activation_silu__prompt_kernel:
    s_cmpk_ge_u32 s2, 0x100
    s_cbranch_scc1 L_end
    s_load_dwordx16 s[32:47], s[0:1], 0
    s_load_dwordx4 s[48:51], s[0:1], 64
    v_lshrrev_b32 v1, 6, v0
    v_and_b32 v0, 63, v0
    v_readfirstlane_b32 s52, v1
    s_lshr_b32 s66, s2, 3
    s_and_b32 s55, s66, 7
    s_lshr_b32 s68, s2, 6
    s_and_b32 s69, s2, 4
    s_lshl1_add_u32 s53, s69, s55
    s_and_b32 s69, s2, 3
    s_lshl2_add_u32 s54, s69, s68
    s_and_b32 s59, s52, 3
    s_cmp_lt_u32 s52, 4
    s_cbranch_scc1 L_qwave
    s_setprio 3
    v_lshlrev_b32 v24, 7, v0
    s_getpc_b64 s[20:21]
    s_lshl2_add_u32 s66, s66, s59
    s_mulk_i32 s66, 384
    s_mov_b32 s22, L_codeend-gated_mix__sliding_block__dense_activation_silu__prompt_kernel-128
    s_mov_b32 s23, 0x20000
    s_mov_b64 exec, 7
    buffer_load_dword v27, v24, s[20:23], s66 offen
    s_mov_b64 exec, -1
    v_lshrrev_b32 v88, 3, v0
    v_mul_u32_u24 v88, 1280, v88
    v_lshrrev_b32 v89, 4, v0
    v_and_b32 v90, 7, v0
    v_xor_b32 v90, v89, v90
    v_lshl_add_u32 v8, v90, 4, v88
    v_xor_b32 v90, 4, v90
    v_lshl_add_u32 v9, v90, 4, v88
    v_add_u32 v9, 9216, v9
    v_add_u32 v10, 18432, v8
    v_add_u32 v11, 18432, v9
    s_cmp_eq_u32 s54, 15
    s_cselect_b32 s66, 0, 3840
    s_cselect_b32 s67, 0, 14336
    s_cselect_b32 s68, 0, -1
    s_mov_b32 s62, 245760
    s_cselect_b32 s62, 128, s62
    v_lshlrev_b32 v90, 2, v89
    v_and_b32 v90, s68, v90
    v_and_b32 v91, 15, v0
    v_xor_b32 v90, v90, v91
    v_lshlrev_b32 v90, 4, v90
    v_mad_u32_u24 v12, v89, s66, v90
    v_add_u32 v13, s67, v12
    v_xor_b32 v14, 32, v13
    v_add_u32 v14, s67, v14
    v_add_u32 v15, s67, v14
    s_lshl2_add_u32 s60, s53, s59
    s_mul_i32 s60, s60, 40960
    s_mul_i32 s61, s59, 61440
    s_lshl_b32 s69, s54, 8
    s_add_u32 s61, s61, s69
    s_and_b32 s61, s61, s68
    s_lshl_b32 s63, s59, 12
    s_add_u32 s78, s53, s54
    s_and_b32 s78, s78, 1
    s_mul_i32 s78, s78, 5
    s_lshr_b32 s66, s2, 2
    s_xor_b32 s66, s66, s2
    s_bitcmp1_b32 s66, 0
    s_cselect_b32 s66, 3, 0
    s_add_u32 s78, s78, s66
    s_lshl_b32 s66, s78, 7
    s_add_u32 s60, s60, s66
    s_mul_i32 s66, s78, s62
    s_add_u32 s61, s61, s66
    s_mov_b32 s6, 2621440
    s_mov_b32 s7, 0x20000
    s_mov_b32 s11, s7
    s_mov_b32 s10, 2457600
    s_cmp_eq_u32 s54, 15
    s_cselect_b32 s10, 1280, s10
    s_waitcnt lgkmcnt(0)
    s_mov_b64 s[4:5], s[32:33]
    s_cselect_b64 s[8:9], s[44:45], s[34:35]
    s_add_u32 m0, s63, 0
    s_nop 0
    buffer_load_dwordx4 v8, s[4:7], s60 offen offset:0  lds
    buffer_load_dwordx4 v9, s[4:7], s60 offen offset:1024  lds
    buffer_load_dwordx4 v10, s[4:7], s60 offen offset:2048  lds
    buffer_load_dwordx4 v11, s[4:7], s60 offen offset:3072  lds
    s_add_u32 m0, s63, 16384
    s_add_u32 s60, s60, 128
    buffer_load_dwordx4 v12, s[8:11], s61 offen offset:0  lds
    buffer_load_dwordx4 v13, s[8:11], s61 offen offset:1024  lds
    buffer_load_dwordx4 v14, s[8:11], s61 offen offset:2048  lds
    buffer_load_dwordx4 v15, s[8:11], s61 offen offset:3072  lds
    s_add_u32 s61, s61, s62
    s_lshr_b32 s74, s2, 3
    s_and_b32 s75, s74, 1
    s_cselect_b64 s[72:73], s[34:35], s[36:37]
    s_cselect_b64 s[70:71], s[40:41], s[42:43]
    s_mul_i32 s74, s74, 5
    s_lshr_b32 s74, s74, 4
    s_cmp_eq_u32 s52, 7
    s_cselect_b64 s[72:73], s[46:47], s[72:73]
    s_cmp_eq_u32 s52, 5
    s_cselect_b64 s[72:73], s[70:71], s[72:73]
    s_cselect_b32 s75, 0, s75
    s_cmp_eq_u32 s52, 4
    s_cselect_b64 s[72:73], s[50:51], s[72:73]
    s_cselect_b32 s74, s74, s75
    s_lshl_b32 s74, s74, 21
    s_load_dword s79, s[72:73], s74
    s_load_dword s79, s[48:49], 128
    s_mov_b32 s75, 20971392
    s_load_dword s79, s[50:51], s75
    v_and_b32 v88, 15, v0
    v_lshrrev_b32 v89, 1, v88
    v_lshrrev_b32 v90, 4, v0
    v_xor_b32 v89, v89, v90
    v_lshl_add_u32 v88, v88, 7, s63
    v_lshl_add_u32 v16, v89, 4, v88
    v_xor_b32 v17, 64, v16
    v_add_u32 v18, 0x10000, v16
    v_add_u32 v19, 0x10000, v17
    s_and_b32 s66, s2, 7
    s_lshr_b32 s68, s2, 6
    s_lshl2_add_u32 s56, s66, s68
    s_lshr_b32 s69, s66, 1
    s_lshl3_add_u32 s57, s69, s55
    s_and_b32 s69, s66, 1
    s_lshl2_add_u32 s58, s69, s68
    s_mov_b32 s14, 1966080
    s_mov_b32 s18, 20971520
    s_mov_b32 s26, 2621440
    s_mov_b32 s30, 256
    s_mov_b32 s15, 0x20000
    s_mov_b32 s19, 0x20000
    s_mov_b32 s23, 0x20000
    s_mov_b32 s27, 0x20000
    s_mov_b32 s31, 0x20000
    s_mov_b64 s[12:13], s[40:41]
    s_mov_b64 s[16:17], s[50:51]
    s_mov_b64 s[24:25], s[46:47]
    s_mov_b64 s[28:29], s[48:49]
    s_mov_b32 s3, 1
    s_mov_b32 s70, 0x76543210
    s_mov_b32 s71, 0xfedcba98
    s_lshl_b32 s69, s54, 2
    s_lshr_b64 s[70:71], s[70:71], s69
    s_and_b32 s35, s70, 15
    v_min_u32 v7, 1, v0
    v_lshlrev_b32 v7, 18, v7
    v_add_u32 v7, 163712, v7
    v_mov_b32 v1, 1
    v_lshlrev_b32 v2, 4, v0
    v_mov_b32 v3, 0
    v_add_u32 v88, 0, v0
    v_mul_u32_u24 v89, 0xaaab, v88
    v_lshrrev_b32 v89, 19, v89
    v_mul_u32_u24 v90, 2880, v89
    v_lshrrev_b32 v88, 3, v89
    v_lshlrev_b32 v88, 1, v88
    v_xor_b32 v88, v0, v88
    v_lshl_add_u32 v80, v88, 4, v90
    v_add_u32 v88, 64, v0
    v_mul_u32_u24 v89, 0xaaab, v88
    v_lshrrev_b32 v89, 19, v89
    v_mul_u32_u24 v90, 2880, v89
    v_lshrrev_b32 v88, 3, v89
    v_lshlrev_b32 v88, 1, v88
    v_xor_b32 v88, v0, v88
    v_lshl_add_u32 v81, v88, 4, v90
    v_add_u32 v88, 128, v0
    v_mul_u32_u24 v89, 0xaaab, v88
    v_lshrrev_b32 v89, 19, v89
    v_mul_u32_u24 v90, 2880, v89
    v_lshrrev_b32 v88, 3, v89
    v_lshlrev_b32 v88, 1, v88
    v_xor_b32 v88, v0, v88
    v_lshl_add_u32 v82, v88, 4, v90
    s_mul_i32 s96, s59, 98304
    s_mul_i32 s66, s35, 192
    s_add_u32 s96, s96, s66
    s_mul_i32 s97, s59, 6144
    s_add_u32 s66, s53, s54
    s_and_b32 s66, s66, 1
    s_mul_i32 s66, s66, 5
    s_lshr_b32 s67, s2, 2
    s_xor_b32 s67, s67, s2
    s_bitcmp1_b32 s67, 0
    s_cselect_b32 s67, 3, 0
    s_add_u32 s66, s66, s67
    s_mul_i32 s66, s66, 196608
    s_add_u32 s96, s96, s66
    v_lshrrev_b32 v90, 4, v0
    v_bfe_u32 v88, v0, 2, 2
    v_lshl_add_u32 v88, v90, 3, v88
    v_mul_u32_u24 v88, 192, v88
    v_and_b32 v90, 1, v90
    v_lshl_add_u32 v88, v90, 5, v88
    v_and_b32 v89, 3, v0
    v_lshl_add_u32 v83, v89, 3, v88
    v_add_u32 v84, 0x10000, v83
    v_add_u32 v85, 0x20000, v83
    s_lshl2_add_u32 s64, s53, s59
    s_mul_i32 s64, s64, 98304
    s_mul_i32 s67, s35, 3072
    s_add_u32 s64, s64, s67
    s_add_u32 s64, s64, 7864320
    s_mov_b32 s65, 0xbfb8aa3b
    s_lshl_b32 s45, s59, 10
    s_mul_i32 s44, s58, 348160
    s_add_u32 s44, s44, s45
    s_lshl3_add_u32 s66, s57, s58
    s_lshl2_add_u32 s66, s66, s59
    s_lshl_b32 s66, s66, 8
    s_add_u32 s32, s66, 19636224
    s_add_u32 s32, s50, s32
    s_addc_u32 s33, s51, 0
    s_lshr_b32 s66, s59, 1
    s_lshl1_add_u32 s66, s53, s66
    s_lshl_b32 s66, s66, 5
    s_lshr_b32 s67, s35, 2
    s_add_u32 s66, s66, s67
    s_lshl_b32 s66, s66, 8
    s_add_u32 s46, s66, 19636224
    s_add_u32 s46, s50, s46
    s_addc_u32 s47, s51, 0
    s_mov_b32 s70, 0
    s_mul_i32 s66, s57, 196608
    s_add_u32 s66, s66, 7864320
    s_mul_i32 s67, s58, 348160
    s_add_u32 s67, s67, 16777216
    s_mul_i32 s69, s59, 3
    s_add_u32 s68, s69, s70
    s_lshl_b32 s36, s68, 12
    s_add_u32 s36, s36, s66
    s_mul_i32 s38, s68, 20480
    s_add_u32 s38, s38, s67
    s_add_u32 s70, s70, 1
    s_cmp_eq_u32 s70, 3
    s_cselect_b32 s70, 0, s70
    s_add_u32 s68, s69, s70
    s_lshl_b32 s37, s68, 12
    s_add_u32 s37, s37, s66
    s_mul_i32 s39, s68, 20480
    s_add_u32 s39, s39, s67
    s_add_u32 s70, s70, 1
    s_cmp_eq_u32 s70, 3
    s_cselect_b32 s70, 0, s70
    s_add_u32 s68, s69, s70
    s_lshl_b32 s43, s68, 12
    s_add_u32 s43, s43, s66
    s_mul_i32 s76, s68, 20480
    s_add_u32 s76, s76, s67
    s_mul_i32 s66, s57, 81920
    s_add_u32 s66, s66, 14155776
    s_lshl_b32 s40, s59, 12
    s_add_u32 s40, s40, s66
    s_lshl_b32 s41, s59, 10
    s_add_u32 s41, s41, s66
    s_add_u32 s41, s41, 16384
    s_lshl2_add_u32 s42, s53, s59
    s_lshl_b32 s42, s42, 7
    s_add_u32 s42, s42, 19562496
    s_mul_i32 s66, s59, 25600
    s_add_u32 s66, s66, 16256
    v_and_b32 v88, 15, v0
    v_mul_u32_u24 v88, 160, v88
    v_lshrrev_b32 v89, 5, v0
    v_lshl_add_u32 v88, v89, 4, v88
    v_lshrrev_b32 v89, 2, v0
    v_xor_b32 v89, v89, v0
    v_bfe_u32 v89, v89, 2, 1
    v_mul_u32_u24 v89, 10256, v89
    v_add3_u32 v95, v88, v89, s66
    v_add_u32 v5, s66, v2
    v_and_b32 v88, 15, v0
    v_lshrrev_b32 v89, 4, v0
    v_lshlrev_b32 v89, 8, v89
    v_lshl_add_u32 v4, v88, 3, v89
    v_lshlrev_b32 v6, 2, v88
    v_lshl_add_u32 v3, s59, 2, v7
    v_add_u32 v94, 4096, v2
    v_add_u32 v88, 0, v2
    v_add_u32 v89, 49152, v2
    v_add_u32 v90, 98304, v2
    v_add_u32 v91, 147456, v2
    s_add_u32 m0, s63, 32768
    s_nop 0
    buffer_load_dwordx4 v8, s[4:7], s60 offen offset:0  lds
    buffer_load_dwordx4 v9, s[4:7], s60 offen offset:1024  lds
    buffer_load_dwordx4 v10, s[4:7], s60 offen offset:2048  lds
    buffer_load_dwordx4 v11, s[4:7], s60 offen offset:3072  lds
    s_add_u32 m0, s63, 49152
    s_add_u32 s60, s60, 128
    buffer_load_dwordx4 v12, s[8:11], s61 offen offset:0  lds
    buffer_load_dwordx4 v13, s[8:11], s61 offen offset:1024  lds
    buffer_load_dwordx4 v14, s[8:11], s61 offen offset:2048  lds
    buffer_load_dwordx4 v15, s[8:11], s61 offen offset:3072  lds
    s_add_u32 s61, s61, s62
    s_setprio 0
    s_waitcnt vmcnt(8)
    s_barrier
    s_cmp_eq_u32 s78, 8
    s_cselect_b32 s66, 10, 0
    s_mul_i32 s67, s66, s62
    s_lshl_b32 s66, s66, 7
    s_sub_u32 s60, s60, s66
    s_sub_u32 s61, s61, s67
    s_add_u32 m0, s63, 65536
    s_nop 0
    buffer_load_dwordx4 v8, s[4:7], s60 offen offset:0  lds
    buffer_load_dwordx4 v9, s[4:7], s60 offen offset:1024  lds
    buffer_load_dwordx4 v10, s[4:7], s60 offen offset:2048  lds
    buffer_load_dwordx4 v11, s[4:7], s60 offen offset:3072  lds
    ds_read_b128 v[96:99], v16 offset:0
    ds_read_b128 v[100:103], v16 offset:2048
    ds_read_b128 v[104:107], v17 offset:0
    ds_read_b128 v[108:111], v17 offset:2048
    s_add_u32 m0, s63, 81920
    s_add_u32 s60, s60, 128
    buffer_load_dwordx4 v12, s[8:11], s61 offen offset:0  lds
    buffer_load_dwordx4 v13, s[8:11], s61 offen offset:1024  lds
    buffer_load_dwordx4 v14, s[8:11], s61 offen offset:2048  lds
    buffer_load_dwordx4 v15, s[8:11], s61 offen offset:3072  lds
    s_add_u32 s61, s61, s62
    s_waitcnt vmcnt(8) lgkmcnt(0)
    s_barrier
    s_add_u32 m0, s63, 0
    s_nop 0
    buffer_load_dwordx4 v8, s[4:7], s60 offen offset:0  lds
    buffer_load_dwordx4 v9, s[4:7], s60 offen offset:1024  lds
    buffer_load_dwordx4 v10, s[4:7], s60 offen offset:2048  lds
    buffer_load_dwordx4 v11, s[4:7], s60 offen offset:3072  lds
    ds_read_b128 v[112:115], v16 offset:32768
    ds_read_b128 v[116:119], v16 offset:34816
    ds_read_b128 v[120:123], v17 offset:32768
    ds_read_b128 v[124:127], v17 offset:34816
    s_add_u32 m0, s63, 16384
    s_add_u32 s60, s60, 128
    buffer_load_dwordx4 v12, s[8:11], s61 offen offset:0  lds
    buffer_load_dwordx4 v13, s[8:11], s61 offen offset:1024  lds
    buffer_load_dwordx4 v14, s[8:11], s61 offen offset:2048  lds
    buffer_load_dwordx4 v15, s[8:11], s61 offen offset:3072  lds
    s_add_u32 s61, s61, s62
    s_waitcnt vmcnt(8) lgkmcnt(0)
    s_barrier
    s_add_u32 m0, s63, 32768
    s_nop 0
    buffer_load_dwordx4 v8, s[4:7], s60 offen offset:0  lds
    buffer_load_dwordx4 v9, s[4:7], s60 offen offset:1024  lds
    buffer_load_dwordx4 v10, s[4:7], s60 offen offset:2048  lds
    buffer_load_dwordx4 v11, s[4:7], s60 offen offset:3072  lds
    ds_read_b128 v[128:131], v18 offset:0
    ds_read_b128 v[132:135], v18 offset:2048
    ds_read_b128 v[136:139], v19 offset:0
    ds_read_b128 v[140:143], v19 offset:2048
    s_add_u32 m0, s63, 49152
    s_add_u32 s60, s60, 128
    buffer_load_dwordx4 v12, s[8:11], s61 offen offset:0  lds
    buffer_load_dwordx4 v13, s[8:11], s61 offen offset:1024  lds
    buffer_load_dwordx4 v14, s[8:11], s61 offen offset:2048  lds
    buffer_load_dwordx4 v15, s[8:11], s61 offen offset:3072  lds
    s_add_u32 s61, s61, s62
    s_waitcnt vmcnt(8) lgkmcnt(0)
    s_barrier
    s_cmp_eq_u32 s78, 5
    s_cselect_b32 s66, 10, 0
    s_mul_i32 s67, s66, s62
    s_lshl_b32 s66, s66, 7
    s_sub_u32 s60, s60, s66
    s_sub_u32 s61, s61, s67
    s_add_u32 m0, s63, 65536
    s_nop 0
    buffer_load_dwordx4 v8, s[4:7], s60 offen offset:0  lds
    buffer_load_dwordx4 v9, s[4:7], s60 offen offset:1024  lds
    buffer_load_dwordx4 v10, s[4:7], s60 offen offset:2048  lds
    buffer_load_dwordx4 v11, s[4:7], s60 offen offset:3072  lds
    ds_read_b128 v[144:147], v16 offset:0
    ds_read_b128 v[148:151], v16 offset:2048
    ds_read_b128 v[152:155], v17 offset:0
    ds_read_b128 v[156:159], v17 offset:2048
    s_add_u32 m0, s63, 81920
    s_add_u32 s60, s60, 128
    buffer_load_dwordx4 v12, s[8:11], s61 offen offset:0  lds
    buffer_load_dwordx4 v13, s[8:11], s61 offen offset:1024  lds
    buffer_load_dwordx4 v14, s[8:11], s61 offen offset:2048  lds
    buffer_load_dwordx4 v15, s[8:11], s61 offen offset:3072  lds
    s_add_u32 s61, s61, s62
    s_waitcnt vmcnt(8) lgkmcnt(0)
    s_barrier
    s_add_u32 m0, s63, 0
    s_nop 0
    buffer_load_dwordx4 v8, s[4:7], s60 offen offset:0  lds
    buffer_load_dwordx4 v9, s[4:7], s60 offen offset:1024  lds
    buffer_load_dwordx4 v10, s[4:7], s60 offen offset:2048  lds
    buffer_load_dwordx4 v11, s[4:7], s60 offen offset:3072  lds
    ds_read_b128 v[160:163], v16 offset:32768
    ds_read_b128 v[164:167], v16 offset:34816
    ds_read_b128 v[168:171], v17 offset:32768
    ds_read_b128 v[172:175], v17 offset:34816
    s_add_u32 m0, s63, 16384
    s_add_u32 s60, s60, 128
    buffer_load_dwordx4 v12, s[8:11], s61 offen offset:0  lds
    buffer_load_dwordx4 v13, s[8:11], s61 offen offset:1024  lds
    buffer_load_dwordx4 v14, s[8:11], s61 offen offset:2048  lds
    buffer_load_dwordx4 v15, s[8:11], s61 offen offset:3072  lds
    s_add_u32 s61, s61, s62
    s_waitcnt vmcnt(8) lgkmcnt(0)
    s_barrier
    s_cmp_eq_u32 s78, 3
    s_cselect_b32 s66, 10, 0
    s_mul_i32 s67, s66, s62
    s_lshl_b32 s66, s66, 7
    s_sub_u32 s60, s60, s66
    s_sub_u32 s61, s61, s67
    s_add_u32 m0, s63, 32768
    s_nop 0
    buffer_load_dwordx4 v8, s[4:7], s60 offen offset:0  lds
    buffer_load_dwordx4 v9, s[4:7], s60 offen offset:1024  lds
    buffer_load_dwordx4 v10, s[4:7], s60 offen offset:2048  lds
    buffer_load_dwordx4 v11, s[4:7], s60 offen offset:3072  lds
    ds_read_b128 v[176:179], v18 offset:0
    ds_read_b128 v[180:183], v18 offset:2048
    ds_read_b128 v[184:187], v19 offset:0
    ds_read_b128 v[188:191], v19 offset:2048
    s_add_u32 m0, s63, 49152
    s_add_u32 s60, s60, 128
    buffer_load_dwordx4 v12, s[8:11], s61 offen offset:0  lds
    buffer_load_dwordx4 v13, s[8:11], s61 offen offset:1024  lds
    buffer_load_dwordx4 v14, s[8:11], s61 offen offset:2048  lds
    buffer_load_dwordx4 v15, s[8:11], s61 offen offset:3072  lds
    s_add_u32 s61, s61, s62
    s_waitcnt vmcnt(8) lgkmcnt(0)
    s_barrier
    s_mov_b32 s34, 16
    s_cmp_lg_u32 s52, 4
    s_cbranch_scc1 L_rdyq_1
    s_load_dword s34, s[48:49], 0
L_rdyq_1:
    s_add_u32 m0, s63, 65536
    s_nop 0
    buffer_load_dwordx4 v8, s[4:7], s60 offen offset:0  lds
    buffer_load_dwordx4 v9, s[4:7], s60 offen offset:1024  lds
    buffer_load_dwordx4 v10, s[4:7], s60 offen offset:2048  lds
    buffer_load_dwordx4 v11, s[4:7], s60 offen offset:3072  lds
    ds_read_b128 v[192:195], v16 offset:0
    ds_read_b128 v[196:199], v16 offset:2048
    ds_read_b128 v[200:203], v17 offset:0
    ds_read_b128 v[204:207], v17 offset:2048
    s_add_u32 m0, s63, 81920
    s_add_u32 s60, s60, 128
    buffer_load_dwordx4 v12, s[8:11], s61 offen offset:0  lds
    buffer_load_dwordx4 v13, s[8:11], s61 offen offset:1024  lds
    buffer_load_dwordx4 v14, s[8:11], s61 offen offset:2048  lds
    buffer_load_dwordx4 v15, s[8:11], s61 offen offset:3072  lds
    s_add_u32 s61, s61, s62
    s_waitcnt vmcnt(8) lgkmcnt(0)
    s_cmp_lt_u32 s34, 16
    s_cbranch_scc1 L_rdys_2
L_rdy_3:
    s_barrier
    s_add_u32 m0, s63, 0
    s_nop 0
    buffer_load_dwordx4 v8, s[4:7], s60 offen offset:0  lds
    buffer_load_dwordx4 v9, s[4:7], s60 offen offset:1024  lds
    buffer_load_dwordx4 v10, s[4:7], s60 offen offset:2048  lds
    buffer_load_dwordx4 v11, s[4:7], s60 offen offset:3072  lds
    ds_read_b128 v[208:211], v16 offset:32768
    ds_read_b128 v[212:215], v16 offset:34816
    ds_read_b128 v[216:219], v17 offset:32768
    ds_read_b128 v[220:223], v17 offset:34816
    s_add_u32 m0, s63, 16384
    s_add_u32 s60, s60, 128
    buffer_load_dwordx4 v12, s[8:11], s61 offen offset:0  lds
    buffer_load_dwordx4 v13, s[8:11], s61 offen offset:1024  lds
    buffer_load_dwordx4 v14, s[8:11], s61 offen offset:2048  lds
    buffer_load_dwordx4 v15, s[8:11], s61 offen offset:3072  lds
    s_add_u32 s61, s61, s62
    s_waitcnt vmcnt(8) lgkmcnt(0)
    s_barrier
    s_add_u32 m0, s97, 98304
    s_add_u32 s71, s96, 0
    buffer_load_dwordx4 v80, s[12:15], s71 offen offset:0  lds
    buffer_load_dwordx4 v81, s[12:15], s71 offen offset:1024  lds
    buffer_load_dwordx4 v82, s[12:15], s71 offen offset:2048  lds
    ds_read_b128 v[224:227], v18 offset:0
    ds_read_b128 v[228:231], v18 offset:2048
    ds_read_b128 v[232:235], v19 offset:0
    ds_read_b128 v[236:239], v19 offset:2048
    s_add_u32 m0, s97, 101376
    s_add_u32 s71, s96, 49152
    buffer_load_dwordx4 v80, s[12:15], s71 offen offset:0  lds
    buffer_load_dwordx4 v81, s[12:15], s71 offen offset:1024  lds
    buffer_load_dwordx4 v82, s[12:15], s71 offen offset:2048  lds
    s_waitcnt vmcnt(6) lgkmcnt(0)
    s_barrier
    s_add_u32 m0, s97, 122880
    s_add_u32 s71, s96, 393216
    s_sub_u32 s70, s71, 1966080
    s_cselect_b32 s71, s71, s70
    buffer_load_dwordx4 v80, s[12:15], s71 offen offset:0  lds
    buffer_load_dwordx4 v81, s[12:15], s71 offen offset:1024  lds
    buffer_load_dwordx4 v82, s[12:15], s71 offen offset:2048  lds
    ds_read_b128 v[240:243], v16 offset:0
    ds_read_b128 v[244:247], v16 offset:2048
    ds_read_b128 v[248:251], v17 offset:0
    ds_read_b128 v[252:255], v17 offset:2048
    s_add_u32 m0, s97, 125952
    s_add_u32 s71, s96, 442368
    s_sub_u32 s70, s71, 1966080
    s_cselect_b32 s71, s71, s70
    buffer_load_dwordx4 v80, s[12:15], s71 offen offset:0  lds
    buffer_load_dwordx4 v81, s[12:15], s71 offen offset:1024  lds
    buffer_load_dwordx4 v82, s[12:15], s71 offen offset:2048  lds
    v_xor_b32 v80, 32, v83
    v_xor_b32 v81, 32, v84
    v_xor_b32 v82, 32, v85
    s_waitcnt vmcnt(6) lgkmcnt(0)
    s_barrier
    s_setprio 2
    ds_read_b64_tr_b16 v[56:57], v84 offset:32768
    ds_read_b64_tr_b16 v[58:59], v84 offset:33536
    ds_read_b64_tr_b16 v[60:61], v84 offset:32832
    ds_read_b64_tr_b16 v[62:63], v84 offset:33600
    ds_read_b64_tr_b16 v[64:65], v84 offset:32896
    ds_read_b64_tr_b16 v[66:67], v84 offset:33664
    ds_read_b64_tr_b16 v[68:69], v81 offset:32768
    ds_read_b64_tr_b16 v[70:71], v81 offset:33536
    s_waitcnt lgkmcnt(6)
    v_mfma_f32_16x16x32_bf16 v[8:11], v[56:59], v[96:99], 0
    s_waitcnt lgkmcnt(4)
    ds_read_b64_tr_b16 v[72:73], v81 offset:32832
    ds_read_b64_tr_b16 v[74:75], v81 offset:33600
    v_mfma_f32_16x16x32_bf16 v[16:19], v[56:59], v[100:103], 0
    v_mfma_f32_16x16x32_bf16 v[32:35], v[60:63], v[100:103], 0
    s_waitcnt lgkmcnt(4)
    ds_read_b64_tr_b16 v[56:57], v81 offset:32896
    ds_read_b64_tr_b16 v[58:59], v81 offset:33664
    v_mfma_f32_16x16x32_bf16 v[24:27], v[60:63], v[96:99], 0
    v_mfma_f32_16x16x32_bf16 v[40:43], v[64:67], v[96:99], 0
    s_waitcnt lgkmcnt(4)
    ds_read_b64_tr_b16 v[60:61], v84 offset:38912
    ds_read_b64_tr_b16 v[62:63], v84 offset:39680
    v_mfma_f32_16x16x32_bf16 v[48:51], v[64:67], v[100:103], 0
    v_mfma_f32_16x16x32_bf16 v[20:23], v[68:71], v[100:103], 0
    s_waitcnt lgkmcnt(4)
    ds_read_b64_tr_b16 v[64:65], v84 offset:38976
    ds_read_b64_tr_b16 v[66:67], v84 offset:39744
    v_mfma_f32_16x16x32_bf16 v[12:15], v[68:71], v[96:99], 0
    v_mfma_f32_16x16x32_bf16 v[28:31], v[72:75], v[96:99], 0
    s_waitcnt lgkmcnt(4)
    ds_read_b64_tr_b16 v[68:69], v84 offset:39040
    ds_read_b64_tr_b16 v[70:71], v84 offset:39808
    v_mfma_f32_16x16x32_bf16 v[36:39], v[72:75], v[100:103], 0
    v_mfma_f32_16x16x32_bf16 v[52:55], v[56:59], v[100:103], 0
    s_waitcnt lgkmcnt(4)
    ds_read_b64_tr_b16 v[72:73], v81 offset:38912
    ds_read_b64_tr_b16 v[74:75], v81 offset:39680
    v_mfma_f32_16x16x32_bf16 v[44:47], v[56:59], v[96:99], 0
    v_mfma_f32_16x16x32_bf16 v[8:11], v[60:63], v[104:107], v[8:11]
    s_waitcnt lgkmcnt(4)
    ds_read_b64_tr_b16 v[56:57], v81 offset:38976
    ds_read_b64_tr_b16 v[58:59], v81 offset:39744
    v_mfma_f32_16x16x32_bf16 v[16:19], v[60:63], v[108:111], v[16:19]
    v_mfma_f32_16x16x32_bf16 v[32:35], v[64:67], v[108:111], v[32:35]
    s_waitcnt lgkmcnt(4)
    ds_read_b64_tr_b16 v[60:61], v81 offset:39040
    ds_read_b64_tr_b16 v[62:63], v81 offset:39808
    v_mfma_f32_16x16x32_bf16 v[24:27], v[64:67], v[104:107], v[24:27]
    v_mfma_f32_16x16x32_bf16 v[40:43], v[68:71], v[104:107], v[40:43]
    s_waitcnt lgkmcnt(4)
    ds_read_b64_tr_b16 v[64:65], v84 offset:45056
    ds_read_b64_tr_b16 v[66:67], v84 offset:45824
    v_mfma_f32_16x16x32_bf16 v[48:51], v[68:71], v[108:111], v[48:51]
    v_mfma_f32_16x16x32_bf16 v[20:23], v[72:75], v[108:111], v[20:23]
    s_waitcnt lgkmcnt(4)
    ds_read_b64_tr_b16 v[68:69], v84 offset:45120
    ds_read_b64_tr_b16 v[70:71], v84 offset:45888
    v_mfma_f32_16x16x32_bf16 v[12:15], v[72:75], v[104:107], v[12:15]
    v_mfma_f32_16x16x32_bf16 v[28:31], v[56:59], v[104:107], v[28:31]
    s_waitcnt lgkmcnt(4)
    ds_read_b64_tr_b16 v[72:73], v84 offset:45184
    ds_read_b64_tr_b16 v[74:75], v84 offset:45952
    v_mfma_f32_16x16x32_bf16 v[36:39], v[56:59], v[108:111], v[36:39]
    v_mfma_f32_16x16x32_bf16 v[52:55], v[60:63], v[108:111], v[52:55]
    s_waitcnt lgkmcnt(4)
    ds_read_b64_tr_b16 v[56:57], v81 offset:45056
    ds_read_b64_tr_b16 v[58:59], v81 offset:45824
    v_mfma_f32_16x16x32_bf16 v[44:47], v[60:63], v[104:107], v[44:47]
    v_mfma_f32_16x16x32_bf16 v[8:11], v[64:67], v[112:115], v[8:11]
    s_waitcnt lgkmcnt(4)
    ds_read_b64_tr_b16 v[60:61], v81 offset:45120
    ds_read_b64_tr_b16 v[62:63], v81 offset:45888
    v_mfma_f32_16x16x32_bf16 v[16:19], v[64:67], v[116:119], v[16:19]
    v_mfma_f32_16x16x32_bf16 v[32:35], v[68:71], v[116:119], v[32:35]
    s_waitcnt lgkmcnt(4)
    ds_read_b64_tr_b16 v[64:65], v81 offset:45184
    ds_read_b64_tr_b16 v[66:67], v81 offset:45952
    v_mfma_f32_16x16x32_bf16 v[24:27], v[68:71], v[112:115], v[24:27]
    s_waitcnt vmcnt(0)
    ds_add_u32 v7, v1 offset:12
    v_mfma_f32_16x16x32_bf16 v[40:43], v[72:75], v[112:115], v[40:43]
    s_waitcnt lgkmcnt(5)
    ds_read_b64_tr_b16 v[68:69], v84 offset:51200
    ds_read_b64_tr_b16 v[70:71], v84 offset:51968
    v_mfma_f32_16x16x32_bf16 v[48:51], v[72:75], v[116:119], v[48:51]
    v_mfma_f32_16x16x32_bf16 v[20:23], v[56:59], v[116:119], v[20:23]
    s_waitcnt lgkmcnt(5)
    ds_read_b64_tr_b16 v[72:73], v84 offset:51264
    ds_read_b64_tr_b16 v[74:75], v84 offset:52032
    v_mfma_f32_16x16x32_bf16 v[12:15], v[56:59], v[112:115], v[12:15]
    v_mfma_f32_16x16x32_bf16 v[28:31], v[60:63], v[112:115], v[28:31]
    s_waitcnt lgkmcnt(5)
    ds_read_b64_tr_b16 v[56:57], v84 offset:51328
    ds_read_b64_tr_b16 v[58:59], v84 offset:52096
    v_mfma_f32_16x16x32_bf16 v[36:39], v[60:63], v[116:119], v[36:39]
    ds_read_b32 v86, v7 offset:12
    v_mfma_f32_16x16x32_bf16 v[52:55], v[64:67], v[116:119], v[52:55]
    s_waitcnt lgkmcnt(5)
    ds_read_b64_tr_b16 v[60:61], v81 offset:51200
    ds_read_b64_tr_b16 v[62:63], v81 offset:51968
    v_mfma_f32_16x16x32_bf16 v[44:47], v[64:67], v[112:115], v[44:47]
    v_mfma_f32_16x16x32_bf16 v[8:11], v[68:71], v[120:123], v[8:11]
    s_waitcnt lgkmcnt(5)
    ds_read_b64_tr_b16 v[64:65], v81 offset:51264
    ds_read_b64_tr_b16 v[66:67], v81 offset:52032
    v_mfma_f32_16x16x32_bf16 v[16:19], v[68:71], v[124:127], v[16:19]
    v_mfma_f32_16x16x32_bf16 v[32:35], v[72:75], v[124:127], v[32:35]
    s_waitcnt lgkmcnt(5)
    ds_read_b64_tr_b16 v[68:69], v81 offset:51328
    ds_read_b64_tr_b16 v[70:71], v81 offset:52096
    v_mfma_f32_16x16x32_bf16 v[24:27], v[72:75], v[120:123], v[24:27]
    v_mfma_f32_16x16x32_bf16 v[40:43], v[56:59], v[120:123], v[40:43]
    s_waitcnt lgkmcnt(4)
    v_readfirstlane_b32 s74, v86
    s_cmp_lt_u32 s74, 4
    s_cbranch_scc1 L_aw_4_s
L_awd_5:
    ds_read_b64_tr_b16 v[72:73], v84 offset:57344
    ds_read_b64_tr_b16 v[74:75], v84 offset:58112
    v_mfma_f32_16x16x32_bf16 v[48:51], v[56:59], v[124:127], v[48:51]
    v_mfma_f32_16x16x32_bf16 v[20:23], v[60:63], v[124:127], v[20:23]
    s_waitcnt lgkmcnt(4)
    ds_read_b64_tr_b16 v[56:57], v84 offset:57408
    ds_read_b64_tr_b16 v[58:59], v84 offset:58176
    v_mfma_f32_16x16x32_bf16 v[12:15], v[60:63], v[120:123], v[12:15]
    v_mfma_f32_16x16x32_bf16 v[28:31], v[64:67], v[120:123], v[28:31]
    s_waitcnt lgkmcnt(4)
    ds_read_b64_tr_b16 v[60:61], v84 offset:57472
    ds_read_b64_tr_b16 v[62:63], v84 offset:58240
    v_mfma_f32_16x16x32_bf16 v[36:39], v[64:67], v[124:127], v[36:39]
    v_mfma_f32_16x16x32_bf16 v[52:55], v[68:71], v[124:127], v[52:55]
    s_waitcnt lgkmcnt(4)
    ds_read_b64_tr_b16 v[64:65], v81 offset:57344
    ds_read_b64_tr_b16 v[66:67], v81 offset:58112
    v_mfma_f32_16x16x32_bf16 v[44:47], v[68:71], v[120:123], v[44:47]
    ds_add_u32 v7, v1 offset:80
    v_mfma_f32_16x16x32_bf16 v[8:11], v[72:75], v[128:131], v[8:11]
    s_waitcnt lgkmcnt(5)
    ds_read_b64_tr_b16 v[68:69], v81 offset:57408
    ds_read_b64_tr_b16 v[70:71], v81 offset:58176
    v_mfma_f32_16x16x32_bf16 v[16:19], v[72:75], v[132:135], v[16:19]
    v_mfma_f32_16x16x32_bf16 v[32:35], v[56:59], v[132:135], v[32:35]
    s_waitcnt lgkmcnt(5)
    ds_read_b64_tr_b16 v[72:73], v81 offset:57472
    ds_read_b64_tr_b16 v[74:75], v81 offset:58240
    v_mfma_f32_16x16x32_bf16 v[24:27], v[56:59], v[128:131], v[24:27]
    v_mfma_f32_16x16x32_bf16 v[40:43], v[60:63], v[128:131], v[40:43]
    s_waitcnt lgkmcnt(5)
    ds_read_b64_tr_b16 v[56:57], v84 offset:63488
    ds_read_b64_tr_b16 v[58:59], v84 offset:64256
    v_mfma_f32_16x16x32_bf16 v[48:51], v[60:63], v[132:135], v[48:51]
    v_mfma_f32_16x16x32_bf16 v[20:23], v[64:67], v[132:135], v[20:23]
    s_waitcnt lgkmcnt(4)
    ds_read_b64_tr_b16 v[60:61], v84 offset:63552
    ds_read_b64_tr_b16 v[62:63], v84 offset:64320
    v_mfma_f32_16x16x32_bf16 v[12:15], v[64:67], v[128:131], v[12:15]
    v_mfma_f32_16x16x32_bf16 v[28:31], v[68:71], v[128:131], v[28:31]
    s_waitcnt lgkmcnt(4)
    ds_read_b64_tr_b16 v[64:65], v84 offset:63616
    ds_read_b64_tr_b16 v[66:67], v84 offset:64384
    v_mfma_f32_16x16x32_bf16 v[36:39], v[68:71], v[132:135], v[36:39]
    v_mfma_f32_16x16x32_bf16 v[52:55], v[72:75], v[132:135], v[52:55]
    s_waitcnt lgkmcnt(4)
    ds_read_b64_tr_b16 v[68:69], v81 offset:63488
    ds_read_b64_tr_b16 v[70:71], v81 offset:64256
    v_mfma_f32_16x16x32_bf16 v[44:47], v[72:75], v[128:131], v[44:47]
    v_mfma_f32_16x16x32_bf16 v[8:11], v[56:59], v[136:139], v[8:11]
    s_waitcnt lgkmcnt(4)
    ds_read_b64_tr_b16 v[72:73], v81 offset:63552
    ds_read_b64_tr_b16 v[74:75], v81 offset:64320
    v_mfma_f32_16x16x32_bf16 v[16:19], v[56:59], v[140:143], v[16:19]
    v_mfma_f32_16x16x32_bf16 v[32:35], v[60:63], v[140:143], v[32:35]
    s_waitcnt lgkmcnt(4)
    ds_read_b64_tr_b16 v[56:57], v81 offset:63616
    ds_read_b64_tr_b16 v[58:59], v81 offset:64384
    v_mfma_f32_16x16x32_bf16 v[24:27], v[60:63], v[136:139], v[24:27]
    v_mfma_f32_16x16x32_bf16 v[40:43], v[64:67], v[136:139], v[40:43]
    s_waitcnt lgkmcnt(4)
    ds_read_b64_tr_b16 v[60:61], v85 offset:4096
    ds_read_b64_tr_b16 v[62:63], v85 offset:4864
    v_mfma_f32_16x16x32_bf16 v[48:51], v[64:67], v[140:143], v[48:51]
    v_mfma_f32_16x16x32_bf16 v[20:23], v[68:71], v[140:143], v[20:23]
    s_waitcnt lgkmcnt(4)
    ds_read_b64_tr_b16 v[64:65], v85 offset:4160
    ds_read_b64_tr_b16 v[66:67], v85 offset:4928
    v_mfma_f32_16x16x32_bf16 v[12:15], v[68:71], v[136:139], v[12:15]
    v_mfma_f32_16x16x32_bf16 v[28:31], v[72:75], v[136:139], v[28:31]
    s_waitcnt lgkmcnt(4)
    ds_read_b64_tr_b16 v[68:69], v85 offset:4224
    ds_read_b64_tr_b16 v[70:71], v85 offset:4992
    v_mfma_f32_16x16x32_bf16 v[36:39], v[72:75], v[140:143], v[36:39]
    v_mfma_f32_16x16x32_bf16 v[52:55], v[56:59], v[140:143], v[52:55]
    s_waitcnt lgkmcnt(4)
    ds_read_b64_tr_b16 v[72:73], v82 offset:4096
    ds_read_b64_tr_b16 v[74:75], v82 offset:4864
    v_mfma_f32_16x16x32_bf16 v[44:47], v[56:59], v[136:139], v[44:47]
    v_mfma_f32_16x16x32_bf16 v[8:11], v[60:63], v[144:147], v[8:11]
    s_waitcnt lgkmcnt(4)
    ds_read_b64_tr_b16 v[56:57], v82 offset:4160
    ds_read_b64_tr_b16 v[58:59], v82 offset:4928
    v_mfma_f32_16x16x32_bf16 v[16:19], v[60:63], v[148:151], v[16:19]
    v_mfma_f32_16x16x32_bf16 v[32:35], v[64:67], v[148:151], v[32:35]
    s_waitcnt lgkmcnt(4)
    ds_read_b64_tr_b16 v[60:61], v82 offset:4224
    ds_read_b64_tr_b16 v[62:63], v82 offset:4992
    v_mfma_f32_16x16x32_bf16 v[24:27], v[64:67], v[144:147], v[24:27]
    v_mfma_f32_16x16x32_bf16 v[40:43], v[68:71], v[144:147], v[40:43]
    s_waitcnt lgkmcnt(4)
    ds_read_b64_tr_b16 v[64:65], v85 offset:10240
    ds_read_b64_tr_b16 v[66:67], v85 offset:11008
    v_mfma_f32_16x16x32_bf16 v[48:51], v[68:71], v[148:151], v[48:51]
    v_mfma_f32_16x16x32_bf16 v[20:23], v[72:75], v[148:151], v[20:23]
    s_waitcnt lgkmcnt(4)
    ds_read_b64_tr_b16 v[68:69], v85 offset:10304
    ds_read_b64_tr_b16 v[70:71], v85 offset:11072
    v_mfma_f32_16x16x32_bf16 v[12:15], v[72:75], v[144:147], v[12:15]
    v_mfma_f32_16x16x32_bf16 v[28:31], v[56:59], v[144:147], v[28:31]
    s_waitcnt lgkmcnt(4)
    ds_read_b64_tr_b16 v[72:73], v85 offset:10368
    ds_read_b64_tr_b16 v[74:75], v85 offset:11136
    v_mfma_f32_16x16x32_bf16 v[36:39], v[56:59], v[148:151], v[36:39]
    ds_read_b32 v86, v7 offset:16
    v_mfma_f32_16x16x32_bf16 v[52:55], v[60:63], v[148:151], v[52:55]
    s_waitcnt lgkmcnt(5)
    ds_read_b64_tr_b16 v[56:57], v82 offset:10240
    ds_read_b64_tr_b16 v[58:59], v82 offset:11008
    v_mfma_f32_16x16x32_bf16 v[44:47], v[60:63], v[144:147], v[44:47]
    v_mfma_f32_16x16x32_bf16 v[8:11], v[64:67], v[152:155], v[8:11]
    s_waitcnt lgkmcnt(5)
    ds_read_b64_tr_b16 v[60:61], v82 offset:10304
    ds_read_b64_tr_b16 v[62:63], v82 offset:11072
    v_mfma_f32_16x16x32_bf16 v[16:19], v[64:67], v[156:159], v[16:19]
    v_mfma_f32_16x16x32_bf16 v[32:35], v[68:71], v[156:159], v[32:35]
    s_waitcnt lgkmcnt(5)
    ds_read_b64_tr_b16 v[64:65], v82 offset:10368
    ds_read_b64_tr_b16 v[66:67], v82 offset:11136
    v_mfma_f32_16x16x32_bf16 v[24:27], v[68:71], v[152:155], v[24:27]
    v_mfma_f32_16x16x32_bf16 v[40:43], v[72:75], v[152:155], v[40:43]
    s_waitcnt lgkmcnt(4)
    v_readfirstlane_b32 s74, v86
    s_cmp_lt_u32 s74, 4
    s_cbranch_scc1 L_aw_6_s
L_awd_7:
    ds_read_b64_tr_b16 v[68:69], v83 offset:49152
    ds_read_b64_tr_b16 v[70:71], v83 offset:49920
    v_mfma_f32_16x16x32_bf16 v[48:51], v[72:75], v[156:159], v[48:51]
    v_mfma_f32_16x16x32_bf16 v[20:23], v[56:59], v[156:159], v[20:23]
    s_waitcnt lgkmcnt(4)
    ds_read_b64_tr_b16 v[72:73], v83 offset:49216
    ds_read_b64_tr_b16 v[74:75], v83 offset:49984
    v_mfma_f32_16x16x32_bf16 v[12:15], v[56:59], v[152:155], v[12:15]
    v_mfma_f32_16x16x32_bf16 v[28:31], v[60:63], v[152:155], v[28:31]
    s_waitcnt lgkmcnt(4)
    ds_read_b64_tr_b16 v[56:57], v83 offset:49280
    ds_read_b64_tr_b16 v[58:59], v83 offset:50048
    v_mfma_f32_16x16x32_bf16 v[36:39], v[60:63], v[156:159], v[36:39]
    v_mfma_f32_16x16x32_bf16 v[52:55], v[64:67], v[156:159], v[52:55]
    s_waitcnt lgkmcnt(4)
    ds_read_b64_tr_b16 v[60:61], v80 offset:49152
    ds_read_b64_tr_b16 v[62:63], v80 offset:49920
    v_mfma_f32_16x16x32_bf16 v[44:47], v[64:67], v[152:155], v[44:47]
    ds_add_u32 v7, v1 offset:84
    v_mfma_f32_16x16x32_bf16 v[8:11], v[68:71], v[160:163], v[8:11]
    s_waitcnt lgkmcnt(5)
    ds_read_b64_tr_b16 v[64:65], v80 offset:49216
    ds_read_b64_tr_b16 v[66:67], v80 offset:49984
    v_mfma_f32_16x16x32_bf16 v[16:19], v[68:71], v[164:167], v[16:19]
    v_mfma_f32_16x16x32_bf16 v[32:35], v[72:75], v[164:167], v[32:35]
    s_waitcnt lgkmcnt(5)
    ds_read_b64_tr_b16 v[68:69], v80 offset:49280
    ds_read_b64_tr_b16 v[70:71], v80 offset:50048
    v_mfma_f32_16x16x32_bf16 v[24:27], v[72:75], v[160:163], v[24:27]
    v_mfma_f32_16x16x32_bf16 v[40:43], v[56:59], v[160:163], v[40:43]
    s_waitcnt lgkmcnt(5)
    ds_read_b64_tr_b16 v[72:73], v83 offset:55296
    ds_read_b64_tr_b16 v[74:75], v83 offset:56064
    v_mfma_f32_16x16x32_bf16 v[48:51], v[56:59], v[164:167], v[48:51]
    v_mfma_f32_16x16x32_bf16 v[20:23], v[60:63], v[164:167], v[20:23]
    s_waitcnt lgkmcnt(4)
    ds_read_b64_tr_b16 v[56:57], v83 offset:55360
    ds_read_b64_tr_b16 v[58:59], v83 offset:56128
    v_mfma_f32_16x16x32_bf16 v[12:15], v[60:63], v[160:163], v[12:15]
    v_mfma_f32_16x16x32_bf16 v[28:31], v[64:67], v[160:163], v[28:31]
    s_waitcnt lgkmcnt(4)
    ds_read_b64_tr_b16 v[60:61], v83 offset:55424
    ds_read_b64_tr_b16 v[62:63], v83 offset:56192
    v_mfma_f32_16x16x32_bf16 v[36:39], v[64:67], v[164:167], v[36:39]
    v_mfma_f32_16x16x32_bf16 v[52:55], v[68:71], v[164:167], v[52:55]
    s_waitcnt lgkmcnt(4)
    ds_read_b64_tr_b16 v[64:65], v80 offset:55296
    ds_read_b64_tr_b16 v[66:67], v80 offset:56064
    v_mfma_f32_16x16x32_bf16 v[44:47], v[68:71], v[160:163], v[44:47]
    v_mfma_f32_16x16x32_bf16 v[8:11], v[72:75], v[168:171], v[8:11]
    s_waitcnt lgkmcnt(4)
    ds_read_b64_tr_b16 v[68:69], v80 offset:55360
    ds_read_b64_tr_b16 v[70:71], v80 offset:56128
    v_mfma_f32_16x16x32_bf16 v[16:19], v[72:75], v[172:175], v[16:19]
    v_mfma_f32_16x16x32_bf16 v[32:35], v[56:59], v[172:175], v[32:35]
    s_waitcnt lgkmcnt(4)
    ds_read_b64_tr_b16 v[72:73], v80 offset:55424
    ds_read_b64_tr_b16 v[74:75], v80 offset:56192
    v_mfma_f32_16x16x32_bf16 v[24:27], v[56:59], v[168:171], v[24:27]
    v_mfma_f32_16x16x32_bf16 v[40:43], v[60:63], v[168:171], v[40:43]
    s_waitcnt lgkmcnt(4)
    ds_read_b64_tr_b16 v[56:57], v83 offset:61440
    ds_read_b64_tr_b16 v[58:59], v83 offset:62208
    v_mfma_f32_16x16x32_bf16 v[48:51], v[60:63], v[172:175], v[48:51]
    v_mfma_f32_16x16x32_bf16 v[20:23], v[64:67], v[172:175], v[20:23]
    s_waitcnt lgkmcnt(4)
    ds_read_b64_tr_b16 v[60:61], v83 offset:61504
    ds_read_b64_tr_b16 v[62:63], v83 offset:62272
    v_mfma_f32_16x16x32_bf16 v[12:15], v[64:67], v[168:171], v[12:15]
    v_mfma_f32_16x16x32_bf16 v[28:31], v[68:71], v[168:171], v[28:31]
    s_waitcnt lgkmcnt(4)
    ds_read_b64_tr_b16 v[64:65], v83 offset:61568
    ds_read_b64_tr_b16 v[66:67], v83 offset:62336
    v_mfma_f32_16x16x32_bf16 v[36:39], v[68:71], v[172:175], v[36:39]
    buffer_load_dword v92, v6, s[16:19], s42 offen offset:0 sc1
    buffer_load_dword v93, v6, s[16:19], s42 offen offset:64 sc1
    v_mfma_f32_16x16x32_bf16 v[52:55], v[72:75], v[172:175], v[52:55]
    s_waitcnt lgkmcnt(4)
    ds_read_b64_tr_b16 v[68:69], v80 offset:61440
    ds_read_b64_tr_b16 v[70:71], v80 offset:62208
    v_mfma_f32_16x16x32_bf16 v[44:47], v[72:75], v[168:171], v[44:47]
    v_mfma_f32_16x16x32_bf16 v[8:11], v[56:59], v[176:179], v[8:11]
    s_waitcnt lgkmcnt(4)
    ds_read_b64_tr_b16 v[72:73], v80 offset:61504
    ds_read_b64_tr_b16 v[74:75], v80 offset:62272
    v_mfma_f32_16x16x32_bf16 v[16:19], v[56:59], v[180:183], v[16:19]
    v_mfma_f32_16x16x32_bf16 v[32:35], v[60:63], v[180:183], v[32:35]
    s_waitcnt lgkmcnt(4)
    ds_read_b64_tr_b16 v[56:57], v80 offset:61568
    ds_read_b64_tr_b16 v[58:59], v80 offset:62336
    v_mfma_f32_16x16x32_bf16 v[24:27], v[60:63], v[176:179], v[24:27]
    v_mfma_f32_16x16x32_bf16 v[40:43], v[64:67], v[176:179], v[40:43]
    s_waitcnt lgkmcnt(4)
    ds_read_b64_tr_b16 v[60:61], v84 offset:2048
    ds_read_b64_tr_b16 v[62:63], v84 offset:2816
    v_mfma_f32_16x16x32_bf16 v[48:51], v[64:67], v[180:183], v[48:51]
    v_mfma_f32_16x16x32_bf16 v[20:23], v[68:71], v[180:183], v[20:23]
    s_waitcnt lgkmcnt(4)
    ds_read_b64_tr_b16 v[64:65], v84 offset:2112
    ds_read_b64_tr_b16 v[66:67], v84 offset:2880
    v_mfma_f32_16x16x32_bf16 v[12:15], v[68:71], v[176:179], v[12:15]
    v_mfma_f32_16x16x32_bf16 v[28:31], v[72:75], v[176:179], v[28:31]
    s_waitcnt lgkmcnt(4)
    ds_read_b64_tr_b16 v[68:69], v84 offset:2176
    ds_read_b64_tr_b16 v[70:71], v84 offset:2944
    v_mfma_f32_16x16x32_bf16 v[36:39], v[72:75], v[180:183], v[36:39]
    ds_read_b32 v86, v7 offset:20
    v_mfma_f32_16x16x32_bf16 v[52:55], v[56:59], v[180:183], v[52:55]
    s_waitcnt lgkmcnt(5)
    ds_read_b64_tr_b16 v[72:73], v81 offset:2048
    ds_read_b64_tr_b16 v[74:75], v81 offset:2816
    v_mfma_f32_16x16x32_bf16 v[44:47], v[56:59], v[176:179], v[44:47]
    v_mfma_f32_16x16x32_bf16 v[8:11], v[60:63], v[184:187], v[8:11]
    s_waitcnt lgkmcnt(5)
    ds_read_b64_tr_b16 v[56:57], v81 offset:2112
    ds_read_b64_tr_b16 v[58:59], v81 offset:2880
    v_mfma_f32_16x16x32_bf16 v[16:19], v[60:63], v[188:191], v[16:19]
    v_mfma_f32_16x16x32_bf16 v[32:35], v[64:67], v[188:191], v[32:35]
    s_waitcnt lgkmcnt(5)
    ds_read_b64_tr_b16 v[60:61], v81 offset:2176
    ds_read_b64_tr_b16 v[62:63], v81 offset:2944
    v_mfma_f32_16x16x32_bf16 v[24:27], v[64:67], v[184:187], v[24:27]
    v_mfma_f32_16x16x32_bf16 v[40:43], v[68:71], v[184:187], v[40:43]
    s_waitcnt lgkmcnt(4)
    v_readfirstlane_b32 s74, v86
    s_cmp_lt_u32 s74, 4
    s_cbranch_scc1 L_aw_8_s
L_awd_9:
    ds_read_b64_tr_b16 v[64:65], v83 offset:24576
    ds_read_b64_tr_b16 v[66:67], v83 offset:25344
    v_mfma_f32_16x16x32_bf16 v[48:51], v[68:71], v[188:191], v[48:51]
    v_mfma_f32_16x16x32_bf16 v[20:23], v[72:75], v[188:191], v[20:23]
    s_waitcnt lgkmcnt(4)
    ds_read_b64_tr_b16 v[68:69], v80 offset:24576
    ds_read_b64_tr_b16 v[70:71], v80 offset:25344
    v_mfma_f32_16x16x32_bf16 v[12:15], v[72:75], v[184:187], v[12:15]
    v_mfma_f32_16x16x32_bf16 v[28:31], v[56:59], v[184:187], v[28:31]
    s_waitcnt lgkmcnt(4)
    ds_read_b64_tr_b16 v[72:73], v83 offset:30720
    ds_read_b64_tr_b16 v[74:75], v83 offset:31488
    v_mfma_f32_16x16x32_bf16 v[36:39], v[56:59], v[188:191], v[36:39]
    v_mfma_f32_16x16x32_bf16 v[52:55], v[60:63], v[188:191], v[52:55]
    s_waitcnt lgkmcnt(4)
    ds_read_b64_tr_b16 v[56:57], v80 offset:30720
    ds_read_b64_tr_b16 v[58:59], v80 offset:31488
    v_mfma_f32_16x16x32_bf16 v[44:47], v[60:63], v[184:187], v[44:47]
    ds_add_u32 v7, v1 offset:88
    v_mfma_f32_16x16x32_bf16 v[8:11], v[64:67], v[192:195], v[8:11]
    s_waitcnt lgkmcnt(5)
    ds_read_b64_tr_b16 v[60:61], v83 offset:36864
    ds_read_b64_tr_b16 v[62:63], v83 offset:37632
    v_mfma_f32_16x16x32_bf16 v[16:19], v[64:67], v[196:199], v[16:19]
    ds_read_b32 v86, v7 offset:24
    v_mfma_f32_16x16x32_bf16 v[20:23], v[68:71], v[196:199], v[20:23]
    s_waitcnt lgkmcnt(6)
    ds_read_b64_tr_b16 v[64:65], v80 offset:36864
    ds_read_b64_tr_b16 v[66:67], v80 offset:37632
    v_mfma_f32_16x16x32_bf16 v[12:15], v[68:71], v[192:195], v[12:15]
    v_mfma_f32_16x16x32_bf16 v[8:11], v[72:75], v[200:203], v[8:11]
    s_waitcnt lgkmcnt(6)
    ds_read_b64_tr_b16 v[68:69], v83 offset:43008
    ds_read_b64_tr_b16 v[70:71], v83 offset:43776
    v_mfma_f32_16x16x32_bf16 v[16:19], v[72:75], v[204:207], v[16:19]
    v_mfma_f32_16x16x32_bf16 v[20:23], v[56:59], v[204:207], v[20:23]
    s_waitcnt lgkmcnt(5)
    ds_read_b64_tr_b16 v[72:73], v80 offset:43008
    ds_read_b64_tr_b16 v[74:75], v80 offset:43776
    v_mfma_f32_16x16x32_bf16 v[12:15], v[56:59], v[200:203], v[12:15]
    v_mfma_f32_16x16x32_bf16 v[8:11], v[60:63], v[208:211], v[8:11]
    s_waitcnt lgkmcnt(4)
    v_readfirstlane_b32 s74, v86
    s_cmp_lt_u32 s74, 4
    s_cbranch_scc1 L_aw_10_s
L_awd_11:
    ds_read_b64_tr_b16 v[56:57], v83 offset:0
    ds_read_b64_tr_b16 v[58:59], v83 offset:768
    v_mfma_f32_16x16x32_bf16 v[16:19], v[60:63], v[212:215], v[16:19]
    v_mfma_f32_16x16x32_bf16 v[20:23], v[64:67], v[212:215], v[20:23]
    s_waitcnt lgkmcnt(4)
    ds_read_b64_tr_b16 v[60:61], v80 offset:0
    ds_read_b64_tr_b16 v[62:63], v80 offset:768
    v_mfma_f32_16x16x32_bf16 v[12:15], v[64:67], v[208:211], v[12:15]
    v_mfma_f32_16x16x32_bf16 v[8:11], v[68:71], v[216:219], v[8:11]
    s_waitcnt lgkmcnt(4)
    ds_read_b64_tr_b16 v[64:65], v83 offset:6144
    ds_read_b64_tr_b16 v[66:67], v83 offset:6912
    v_mfma_f32_16x16x32_bf16 v[16:19], v[68:71], v[220:223], v[16:19]
    v_mfma_f32_16x16x32_bf16 v[20:23], v[72:75], v[220:223], v[20:23]
    s_waitcnt lgkmcnt(4)
    ds_read_b64_tr_b16 v[68:69], v80 offset:6144
    ds_read_b64_tr_b16 v[70:71], v80 offset:6912
    v_mfma_f32_16x16x32_bf16 v[12:15], v[72:75], v[216:219], v[12:15]
    v_mfma_f32_16x16x32_bf16 v[8:11], v[56:59], v[224:227], v[8:11]
    s_waitcnt lgkmcnt(4)
    ds_read_b64_tr_b16 v[72:73], v83 offset:12288
    ds_read_b64_tr_b16 v[74:75], v83 offset:13056
    v_mfma_f32_16x16x32_bf16 v[16:19], v[56:59], v[228:231], v[16:19]
    v_mfma_f32_16x16x32_bf16 v[20:23], v[60:63], v[228:231], v[20:23]
    s_waitcnt lgkmcnt(4)
    ds_read_b64_tr_b16 v[56:57], v80 offset:12288
    ds_read_b64_tr_b16 v[58:59], v80 offset:13056
    v_mfma_f32_16x16x32_bf16 v[12:15], v[60:63], v[224:227], v[12:15]
    v_mfma_f32_16x16x32_bf16 v[8:11], v[64:67], v[232:235], v[8:11]
    s_waitcnt lgkmcnt(4)
    ds_read_b64_tr_b16 v[60:61], v83 offset:18432
    ds_read_b64_tr_b16 v[62:63], v83 offset:19200
    v_mfma_f32_16x16x32_bf16 v[16:19], v[64:67], v[236:239], v[16:19]
    v_mfma_f32_16x16x32_bf16 v[20:23], v[68:71], v[236:239], v[20:23]
    s_waitcnt lgkmcnt(4)
    ds_read_b64_tr_b16 v[64:65], v80 offset:18432
    ds_read_b64_tr_b16 v[66:67], v80 offset:19200
    v_mfma_f32_16x16x32_bf16 v[12:15], v[68:71], v[232:235], v[12:15]
    v_mfma_f32_16x16x32_bf16 v[8:11], v[72:75], v[240:243], v[8:11]
    s_waitcnt lgkmcnt(4)
    ds_read_b64_tr_b16 v[68:69], v83 offset:24640
    ds_read_b64_tr_b16 v[70:71], v83 offset:25408
    v_mfma_f32_16x16x32_bf16 v[16:19], v[72:75], v[244:247], v[16:19]
    s_waitcnt vmcnt(0)
    v_cmp_eq_u32 vcc, 0xbf800000, v92
    s_cbranch_vccnz L_gslow
    v_cmp_eq_u32 vcc, 0xbf800000, v93
    s_cbranch_vccnz L_gslow
L_gok:
    v_mfma_f32_16x16x32_bf16 v[20:23], v[56:59], v[244:247], v[20:23]
    s_waitcnt lgkmcnt(4)
    ds_read_b64_tr_b16 v[72:73], v80 offset:24640
    ds_read_b64_tr_b16 v[74:75], v80 offset:25408
    v_mfma_f32_16x16x32_bf16 v[12:15], v[56:59], v[240:243], v[12:15]
    v_sub_f32 v92, 1.0, v92
    v_sub_f32 v93, 1.0, v93
    v_mfma_f32_16x16x32_bf16 v[8:11], v[60:63], v[248:251], v[8:11]
    s_waitcnt lgkmcnt(4)
    ds_read_b64_tr_b16 v[56:57], v83 offset:30784
    ds_read_b64_tr_b16 v[58:59], v83 offset:31552
    v_mfma_f32_16x16x32_bf16 v[16:19], v[60:63], v[252:255], v[16:19]
    v_cvt_pk_bf16_f32 v92, v92, v92
    v_cvt_pk_bf16_f32 v93, v93, v93
    v_mfma_f32_16x16x32_bf16 v[20:23], v[64:67], v[252:255], v[20:23]
    s_waitcnt lgkmcnt(4)
    ds_read_b64_tr_b16 v[60:61], v80 offset:30784
    ds_read_b64_tr_b16 v[62:63], v80 offset:31552
    v_mfma_f32_16x16x32_bf16 v[12:15], v[64:67], v[248:251], v[12:15]
    v_and_b32 v92, 0xffff0000, v92
    v_and_b32 v93, 0xffff0000, v93
    v_mfma_f32_16x16x32_bf16 v[24:27], v[68:71], v[192:195], v[24:27]
    s_waitcnt lgkmcnt(4)
    ds_read_b64_tr_b16 v[64:65], v83 offset:36928
    ds_read_b64_tr_b16 v[66:67], v83 offset:37696
    v_mfma_f32_16x16x32_bf16 v[32:35], v[68:71], v[196:199], v[32:35]
    v_rcp_f32 v92, v92
    v_rcp_f32 v93, v93
    v_mfma_f32_16x16x32_bf16 v[36:39], v[72:75], v[196:199], v[36:39]
    s_waitcnt lgkmcnt(4)
    ds_read_b64_tr_b16 v[68:69], v80 offset:36928
    ds_read_b64_tr_b16 v[70:71], v80 offset:37696
    v_mfma_f32_16x16x32_bf16 v[28:31], v[72:75], v[192:195], v[28:31]
    s_mov_b32 s66, 0x7f000000
    v_minimum3_f32 v92, v92, s66, s66
    v_minimum3_f32 v93, v93, s66, s66
    v_mfma_f32_16x16x32_bf16 v[24:27], v[56:59], v[200:203], v[24:27]
    s_waitcnt lgkmcnt(4)
    ds_read_b64_tr_b16 v[72:73], v83 offset:43072
    ds_read_b64_tr_b16 v[74:75], v83 offset:43840
    v_mfma_f32_16x16x32_bf16 v[32:35], v[56:59], v[204:207], v[32:35]
    v_mul_f32 v76, s65, v8
    v_mul_f32 v77, s65, v9
    v_mul_f32 v78, s65, v10
    v_mul_f32 v79, s65, v11
    v_exp_f32 v76, v76
    v_exp_f32 v77, v77
    v_exp_f32 v78, v78
    v_mfma_f32_16x16x32_bf16 v[36:39], v[60:63], v[204:207], v[36:39]
    s_waitcnt lgkmcnt(4)
    ds_read_b64_tr_b16 v[56:57], v80 offset:43072
    ds_read_b64_tr_b16 v[58:59], v80 offset:43840
    v_mfma_f32_16x16x32_bf16 v[28:31], v[60:63], v[200:203], v[28:31]
    v_exp_f32 v79, v79
    v_fma_f32 v76, v76, v92, v92
    v_fma_f32 v77, v77, v92, v92
    v_fma_f32 v78, v78, v92, v92
    v_fma_f32 v79, v79, v92, v92
    v_rcp_f32 v76, v76
    v_mfma_f32_16x16x32_bf16 v[24:27], v[64:67], v[208:211], v[24:27]
    s_waitcnt lgkmcnt(4)
    ds_read_b64_tr_b16 v[60:61], v83 offset:64
    ds_read_b64_tr_b16 v[62:63], v83 offset:832
    v_mfma_f32_16x16x32_bf16 v[32:35], v[64:67], v[212:215], v[32:35]
    v_rcp_f32 v77, v77
    v_rcp_f32 v78, v78
    v_rcp_f32 v79, v79
    v_mul_f32 v8, v8, v76
    v_mul_f32 v9, v9, v77
    v_mfma_f32_16x16x32_bf16 v[36:39], v[68:71], v[212:215], v[36:39]
    s_waitcnt lgkmcnt(4)
    ds_read_b64_tr_b16 v[64:65], v80 offset:64
    ds_read_b64_tr_b16 v[66:67], v80 offset:832
    v_mfma_f32_16x16x32_bf16 v[28:31], v[68:71], v[208:211], v[28:31]
    v_mul_f32 v10, v10, v78
    v_mul_f32 v11, v11, v79
    v_mul_f32 v76, s65, v12
    v_mul_f32 v77, s65, v13
    v_mul_f32 v78, s65, v14
    v_mul_f32 v79, s65, v15
    v_exp_f32 v76, v76
    v_exp_f32 v77, v77
    v_mfma_f32_16x16x32_bf16 v[24:27], v[72:75], v[216:219], v[24:27]
    s_waitcnt lgkmcnt(4)
    ds_read_b64_tr_b16 v[68:69], v83 offset:6208
    ds_read_b64_tr_b16 v[70:71], v83 offset:6976
    v_mfma_f32_16x16x32_bf16 v[32:35], v[72:75], v[220:223], v[32:35]
    v_exp_f32 v78, v78
    v_exp_f32 v79, v79
    v_fma_f32 v76, v76, v92, v92
    v_fma_f32 v77, v77, v92, v92
    v_fma_f32 v78, v78, v92, v92
    v_mfma_f32_16x16x32_bf16 v[36:39], v[56:59], v[220:223], v[36:39]
    s_waitcnt lgkmcnt(4)
    ds_read_b64_tr_b16 v[72:73], v80 offset:6208
    ds_read_b64_tr_b16 v[74:75], v80 offset:6976
    v_mfma_f32_16x16x32_bf16 v[28:31], v[56:59], v[216:219], v[28:31]
    v_fma_f32 v79, v79, v92, v92
    v_rcp_f32 v76, v76
    v_rcp_f32 v77, v77
    v_rcp_f32 v78, v78
    v_rcp_f32 v79, v79
    v_mfma_f32_16x16x32_bf16 v[24:27], v[60:63], v[224:227], v[24:27]
    s_waitcnt lgkmcnt(4)
    ds_read_b64_tr_b16 v[56:57], v83 offset:12352
    ds_read_b64_tr_b16 v[58:59], v83 offset:13120
    v_mfma_f32_16x16x32_bf16 v[32:35], v[60:63], v[228:231], v[32:35]
    v_mul_f32 v12, v12, v76
    v_mul_f32 v13, v13, v77
    v_mul_f32 v14, v14, v78
    v_mul_f32 v15, v15, v79
    v_cvt_pk_bf16_f32 v8, v8, v9
    v_cvt_pk_bf16_f32 v9, v10, v11
    v_cvt_pk_bf16_f32 v10, v12, v13
    v_cvt_pk_bf16_f32 v11, v14, v15
    v_mfma_f32_16x16x32_bf16 v[36:39], v[64:67], v[228:231], v[36:39]
    s_waitcnt lgkmcnt(4)
    ds_read_b64_tr_b16 v[60:61], v80 offset:12352
    ds_read_b64_tr_b16 v[62:63], v80 offset:13120
    v_mfma_f32_16x16x32_bf16 v[28:31], v[64:67], v[224:227], v[28:31]
    buffer_store_dwordx4 v[8:11], v88, s[16:19], s64 offen offset:0 sc1
    v_mul_f32 v76, s65, v16
    v_mul_f32 v77, s65, v17
    v_mul_f32 v78, s65, v18
    v_mul_f32 v79, s65, v19
    v_exp_f32 v76, v76
    v_exp_f32 v77, v77
    v_exp_f32 v78, v78
    v_mfma_f32_16x16x32_bf16 v[24:27], v[68:71], v[232:235], v[24:27]
    s_waitcnt lgkmcnt(4)
    ds_read_b64_tr_b16 v[64:65], v83 offset:18496
    ds_read_b64_tr_b16 v[66:67], v83 offset:19264
    v_mfma_f32_16x16x32_bf16 v[32:35], v[68:71], v[236:239], v[32:35]
    v_exp_f32 v79, v79
    v_fma_f32 v76, v76, v93, v93
    v_fma_f32 v77, v77, v93, v93
    v_fma_f32 v78, v78, v93, v93
    v_fma_f32 v79, v79, v93, v93
    v_rcp_f32 v76, v76
    v_mfma_f32_16x16x32_bf16 v[36:39], v[72:75], v[236:239], v[36:39]
    s_waitcnt lgkmcnt(4)
    ds_read_b64_tr_b16 v[68:69], v80 offset:18496
    ds_read_b64_tr_b16 v[70:71], v80 offset:19264
    v_mfma_f32_16x16x32_bf16 v[28:31], v[72:75], v[232:235], v[28:31]
    v_rcp_f32 v77, v77
    v_rcp_f32 v78, v78
    v_rcp_f32 v79, v79
    v_mul_f32 v16, v16, v76
    v_mul_f32 v17, v17, v77
    v_mfma_f32_16x16x32_bf16 v[24:27], v[56:59], v[240:243], v[24:27]
    s_waitcnt lgkmcnt(4)
    ds_read_b64_tr_b16 v[72:73], v83 offset:24704
    ds_read_b64_tr_b16 v[74:75], v83 offset:25472
    v_mfma_f32_16x16x32_bf16 v[32:35], v[56:59], v[244:247], v[32:35]
    v_mul_f32 v18, v18, v78
    v_mul_f32 v19, v19, v79
    v_mul_f32 v76, s65, v20
    v_mul_f32 v77, s65, v21
    v_mul_f32 v78, s65, v22
    v_mul_f32 v79, s65, v23
    v_exp_f32 v76, v76
    v_exp_f32 v77, v77
    v_mfma_f32_16x16x32_bf16 v[36:39], v[60:63], v[244:247], v[36:39]
    s_waitcnt lgkmcnt(4)
    ds_read_b64_tr_b16 v[56:57], v80 offset:24704
    ds_read_b64_tr_b16 v[58:59], v80 offset:25472
    v_mfma_f32_16x16x32_bf16 v[28:31], v[60:63], v[240:243], v[28:31]
    v_exp_f32 v78, v78
    v_exp_f32 v79, v79
    v_fma_f32 v76, v76, v93, v93
    v_fma_f32 v77, v77, v93, v93
    v_fma_f32 v78, v78, v93, v93
    v_mfma_f32_16x16x32_bf16 v[24:27], v[64:67], v[248:251], v[24:27]
    s_waitcnt lgkmcnt(4)
    ds_read_b64_tr_b16 v[60:61], v83 offset:30848
    ds_read_b64_tr_b16 v[62:63], v83 offset:31616
    v_mfma_f32_16x16x32_bf16 v[32:35], v[64:67], v[252:255], v[32:35]
    v_fma_f32 v79, v79, v93, v93
    v_rcp_f32 v76, v76
    v_rcp_f32 v77, v77
    v_rcp_f32 v78, v78
    v_rcp_f32 v79, v79
    v_mfma_f32_16x16x32_bf16 v[36:39], v[68:71], v[252:255], v[36:39]
    s_waitcnt lgkmcnt(4)
    ds_read_b64_tr_b16 v[64:65], v80 offset:30848
    ds_read_b64_tr_b16 v[66:67], v80 offset:31616
    v_mfma_f32_16x16x32_bf16 v[28:31], v[68:71], v[248:251], v[28:31]
    v_mul_f32 v20, v20, v76
    v_mul_f32 v21, v21, v77
    v_mul_f32 v22, v22, v78
    v_mul_f32 v23, v23, v79
    v_cvt_pk_bf16_f32 v16, v16, v17
    v_cvt_pk_bf16_f32 v17, v18, v19
    v_cvt_pk_bf16_f32 v18, v20, v21
    v_cvt_pk_bf16_f32 v19, v22, v23
    buffer_store_dwordx4 v[16:19], v89, s[16:19], s64 offen offset:0 sc1
    v_mfma_f32_16x16x32_bf16 v[40:43], v[72:75], v[192:195], v[40:43]
    s_waitcnt lgkmcnt(4)
    ds_read_b64_tr_b16 v[68:69], v83 offset:36992
    ds_read_b64_tr_b16 v[70:71], v83 offset:37760
    v_mfma_f32_16x16x32_bf16 v[48:51], v[72:75], v[196:199], v[48:51]
    ds_read_b32 v87, v7 offset:4
    v_mfma_f32_16x16x32_bf16 v[52:55], v[56:59], v[196:199], v[52:55]
    s_waitcnt lgkmcnt(5)
    ds_read_b64_tr_b16 v[72:73], v80 offset:36992
    ds_read_b64_tr_b16 v[74:75], v80 offset:37760
    v_mfma_f32_16x16x32_bf16 v[44:47], v[56:59], v[192:195], v[44:47]
    v_mfma_f32_16x16x32_bf16 v[40:43], v[60:63], v[200:203], v[40:43]
    s_waitcnt lgkmcnt(5)
    ds_read_b64_tr_b16 v[56:57], v83 offset:43136
    ds_read_b64_tr_b16 v[58:59], v83 offset:43904
    v_mfma_f32_16x16x32_bf16 v[48:51], v[60:63], v[204:207], v[48:51]
    v_mul_f32 v76, s65, v24
    v_mul_f32 v77, s65, v25
    v_mul_f32 v78, s65, v26
    v_mul_f32 v79, s65, v27
    v_exp_f32 v76, v76
    v_exp_f32 v77, v77
    v_exp_f32 v78, v78
    v_mfma_f32_16x16x32_bf16 v[52:55], v[64:67], v[204:207], v[52:55]
    s_waitcnt lgkmcnt(5)
    ds_read_b64_tr_b16 v[60:61], v80 offset:43136
    ds_read_b64_tr_b16 v[62:63], v80 offset:43904
    v_mfma_f32_16x16x32_bf16 v[44:47], v[64:67], v[200:203], v[44:47]
    v_exp_f32 v79, v79
    v_fma_f32 v76, v76, v92, v92
    v_fma_f32 v77, v77, v92, v92
    v_fma_f32 v78, v78, v92, v92
    v_fma_f32 v79, v79, v92, v92
    v_rcp_f32 v76, v76
    v_mfma_f32_16x16x32_bf16 v[40:43], v[68:71], v[208:211], v[40:43]
    s_waitcnt lgkmcnt(4)
    ds_read_b64_tr_b16 v[64:65], v83 offset:128
    ds_read_b64_tr_b16 v[66:67], v83 offset:896
    v_mfma_f32_16x16x32_bf16 v[48:51], v[68:71], v[212:215], v[48:51]
    v_rcp_f32 v77, v77
    v_rcp_f32 v78, v78
    v_rcp_f32 v79, v79
    v_mul_f32 v24, v24, v76
    v_mul_f32 v25, v25, v77
    v_mfma_f32_16x16x32_bf16 v[52:55], v[72:75], v[212:215], v[52:55]
    s_waitcnt lgkmcnt(4)
    ds_read_b64_tr_b16 v[68:69], v80 offset:128
    ds_read_b64_tr_b16 v[70:71], v80 offset:896
    v_mfma_f32_16x16x32_bf16 v[44:47], v[72:75], v[208:211], v[44:47]
    v_readfirstlane_b32 s74, v87
    s_cmp_lt_u32 s74, 1
    s_cbranch_scc1 L_aw_12_s
L_awd_13:
    v_mul_f32 v26, v26, v78
    v_mul_f32 v27, v27, v79
    v_mul_f32 v76, s65, v28
    v_mul_f32 v77, s65, v29
    v_mul_f32 v78, s65, v30
    v_mul_f32 v79, s65, v31
    v_exp_f32 v76, v76
    v_exp_f32 v77, v77
    v_mfma_f32_16x16x32_bf16 v[40:43], v[56:59], v[216:219], v[40:43]
    s_waitcnt lgkmcnt(4)
    ds_read_b64_tr_b16 v[72:73], v83 offset:6272
    ds_read_b64_tr_b16 v[74:75], v83 offset:7040
    v_mfma_f32_16x16x32_bf16 v[48:51], v[56:59], v[220:223], v[48:51]
    buffer_load_dwordx4 v[112:115], v2, s[16:19], s38 offen offset:0 sc1
    v_exp_f32 v78, v78
    v_exp_f32 v79, v79
    v_fma_f32 v76, v76, v92, v92
    v_fma_f32 v77, v77, v92, v92
    v_fma_f32 v78, v78, v92, v92
    v_mfma_f32_16x16x32_bf16 v[52:55], v[60:63], v[220:223], v[52:55]
    s_waitcnt lgkmcnt(4)
    ds_read_b64_tr_b16 v[56:57], v80 offset:6272
    ds_read_b64_tr_b16 v[58:59], v80 offset:7040
    v_mfma_f32_16x16x32_bf16 v[44:47], v[60:63], v[216:219], v[44:47]
    v_fma_f32 v79, v79, v92, v92
    v_rcp_f32 v76, v76
    v_rcp_f32 v77, v77
    v_rcp_f32 v78, v78
    v_rcp_f32 v79, v79
    v_mfma_f32_16x16x32_bf16 v[40:43], v[64:67], v[224:227], v[40:43]
    s_waitcnt lgkmcnt(4)
    ds_read_b64_tr_b16 v[60:61], v83 offset:12416
    ds_read_b64_tr_b16 v[62:63], v83 offset:13184
    v_mfma_f32_16x16x32_bf16 v[48:51], v[64:67], v[228:231], v[48:51]
    buffer_load_dwordx4 v[116:119], v2, s[16:19], s38 offen offset:1024 sc1
    v_mul_f32 v28, v28, v76
    v_mul_f32 v29, v29, v77
    v_mul_f32 v30, v30, v78
    v_mul_f32 v31, v31, v79
    v_cvt_pk_bf16_f32 v24, v24, v25
    v_cvt_pk_bf16_f32 v25, v26, v27
    v_cvt_pk_bf16_f32 v26, v28, v29
    v_cvt_pk_bf16_f32 v27, v30, v31
    v_mfma_f32_16x16x32_bf16 v[52:55], v[68:71], v[228:231], v[52:55]
    s_waitcnt lgkmcnt(4)
    ds_read_b64_tr_b16 v[64:65], v80 offset:12416
    ds_read_b64_tr_b16 v[66:67], v80 offset:13184
    v_mfma_f32_16x16x32_bf16 v[44:47], v[68:71], v[224:227], v[44:47]
    buffer_store_dwordx4 v[24:27], v88, s[16:19], s64 offen offset:1024 sc1
    v_mul_f32 v76, s65, v32
    v_mul_f32 v77, s65, v33
    v_mul_f32 v78, s65, v34
    v_mul_f32 v79, s65, v35
    v_exp_f32 v76, v76
    v_exp_f32 v77, v77
    v_exp_f32 v78, v78
    v_mfma_f32_16x16x32_bf16 v[40:43], v[72:75], v[232:235], v[40:43]
    s_waitcnt lgkmcnt(4)
    ds_read_b64_tr_b16 v[68:69], v83 offset:18560
    ds_read_b64_tr_b16 v[70:71], v83 offset:19328
    v_mfma_f32_16x16x32_bf16 v[48:51], v[72:75], v[236:239], v[48:51]
    buffer_load_dwordx4 v[120:123], v2, s[16:19], s38 offen offset:2048 sc1
    v_exp_f32 v79, v79
    v_fma_f32 v76, v76, v93, v93
    v_fma_f32 v77, v77, v93, v93
    v_fma_f32 v78, v78, v93, v93
    v_fma_f32 v79, v79, v93, v93
    v_rcp_f32 v76, v76
    v_mfma_f32_16x16x32_bf16 v[52:55], v[56:59], v[236:239], v[52:55]
    s_waitcnt lgkmcnt(4)
    ds_read_b64_tr_b16 v[72:73], v80 offset:18560
    ds_read_b64_tr_b16 v[74:75], v80 offset:19328
    v_mfma_f32_16x16x32_bf16 v[44:47], v[56:59], v[232:235], v[44:47]
    v_rcp_f32 v77, v77
    v_rcp_f32 v78, v78
    v_rcp_f32 v79, v79
    v_mul_f32 v32, v32, v76
    v_mul_f32 v33, v33, v77
    v_mfma_f32_16x16x32_bf16 v[40:43], v[60:63], v[240:243], v[40:43]
    s_waitcnt lgkmcnt(4)
    v_mfma_f32_16x16x32_bf16 v[48:51], v[60:63], v[244:247], v[48:51]
    buffer_load_dwordx4 v[124:127], v2, s[16:19], s38 offen offset:3072 sc1
    v_mul_f32 v34, v34, v78
    v_mul_f32 v35, v35, v79
    v_mul_f32 v76, s65, v36
    v_mul_f32 v77, s65, v37
    v_mul_f32 v78, s65, v38
    v_mul_f32 v79, s65, v39
    v_exp_f32 v76, v76
    v_exp_f32 v77, v77
    v_mfma_f32_16x16x32_bf16 v[52:55], v[64:67], v[244:247], v[52:55]
    s_waitcnt lgkmcnt(2)
    v_mfma_f32_16x16x32_bf16 v[44:47], v[64:67], v[240:243], v[44:47]
    v_exp_f32 v78, v78
    v_exp_f32 v79, v79
    v_fma_f32 v76, v76, v93, v93
    v_fma_f32 v77, v77, v93, v93
    v_fma_f32 v78, v78, v93, v93
    v_mfma_f32_16x16x32_bf16 v[40:43], v[68:71], v[248:251], v[40:43]
    s_waitcnt lgkmcnt(0)
    v_mfma_f32_16x16x32_bf16 v[48:51], v[68:71], v[252:255], v[48:51]
    buffer_load_dwordx4 v[128:131], v94, s[16:19], s38 offen sc1
    s_add_u32 s38, s38, 5120
    v_fma_f32 v79, v79, v93, v93
    v_rcp_f32 v76, v76
    v_rcp_f32 v77, v77
    v_rcp_f32 v78, v78
    v_rcp_f32 v79, v79
    v_mfma_f32_16x16x32_bf16 v[52:55], v[72:75], v[252:255], v[52:55]
    v_mfma_f32_16x16x32_bf16 v[44:47], v[72:75], v[248:251], v[44:47]
    ds_add_u32 v7, v1 offset:32
    v_mul_f32 v36, v36, v76
    v_mul_f32 v37, v37, v77
    v_mul_f32 v38, v38, v78
    v_mul_f32 v39, v39, v79
    v_cvt_pk_bf16_f32 v32, v32, v33
    v_cvt_pk_bf16_f32 v33, v34, v35
    v_cvt_pk_bf16_f32 v34, v36, v37
    v_cvt_pk_bf16_f32 v35, v38, v39
    buffer_store_dwordx4 v[32:35], v89, s[16:19], s64 offen offset:1024 sc1
    s_nop 5
    v_mul_f32 v76, s65, v40
    v_mul_f32 v77, s65, v41
    v_mul_f32 v78, s65, v42
    v_mul_f32 v79, s65, v43
    v_exp_f32 v76, v76
    v_exp_f32 v77, v77
    v_exp_f32 v78, v78
    v_exp_f32 v79, v79
    v_fma_f32 v76, v76, v92, v92
    v_fma_f32 v77, v77, v92, v92
    v_fma_f32 v78, v78, v92, v92
    v_fma_f32 v79, v79, v92, v92
    v_rcp_f32 v76, v76
    v_rcp_f32 v77, v77
    v_rcp_f32 v78, v78
    v_rcp_f32 v79, v79
    v_mul_f32 v40, v40, v76
    v_mul_f32 v41, v41, v77
    v_mul_f32 v42, v42, v78
    v_mul_f32 v43, v43, v79
    v_mul_f32 v76, s65, v44
    v_mul_f32 v77, s65, v45
    v_mul_f32 v78, s65, v46
    v_mul_f32 v79, s65, v47
    v_exp_f32 v76, v76
    v_exp_f32 v77, v77
    v_exp_f32 v78, v78
    v_exp_f32 v79, v79
    v_fma_f32 v76, v76, v92, v92
    v_fma_f32 v77, v77, v92, v92
    v_fma_f32 v78, v78, v92, v92
    v_fma_f32 v79, v79, v92, v92
    v_rcp_f32 v76, v76
    v_rcp_f32 v77, v77
    v_rcp_f32 v78, v78
    v_rcp_f32 v79, v79
    v_mul_f32 v44, v44, v76
    v_mul_f32 v45, v45, v77
    v_mul_f32 v46, v46, v78
    v_mul_f32 v47, v47, v79
    v_cvt_pk_bf16_f32 v40, v40, v41
    v_cvt_pk_bf16_f32 v41, v42, v43
    v_cvt_pk_bf16_f32 v42, v44, v45
    v_cvt_pk_bf16_f32 v43, v46, v47
    buffer_store_dwordx4 v[40:43], v88, s[16:19], s64 offen offset:2048 sc1
    v_mul_f32 v76, s65, v48
    v_mul_f32 v77, s65, v49
    v_mul_f32 v78, s65, v50
    v_mul_f32 v79, s65, v51
    v_exp_f32 v76, v76
    v_exp_f32 v77, v77
    v_exp_f32 v78, v78
    v_exp_f32 v79, v79
    v_fma_f32 v76, v76, v93, v93
    v_fma_f32 v77, v77, v93, v93
    v_fma_f32 v78, v78, v93, v93
    v_fma_f32 v79, v79, v93, v93
    v_rcp_f32 v76, v76
    v_rcp_f32 v77, v77
    v_rcp_f32 v78, v78
    v_rcp_f32 v79, v79
    v_mul_f32 v48, v48, v76
    v_mul_f32 v49, v49, v77
    v_mul_f32 v50, v50, v78
    v_mul_f32 v51, v51, v79
    v_mul_f32 v76, s65, v52
    v_mul_f32 v77, s65, v53
    v_mul_f32 v78, s65, v54
    v_mul_f32 v79, s65, v55
    v_exp_f32 v76, v76
    v_exp_f32 v77, v77
    v_exp_f32 v78, v78
    v_exp_f32 v79, v79
    v_fma_f32 v76, v76, v93, v93
    v_fma_f32 v77, v77, v93, v93
    v_fma_f32 v78, v78, v93, v93
    v_fma_f32 v79, v79, v93, v93
    v_rcp_f32 v76, v76
    v_rcp_f32 v77, v77
    v_rcp_f32 v78, v78
    v_rcp_f32 v79, v79
    v_mul_f32 v52, v52, v76
    v_mul_f32 v53, v53, v77
    v_mul_f32 v54, v54, v78
    v_mul_f32 v55, v55, v79
    v_cvt_pk_bf16_f32 v48, v48, v49
    v_cvt_pk_bf16_f32 v49, v50, v51
    v_cvt_pk_bf16_f32 v50, v52, v53
    v_cvt_pk_bf16_f32 v51, v54, v55
    buffer_store_dwordx4 v[48:51], v89, s[16:19], s64 offen offset:2048 sc1
    buffer_load_dwordx4 v[148:151], v2, s[16:19], s38 offen offset:0 sc1
    buffer_load_dwordx4 v[152:155], v2, s[16:19], s38 offen offset:1024 sc1
    s_waitcnt vmcnt(2)
    s_atomic_add s3, s[46:47], 0
    s_atomic_add s3, s[46:47], 1024
    s_atomic_add s3, s[46:47], 2048
    s_atomic_add s3, s[46:47], 3072
    s_atomic_add s3, s[46:47], 4096
    s_atomic_add s3, s[46:47], 5120
    s_atomic_add s3, s[46:47], 6144
    s_atomic_add s3, s[46:47], 7168
    s_setprio 0
    buffer_load_dwordx4 v[156:159], v2, s[16:19], s38 offen offset:2048 sc1
    buffer_load_dwordx4 v[160:163], v2, s[16:19], s38 offen offset:3072 sc1
    buffer_load_dwordx4 v[164:167], v94, s[16:19], s38 offen sc1
    s_add_u32 s38, s38, 5120
    buffer_load_dwordx4 v[184:187], v2, s[16:19], s38 offen offset:0 sc1
    buffer_load_dwordx4 v[188:191], v2, s[16:19], s38 offen offset:1024 sc1
    buffer_load_dwordx4 v[192:195], v2, s[16:19], s38 offen offset:2048 sc1
    buffer_load_dwordx4 v[196:199], v2, s[16:19], s38 offen offset:3072 sc1
    buffer_load_dwordx4 v[200:203], v94, s[16:19], s38 offen sc1
    s_add_u32 s38, s38, 5120
    buffer_load_dwordx4 v[220:223], v2, s[16:19], s38 offen offset:0 sc1
    buffer_load_dwordx4 v[224:227], v2, s[16:19], s38 offen offset:1024 sc1
    buffer_load_dwordx4 v[228:231], v2, s[16:19], s38 offen offset:2048 sc1
    buffer_load_dwordx4 v[232:235], v2, s[16:19], s38 offen offset:3072 sc1
    buffer_load_dwordx4 v[236:239], v94, s[16:19], s38 offen sc1
    s_add_u32 s38, s38, 5120
    s_mov_b32 s75, 0
L_aw_14:
    ds_read_b32 v93, v7 offset:32
    s_add_u32 s75, s75, 1
    s_cmp_gt_u32 s75, 4000000
    s_waitcnt lgkmcnt(0)
    s_cbranch_scc1 L_awd_15
    v_readfirstlane_b32 s74, v93
    s_cmp_lt_u32 s74, 4
    s_cbranch_scc1 L_aw_14
L_awd_15:
    s_add_u32 m0, s45, 16256
    s_add_u32 s68, s44, 17022976
    buffer_load_dwordx4 v2, s[16:19], s68 offen sc1 lds
    s_load_dword s34, s[32:33], 0 glc
    s_add_u32 m0, s45, 20352
    s_add_u32 s68, s44, 17027072
    buffer_load_dwordx4 v2, s[16:19], s68 offen sc1 lds
    s_add_u32 m0, s45, 24448
    s_add_u32 s68, s44, 17031168
    buffer_load_dwordx4 v2, s[16:19], s68 offen sc1 lds
    s_add_u32 m0, s45, 28544
    s_add_u32 s68, s44, 17035264
    buffer_load_dwordx4 v2, s[16:19], s68 offen sc1 lds
    s_add_u32 m0, s45, 32640
    s_add_u32 s68, s44, 17039360
    buffer_load_dwordx4 v2, s[16:19], s68 offen sc1 lds
    s_add_u32 m0, s45, 36736
    s_add_u32 s68, s44, 17043456
    buffer_load_dwordx4 v2, s[16:19], s68 offen sc1 lds
    s_add_u32 m0, s45, 40832
    s_add_u32 s68, s44, 17047552
    buffer_load_dwordx4 v2, s[16:19], s68 offen sc1 lds
    s_add_u32 m0, s45, 44928
    s_add_u32 s68, s44, 17051648
    buffer_load_dwordx4 v2, s[16:19], s68 offen sc1 lds
    s_add_u32 m0, s45, 49024
    s_add_u32 s68, s44, 17055744
    buffer_load_dwordx4 v2, s[16:19], s68 offen sc1 lds
    s_setprio 0
    s_mov_b32 s75, 0
    s_branch L_spck_17
L_spin_16:
    s_load_dword s34, s[32:33], 0 glc
    s_add_u32 s75, s75, 1
    s_cmp_gt_u32 s75, 200000
    s_cbranch_scc1 L_spun_18
L_spck_17:
    s_waitcnt lgkmcnt(0)
    s_cmp_lt_u32 s34, 8
    s_cbranch_scc1 L_spin_16
L_spun_18:
    s_waitcnt lgkmcnt(0)
    s_setprio 2
    buffer_load_dwordx4 v[96:99], v88, s[16:19], s36 offen offset:0 sc1
    buffer_load_dwordx4 v[100:103], v89, s[16:19], s36 offen offset:0 sc1
    buffer_load_dwordx4 v[104:107], v90, s[16:19], s36 offen offset:0 sc1
    buffer_load_dwordx4 v[108:111], v91, s[16:19], s36 offen offset:0 sc1
    buffer_load_dwordx4 v[132:135], v88, s[16:19], s36 offen offset:1024 sc1
    buffer_load_dwordx4 v[136:139], v89, s[16:19], s36 offen offset:1024 sc1
    buffer_load_dwordx4 v[140:143], v90, s[16:19], s36 offen offset:1024 sc1
    buffer_load_dwordx4 v[144:147], v91, s[16:19], s36 offen offset:1024 sc1
    s_waitcnt vmcnt(7)
    v_mfma_f32_16x16x32_bf16 v[8:11], v[112:115], v[96:99], 0
    v_mfma_f32_16x16x32_bf16 v[12:15], v[116:119], v[96:99], 0
    buffer_load_dwordx4 v[168:171], v88, s[16:19], s36 offen offset:2048 sc1
    v_mfma_f32_16x16x32_bf16 v[16:19], v[120:123], v[96:99], 0
    v_mfma_f32_16x16x32_bf16 v[20:23], v[124:127], v[96:99], 0
    buffer_load_dwordx4 v[172:175], v89, s[16:19], s36 offen offset:2048 sc1
    v_mfma_f32_16x16x32_bf16 v[24:27], v[128:131], v[96:99], 0
    s_waitcnt vmcnt(8)
    v_mfma_f32_16x16x32_bf16 v[44:47], v[128:131], v[100:103], 0
    buffer_load_dwordx4 v[176:179], v90, s[16:19], s36 offen offset:2048 sc1
    v_mfma_f32_16x16x32_bf16 v[40:43], v[124:127], v[100:103], 0
    v_mfma_f32_16x16x32_bf16 v[36:39], v[120:123], v[100:103], 0
    buffer_load_dwordx4 v[180:183], v91, s[16:19], s36 offen offset:2048 sc1
    v_mfma_f32_16x16x32_bf16 v[32:35], v[116:119], v[100:103], 0
    v_mfma_f32_16x16x32_bf16 v[28:31], v[112:115], v[100:103], 0
    s_waitcnt vmcnt(9)
    v_mfma_f32_16x16x32_bf16 v[48:51], v[112:115], v[104:107], 0
    v_mfma_f32_16x16x32_bf16 v[52:55], v[116:119], v[104:107], 0
    v_mfma_f32_16x16x32_bf16 v[56:59], v[120:123], v[104:107], 0
    v_mfma_f32_16x16x32_bf16 v[60:63], v[124:127], v[104:107], 0
    v_mfma_f32_16x16x32_bf16 v[64:67], v[128:131], v[104:107], 0
    s_waitcnt vmcnt(8)
    v_mfma_f32_16x16x32_bf16 v[84:87], v[128:131], v[108:111], 0
    v_mfma_f32_16x16x32_bf16 v[80:83], v[124:127], v[108:111], 0
    v_mfma_f32_16x16x32_bf16 v[76:79], v[120:123], v[108:111], 0
    v_mfma_f32_16x16x32_bf16 v[72:75], v[116:119], v[108:111], 0
    v_mfma_f32_16x16x32_bf16 v[68:71], v[112:115], v[108:111], 0
    ds_add_u32 v7, v1 offset:40
    s_waitcnt vmcnt(7)
    v_mfma_f32_16x16x32_bf16 v[8:11], v[148:151], v[132:135], v[8:11]
    v_mfma_f32_16x16x32_bf16 v[12:15], v[152:155], v[132:135], v[12:15]
    buffer_load_dwordx4 v[204:207], v88, s[16:19], s36 offen offset:3072 sc1
    v_mfma_f32_16x16x32_bf16 v[16:19], v[156:159], v[132:135], v[16:19]
    v_mfma_f32_16x16x32_bf16 v[20:23], v[160:163], v[132:135], v[20:23]
    buffer_load_dwordx4 v[208:211], v89, s[16:19], s36 offen offset:3072 sc1
    v_mfma_f32_16x16x32_bf16 v[24:27], v[164:167], v[132:135], v[24:27]
    s_waitcnt vmcnt(8)
    v_mfma_f32_16x16x32_bf16 v[44:47], v[164:167], v[136:139], v[44:47]
    buffer_load_dwordx4 v[212:215], v90, s[16:19], s36 offen offset:3072 sc1
    v_mfma_f32_16x16x32_bf16 v[40:43], v[160:163], v[136:139], v[40:43]
    v_mfma_f32_16x16x32_bf16 v[36:39], v[156:159], v[136:139], v[36:39]
    buffer_load_dwordx4 v[216:219], v91, s[16:19], s36 offen offset:3072 sc1
    v_mfma_f32_16x16x32_bf16 v[32:35], v[152:155], v[136:139], v[32:35]
    v_mfma_f32_16x16x32_bf16 v[28:31], v[148:151], v[136:139], v[28:31]
    s_waitcnt vmcnt(9)
    v_mfma_f32_16x16x32_bf16 v[48:51], v[148:151], v[140:143], v[48:51]
    v_mfma_f32_16x16x32_bf16 v[52:55], v[152:155], v[140:143], v[52:55]
    v_mfma_f32_16x16x32_bf16 v[56:59], v[156:159], v[140:143], v[56:59]
    v_mfma_f32_16x16x32_bf16 v[60:63], v[160:163], v[140:143], v[60:63]
    v_mfma_f32_16x16x32_bf16 v[64:67], v[164:167], v[140:143], v[64:67]
    s_waitcnt vmcnt(8)
    v_mfma_f32_16x16x32_bf16 v[84:87], v[164:167], v[144:147], v[84:87]
    v_mfma_f32_16x16x32_bf16 v[80:83], v[160:163], v[144:147], v[80:83]
    v_mfma_f32_16x16x32_bf16 v[76:79], v[156:159], v[144:147], v[76:79]
    v_mfma_f32_16x16x32_bf16 v[72:75], v[152:155], v[144:147], v[72:75]
    v_mfma_f32_16x16x32_bf16 v[68:71], v[148:151], v[144:147], v[68:71]
    s_waitcnt vmcnt(7)
    v_mfma_f32_16x16x32_bf16 v[8:11], v[184:187], v[168:171], v[8:11]
    v_mfma_f32_16x16x32_bf16 v[12:15], v[188:191], v[168:171], v[12:15]
    buffer_load_dwordx4 v[112:115], v2, s[16:19], s39 offen offset:0 sc1
    v_mfma_f32_16x16x32_bf16 v[16:19], v[192:195], v[168:171], v[16:19]
    v_mfma_f32_16x16x32_bf16 v[20:23], v[196:199], v[168:171], v[20:23]
    buffer_load_dwordx4 v[116:119], v2, s[16:19], s39 offen offset:1024 sc1
    v_mfma_f32_16x16x32_bf16 v[24:27], v[200:203], v[168:171], v[24:27]
    s_waitcnt vmcnt(8)
    v_mfma_f32_16x16x32_bf16 v[44:47], v[200:203], v[172:175], v[44:47]
    buffer_load_dwordx4 v[120:123], v2, s[16:19], s39 offen offset:2048 sc1
    v_mfma_f32_16x16x32_bf16 v[40:43], v[196:199], v[172:175], v[40:43]
    v_mfma_f32_16x16x32_bf16 v[36:39], v[192:195], v[172:175], v[36:39]
    buffer_load_dwordx4 v[124:127], v2, s[16:19], s39 offen offset:3072 sc1
    v_mfma_f32_16x16x32_bf16 v[32:35], v[188:191], v[172:175], v[32:35]
    v_mfma_f32_16x16x32_bf16 v[28:31], v[184:187], v[172:175], v[28:31]
    buffer_load_dwordx4 v[128:131], v94, s[16:19], s39 offen sc1
    s_add_u32 s39, s39, 5120
    s_waitcnt vmcnt(10)
    v_mfma_f32_16x16x32_bf16 v[48:51], v[184:187], v[176:179], v[48:51]
    v_mfma_f32_16x16x32_bf16 v[52:55], v[188:191], v[176:179], v[52:55]
    buffer_load_dwordx4 v[96:99], v88, s[16:19], s37 offen offset:0 sc1
    v_mfma_f32_16x16x32_bf16 v[56:59], v[192:195], v[176:179], v[56:59]
    v_mfma_f32_16x16x32_bf16 v[60:63], v[196:199], v[176:179], v[60:63]
    buffer_load_dwordx4 v[100:103], v89, s[16:19], s37 offen offset:0 sc1
    v_mfma_f32_16x16x32_bf16 v[64:67], v[200:203], v[176:179], v[64:67]
    s_waitcnt vmcnt(11)
    v_mfma_f32_16x16x32_bf16 v[84:87], v[200:203], v[180:183], v[84:87]
    buffer_load_dwordx4 v[104:107], v90, s[16:19], s37 offen offset:0 sc1
    v_mfma_f32_16x16x32_bf16 v[80:83], v[196:199], v[180:183], v[80:83]
    v_mfma_f32_16x16x32_bf16 v[76:79], v[192:195], v[180:183], v[76:79]
    buffer_load_dwordx4 v[108:111], v91, s[16:19], s37 offen offset:0 sc1
    v_mfma_f32_16x16x32_bf16 v[72:75], v[188:191], v[180:183], v[72:75]
    v_mfma_f32_16x16x32_bf16 v[68:71], v[184:187], v[180:183], v[68:71]
    s_waitcnt vmcnt(12)
    v_mfma_f32_16x16x32_bf16 v[8:11], v[220:223], v[204:207], v[8:11]
    v_mfma_f32_16x16x32_bf16 v[12:15], v[224:227], v[204:207], v[12:15]
    buffer_load_dwordx4 v[148:151], v2, s[16:19], s39 offen offset:0 sc1
    v_mfma_f32_16x16x32_bf16 v[16:19], v[228:231], v[204:207], v[16:19]
    v_mfma_f32_16x16x32_bf16 v[20:23], v[232:235], v[204:207], v[20:23]
    buffer_load_dwordx4 v[152:155], v2, s[16:19], s39 offen offset:1024 sc1
    v_mfma_f32_16x16x32_bf16 v[24:27], v[236:239], v[204:207], v[24:27]
    s_waitcnt vmcnt(13)
    v_mfma_f32_16x16x32_bf16 v[44:47], v[236:239], v[208:211], v[44:47]
    buffer_load_dwordx4 v[156:159], v2, s[16:19], s39 offen offset:2048 sc1
    v_mfma_f32_16x16x32_bf16 v[40:43], v[232:235], v[208:211], v[40:43]
    v_mfma_f32_16x16x32_bf16 v[36:39], v[228:231], v[208:211], v[36:39]
    buffer_load_dwordx4 v[160:163], v2, s[16:19], s39 offen offset:3072 sc1
    v_mfma_f32_16x16x32_bf16 v[32:35], v[224:227], v[208:211], v[32:35]
    v_mfma_f32_16x16x32_bf16 v[28:31], v[220:223], v[208:211], v[28:31]
    buffer_load_dwordx4 v[164:167], v94, s[16:19], s39 offen sc1
    s_add_u32 s39, s39, 5120
    s_waitcnt vmcnt(15)
    v_mfma_f32_16x16x32_bf16 v[48:51], v[220:223], v[212:215], v[48:51]
    v_mfma_f32_16x16x32_bf16 v[52:55], v[224:227], v[212:215], v[52:55]
    buffer_load_dwordx4 v[132:135], v88, s[16:19], s37 offen offset:1024 sc1
    v_mfma_f32_16x16x32_bf16 v[56:59], v[228:231], v[212:215], v[56:59]
    v_mfma_f32_16x16x32_bf16 v[60:63], v[232:235], v[212:215], v[60:63]
    buffer_load_dwordx4 v[136:139], v89, s[16:19], s37 offen offset:1024 sc1
    v_mfma_f32_16x16x32_bf16 v[64:67], v[236:239], v[212:215], v[64:67]
    s_waitcnt vmcnt(16)
    v_mfma_f32_16x16x32_bf16 v[84:87], v[236:239], v[216:219], v[84:87]
    buffer_load_dwordx4 v[140:143], v90, s[16:19], s37 offen offset:1024 sc1
    v_mfma_f32_16x16x32_bf16 v[80:83], v[232:235], v[216:219], v[80:83]
    v_mfma_f32_16x16x32_bf16 v[76:79], v[228:231], v[216:219], v[76:79]
    buffer_load_dwordx4 v[144:147], v91, s[16:19], s37 offen offset:1024 sc1
    v_mfma_f32_16x16x32_bf16 v[72:75], v[224:227], v[216:219], v[72:75]
    v_mfma_f32_16x16x32_bf16 v[68:71], v[220:223], v[216:219], v[68:71]
    s_waitcnt vmcnt(12)
    v_mfma_f32_16x16x32_bf16 v[8:11], v[112:115], v[96:99], v[8:11]
    v_mfma_f32_16x16x32_bf16 v[12:15], v[116:119], v[96:99], v[12:15]
    buffer_load_dwordx4 v[184:187], v2, s[16:19], s39 offen offset:0 sc1
    v_mfma_f32_16x16x32_bf16 v[16:19], v[120:123], v[96:99], v[16:19]
    v_mfma_f32_16x16x32_bf16 v[20:23], v[124:127], v[96:99], v[20:23]
    buffer_load_dwordx4 v[188:191], v2, s[16:19], s39 offen offset:1024 sc1
    v_mfma_f32_16x16x32_bf16 v[24:27], v[128:131], v[96:99], v[24:27]
    s_waitcnt vmcnt(13)
    v_mfma_f32_16x16x32_bf16 v[44:47], v[128:131], v[100:103], v[44:47]
    buffer_load_dwordx4 v[192:195], v2, s[16:19], s39 offen offset:2048 sc1
    v_mfma_f32_16x16x32_bf16 v[40:43], v[124:127], v[100:103], v[40:43]
    v_mfma_f32_16x16x32_bf16 v[36:39], v[120:123], v[100:103], v[36:39]
    buffer_load_dwordx4 v[196:199], v2, s[16:19], s39 offen offset:3072 sc1
    v_mfma_f32_16x16x32_bf16 v[32:35], v[116:119], v[100:103], v[32:35]
    v_mfma_f32_16x16x32_bf16 v[28:31], v[112:115], v[100:103], v[28:31]
    buffer_load_dwordx4 v[200:203], v94, s[16:19], s39 offen sc1
    s_add_u32 s39, s39, 5120
    s_waitcnt vmcnt(15)
    v_mfma_f32_16x16x32_bf16 v[48:51], v[112:115], v[104:107], v[48:51]
    v_mfma_f32_16x16x32_bf16 v[52:55], v[116:119], v[104:107], v[52:55]
    buffer_load_dwordx4 v[168:171], v88, s[16:19], s37 offen offset:2048 sc1
    v_mfma_f32_16x16x32_bf16 v[56:59], v[120:123], v[104:107], v[56:59]
    v_mfma_f32_16x16x32_bf16 v[60:63], v[124:127], v[104:107], v[60:63]
    buffer_load_dwordx4 v[172:175], v89, s[16:19], s37 offen offset:2048 sc1
    v_mfma_f32_16x16x32_bf16 v[64:67], v[128:131], v[104:107], v[64:67]
    s_waitcnt vmcnt(16)
    v_mfma_f32_16x16x32_bf16 v[84:87], v[128:131], v[108:111], v[84:87]
    buffer_load_dwordx4 v[176:179], v90, s[16:19], s37 offen offset:2048 sc1
    v_mfma_f32_16x16x32_bf16 v[80:83], v[124:127], v[108:111], v[80:83]
    v_mfma_f32_16x16x32_bf16 v[76:79], v[120:123], v[108:111], v[76:79]
    buffer_load_dwordx4 v[180:183], v91, s[16:19], s37 offen offset:2048 sc1
    v_mfma_f32_16x16x32_bf16 v[72:75], v[116:119], v[108:111], v[72:75]
    v_mfma_f32_16x16x32_bf16 v[68:71], v[112:115], v[108:111], v[68:71]
    s_waitcnt vmcnt(12)
    v_mfma_f32_16x16x32_bf16 v[8:11], v[148:151], v[132:135], v[8:11]
    v_mfma_f32_16x16x32_bf16 v[12:15], v[152:155], v[132:135], v[12:15]
    buffer_load_dwordx4 v[220:223], v2, s[16:19], s39 offen offset:0 sc1
    v_mfma_f32_16x16x32_bf16 v[16:19], v[156:159], v[132:135], v[16:19]
    v_mfma_f32_16x16x32_bf16 v[20:23], v[160:163], v[132:135], v[20:23]
    buffer_load_dwordx4 v[224:227], v2, s[16:19], s39 offen offset:1024 sc1
    v_mfma_f32_16x16x32_bf16 v[24:27], v[164:167], v[132:135], v[24:27]
    s_waitcnt vmcnt(13)
    v_mfma_f32_16x16x32_bf16 v[44:47], v[164:167], v[136:139], v[44:47]
    buffer_load_dwordx4 v[228:231], v2, s[16:19], s39 offen offset:2048 sc1
    v_mfma_f32_16x16x32_bf16 v[40:43], v[160:163], v[136:139], v[40:43]
    v_mfma_f32_16x16x32_bf16 v[36:39], v[156:159], v[136:139], v[36:39]
    buffer_load_dwordx4 v[232:235], v2, s[16:19], s39 offen offset:3072 sc1
    v_mfma_f32_16x16x32_bf16 v[32:35], v[152:155], v[136:139], v[32:35]
    v_mfma_f32_16x16x32_bf16 v[28:31], v[148:151], v[136:139], v[28:31]
    buffer_load_dwordx4 v[236:239], v94, s[16:19], s39 offen sc1
    s_add_u32 s39, s39, 5120
    s_waitcnt vmcnt(15)
    v_mfma_f32_16x16x32_bf16 v[48:51], v[148:151], v[140:143], v[48:51]
    v_mfma_f32_16x16x32_bf16 v[52:55], v[152:155], v[140:143], v[52:55]
    buffer_load_dwordx4 v[204:207], v88, s[16:19], s37 offen offset:3072 sc1
    v_mfma_f32_16x16x32_bf16 v[56:59], v[156:159], v[140:143], v[56:59]
    v_mfma_f32_16x16x32_bf16 v[60:63], v[160:163], v[140:143], v[60:63]
    buffer_load_dwordx4 v[208:211], v89, s[16:19], s37 offen offset:3072 sc1
    v_mfma_f32_16x16x32_bf16 v[64:67], v[164:167], v[140:143], v[64:67]
    s_waitcnt vmcnt(16)
    v_mfma_f32_16x16x32_bf16 v[84:87], v[164:167], v[144:147], v[84:87]
    buffer_load_dwordx4 v[212:215], v90, s[16:19], s37 offen offset:3072 sc1
    v_mfma_f32_16x16x32_bf16 v[80:83], v[160:163], v[144:147], v[80:83]
    v_mfma_f32_16x16x32_bf16 v[76:79], v[156:159], v[144:147], v[76:79]
    buffer_load_dwordx4 v[216:219], v91, s[16:19], s37 offen offset:3072 sc1
    v_mfma_f32_16x16x32_bf16 v[72:75], v[152:155], v[144:147], v[72:75]
    v_mfma_f32_16x16x32_bf16 v[68:71], v[148:151], v[144:147], v[68:71]
    s_waitcnt vmcnt(12)
    v_mfma_f32_16x16x32_bf16 v[8:11], v[184:187], v[168:171], v[8:11]
    v_mfma_f32_16x16x32_bf16 v[12:15], v[188:191], v[168:171], v[12:15]
    buffer_load_dwordx4 v[112:115], v2, s[16:19], s76 offen offset:0 sc1
    v_mfma_f32_16x16x32_bf16 v[16:19], v[192:195], v[168:171], v[16:19]
    v_mfma_f32_16x16x32_bf16 v[20:23], v[196:199], v[168:171], v[20:23]
    buffer_load_dwordx4 v[116:119], v2, s[16:19], s76 offen offset:1024 sc1
    v_mfma_f32_16x16x32_bf16 v[24:27], v[200:203], v[168:171], v[24:27]
    s_waitcnt vmcnt(13)
    v_mfma_f32_16x16x32_bf16 v[44:47], v[200:203], v[172:175], v[44:47]
    buffer_load_dwordx4 v[120:123], v2, s[16:19], s76 offen offset:2048 sc1
    v_mfma_f32_16x16x32_bf16 v[40:43], v[196:199], v[172:175], v[40:43]
    v_mfma_f32_16x16x32_bf16 v[36:39], v[192:195], v[172:175], v[36:39]
    buffer_load_dwordx4 v[124:127], v2, s[16:19], s76 offen offset:3072 sc1
    v_mfma_f32_16x16x32_bf16 v[32:35], v[188:191], v[172:175], v[32:35]
    v_mfma_f32_16x16x32_bf16 v[28:31], v[184:187], v[172:175], v[28:31]
    buffer_load_dwordx4 v[128:131], v94, s[16:19], s76 offen sc1
    s_add_u32 s76, s76, 5120
    s_waitcnt vmcnt(15)
    v_mfma_f32_16x16x32_bf16 v[48:51], v[184:187], v[176:179], v[48:51]
    v_mfma_f32_16x16x32_bf16 v[52:55], v[188:191], v[176:179], v[52:55]
    buffer_load_dwordx4 v[96:99], v88, s[16:19], s43 offen offset:0 sc1
    v_mfma_f32_16x16x32_bf16 v[56:59], v[192:195], v[176:179], v[56:59]
    v_mfma_f32_16x16x32_bf16 v[60:63], v[196:199], v[176:179], v[60:63]
    buffer_load_dwordx4 v[100:103], v89, s[16:19], s43 offen offset:0 sc1
    v_mfma_f32_16x16x32_bf16 v[64:67], v[200:203], v[176:179], v[64:67]
    s_waitcnt vmcnt(16)
    v_mfma_f32_16x16x32_bf16 v[84:87], v[200:203], v[180:183], v[84:87]
    buffer_load_dwordx4 v[104:107], v90, s[16:19], s43 offen offset:0 sc1
    v_mfma_f32_16x16x32_bf16 v[80:83], v[196:199], v[180:183], v[80:83]
    v_mfma_f32_16x16x32_bf16 v[76:79], v[192:195], v[180:183], v[76:79]
    buffer_load_dwordx4 v[108:111], v91, s[16:19], s43 offen offset:0 sc1
    v_mfma_f32_16x16x32_bf16 v[72:75], v[188:191], v[180:183], v[72:75]
    v_mfma_f32_16x16x32_bf16 v[68:71], v[184:187], v[180:183], v[68:71]
    s_waitcnt vmcnt(12)
    v_mfma_f32_16x16x32_bf16 v[8:11], v[220:223], v[204:207], v[8:11]
    v_mfma_f32_16x16x32_bf16 v[12:15], v[224:227], v[204:207], v[12:15]
    buffer_load_dwordx4 v[148:151], v2, s[16:19], s76 offen offset:0 sc1
    v_mfma_f32_16x16x32_bf16 v[16:19], v[228:231], v[204:207], v[16:19]
    v_mfma_f32_16x16x32_bf16 v[20:23], v[232:235], v[204:207], v[20:23]
    buffer_load_dwordx4 v[152:155], v2, s[16:19], s76 offen offset:1024 sc1
    v_mfma_f32_16x16x32_bf16 v[24:27], v[236:239], v[204:207], v[24:27]
    s_waitcnt vmcnt(13)
    v_mfma_f32_16x16x32_bf16 v[44:47], v[236:239], v[208:211], v[44:47]
    buffer_load_dwordx4 v[156:159], v2, s[16:19], s76 offen offset:2048 sc1
    v_mfma_f32_16x16x32_bf16 v[40:43], v[232:235], v[208:211], v[40:43]
    v_mfma_f32_16x16x32_bf16 v[36:39], v[228:231], v[208:211], v[36:39]
    buffer_load_dwordx4 v[160:163], v2, s[16:19], s76 offen offset:3072 sc1
    v_mfma_f32_16x16x32_bf16 v[32:35], v[224:227], v[208:211], v[32:35]
    v_mfma_f32_16x16x32_bf16 v[28:31], v[220:223], v[208:211], v[28:31]
    buffer_load_dwordx4 v[164:167], v94, s[16:19], s76 offen sc1
    s_add_u32 s76, s76, 5120
    s_waitcnt vmcnt(15)
    v_mfma_f32_16x16x32_bf16 v[48:51], v[220:223], v[212:215], v[48:51]
    v_mfma_f32_16x16x32_bf16 v[52:55], v[224:227], v[212:215], v[52:55]
    buffer_load_dwordx4 v[132:135], v88, s[16:19], s43 offen offset:1024 sc1
    v_mfma_f32_16x16x32_bf16 v[56:59], v[228:231], v[212:215], v[56:59]
    ds_read_b32 v93, v7 offset:40
    v_mfma_f32_16x16x32_bf16 v[60:63], v[232:235], v[212:215], v[60:63]
    buffer_load_dwordx4 v[136:139], v89, s[16:19], s43 offen offset:1024 sc1
    v_mfma_f32_16x16x32_bf16 v[64:67], v[236:239], v[212:215], v[64:67]
    s_waitcnt vmcnt(16)
    v_mfma_f32_16x16x32_bf16 v[84:87], v[236:239], v[216:219], v[84:87]
    buffer_load_dwordx4 v[140:143], v90, s[16:19], s43 offen offset:1024 sc1
    v_mfma_f32_16x16x32_bf16 v[80:83], v[232:235], v[216:219], v[80:83]
    v_mfma_f32_16x16x32_bf16 v[76:79], v[228:231], v[216:219], v[76:79]
    buffer_load_dwordx4 v[144:147], v91, s[16:19], s43 offen offset:1024 sc1
    v_mfma_f32_16x16x32_bf16 v[72:75], v[224:227], v[216:219], v[72:75]
    v_mfma_f32_16x16x32_bf16 v[68:71], v[220:223], v[216:219], v[68:71]
    s_waitcnt lgkmcnt(0)
    v_readfirstlane_b32 s74, v93
    s_cmp_lt_u32 s74, 8
    s_cbranch_scc1 L_aw_19_s
L_awd_20:
    s_waitcnt vmcnt(12)
    v_mfma_f32_16x16x32_bf16 v[8:11], v[112:115], v[96:99], v[8:11]
    v_mfma_f32_16x16x32_bf16 v[12:15], v[116:119], v[96:99], v[12:15]
    buffer_load_dwordx4 v[184:187], v2, s[16:19], s76 offen offset:0 sc1
    v_mfma_f32_16x16x32_bf16 v[16:19], v[120:123], v[96:99], v[16:19]
    v_mfma_f32_16x16x32_bf16 v[20:23], v[124:127], v[96:99], v[20:23]
    buffer_load_dwordx4 v[188:191], v2, s[16:19], s76 offen offset:1024 sc1
    v_mfma_f32_16x16x32_bf16 v[24:27], v[128:131], v[96:99], v[24:27]
    s_waitcnt vmcnt(13)
    v_mfma_f32_16x16x32_bf16 v[44:47], v[128:131], v[100:103], v[44:47]
    buffer_load_dwordx4 v[192:195], v2, s[16:19], s76 offen offset:2048 sc1
    v_mfma_f32_16x16x32_bf16 v[40:43], v[124:127], v[100:103], v[40:43]
    v_mfma_f32_16x16x32_bf16 v[36:39], v[120:123], v[100:103], v[36:39]
    buffer_load_dwordx4 v[196:199], v2, s[16:19], s76 offen offset:3072 sc1
    v_mfma_f32_16x16x32_bf16 v[32:35], v[116:119], v[100:103], v[32:35]
    v_mfma_f32_16x16x32_bf16 v[28:31], v[112:115], v[100:103], v[28:31]
    buffer_load_dwordx4 v[200:203], v94, s[16:19], s76 offen sc1
    s_add_u32 s76, s76, 5120
    s_waitcnt vmcnt(15)
    v_mfma_f32_16x16x32_bf16 v[48:51], v[112:115], v[104:107], v[48:51]
    v_mfma_f32_16x16x32_bf16 v[52:55], v[116:119], v[104:107], v[52:55]
    buffer_load_dwordx4 v[168:171], v88, s[16:19], s43 offen offset:2048 sc1
    v_mfma_f32_16x16x32_bf16 v[56:59], v[120:123], v[104:107], v[56:59]
    v_mfma_f32_16x16x32_bf16 v[60:63], v[124:127], v[104:107], v[60:63]
    buffer_load_dwordx4 v[172:175], v89, s[16:19], s43 offen offset:2048 sc1
    v_mfma_f32_16x16x32_bf16 v[64:67], v[128:131], v[104:107], v[64:67]
    s_waitcnt vmcnt(16)
    v_mfma_f32_16x16x32_bf16 v[84:87], v[128:131], v[108:111], v[84:87]
    buffer_load_dwordx4 v[176:179], v90, s[16:19], s43 offen offset:2048 sc1
    v_mfma_f32_16x16x32_bf16 v[80:83], v[124:127], v[108:111], v[80:83]
    v_mfma_f32_16x16x32_bf16 v[76:79], v[120:123], v[108:111], v[76:79]
    buffer_load_dwordx4 v[180:183], v91, s[16:19], s43 offen offset:2048 sc1
    v_mfma_f32_16x16x32_bf16 v[72:75], v[116:119], v[108:111], v[72:75]
    v_mfma_f32_16x16x32_bf16 v[68:71], v[112:115], v[108:111], v[68:71]
    s_waitcnt vmcnt(12)
    v_mfma_f32_16x16x32_bf16 v[8:11], v[148:151], v[132:135], v[8:11]
    v_mfma_f32_16x16x32_bf16 v[12:15], v[152:155], v[132:135], v[12:15]
    buffer_load_dwordx4 v[220:223], v2, s[16:19], s76 offen offset:0 sc1
    v_mfma_f32_16x16x32_bf16 v[16:19], v[156:159], v[132:135], v[16:19]
    v_mfma_f32_16x16x32_bf16 v[20:23], v[160:163], v[132:135], v[20:23]
    buffer_load_dwordx4 v[224:227], v2, s[16:19], s76 offen offset:1024 sc1
    v_mfma_f32_16x16x32_bf16 v[24:27], v[164:167], v[132:135], v[24:27]
    s_waitcnt vmcnt(13)
    v_mfma_f32_16x16x32_bf16 v[44:47], v[164:167], v[136:139], v[44:47]
    buffer_load_dwordx4 v[228:231], v2, s[16:19], s76 offen offset:2048 sc1
    v_mfma_f32_16x16x32_bf16 v[40:43], v[160:163], v[136:139], v[40:43]
    v_mfma_f32_16x16x32_bf16 v[36:39], v[156:159], v[136:139], v[36:39]
    buffer_load_dwordx4 v[232:235], v2, s[16:19], s76 offen offset:3072 sc1
    v_mfma_f32_16x16x32_bf16 v[32:35], v[152:155], v[136:139], v[32:35]
    v_mfma_f32_16x16x32_bf16 v[28:31], v[148:151], v[136:139], v[28:31]
    buffer_load_dwordx4 v[236:239], v94, s[16:19], s76 offen sc1
    s_add_u32 s76, s76, 5120
    s_waitcnt vmcnt(15)
    v_mfma_f32_16x16x32_bf16 v[48:51], v[148:151], v[140:143], v[48:51]
    v_mfma_f32_16x16x32_bf16 v[52:55], v[152:155], v[140:143], v[52:55]
    buffer_load_dwordx4 v[204:207], v88, s[16:19], s43 offen offset:3072 sc1
    v_mfma_f32_16x16x32_bf16 v[56:59], v[156:159], v[140:143], v[56:59]
    v_mfma_f32_16x16x32_bf16 v[60:63], v[160:163], v[140:143], v[60:63]
    buffer_load_dwordx4 v[208:211], v89, s[16:19], s43 offen offset:3072 sc1
    v_mfma_f32_16x16x32_bf16 v[64:67], v[164:167], v[140:143], v[64:67]
    s_waitcnt vmcnt(16)
    v_mfma_f32_16x16x32_bf16 v[84:87], v[164:167], v[144:147], v[84:87]
    buffer_load_dwordx4 v[212:215], v90, s[16:19], s43 offen offset:3072 sc1
    v_mfma_f32_16x16x32_bf16 v[80:83], v[160:163], v[144:147], v[80:83]
    v_mfma_f32_16x16x32_bf16 v[76:79], v[156:159], v[144:147], v[76:79]
    buffer_load_dwordx4 v[216:219], v91, s[16:19], s43 offen offset:3072 sc1
    v_mfma_f32_16x16x32_bf16 v[72:75], v[152:155], v[144:147], v[72:75]
    ds_read_b32 v93, v3 offset:96
    v_mfma_f32_16x16x32_bf16 v[68:71], v[148:151], v[144:147], v[68:71]
    s_waitcnt lgkmcnt(0)
    v_readfirstlane_b32 s74, v93
    s_cmp_lt_u32 s74, 1
    s_cbranch_scc1 L_olate
    s_setprio 2
    s_waitcnt vmcnt(12)
    v_mfma_f32_16x16x32_bf16 v[8:11], v[184:187], v[168:171], v[8:11]
    ds_read_b128 v[136:139], v5 offset:0
    v_mfma_f32_16x16x32_bf16 v[12:15], v[188:191], v[168:171], v[12:15]
    buffer_load_dwordx4 v[96:99], v2, s[16:19], s40 offen offset:0 sc1
    v_mfma_f32_16x16x32_bf16 v[16:19], v[192:195], v[168:171], v[16:19]
    ds_read_b128 v[140:143], v5 offset:1024
    v_mfma_f32_16x16x32_bf16 v[20:23], v[196:199], v[168:171], v[20:23]
    buffer_load_dwordx4 v[100:103], v2, s[16:19], s40 offen offset:1024 sc1
    v_mfma_f32_16x16x32_bf16 v[24:27], v[200:203], v[168:171], v[24:27]
    ds_read_b128 v[144:147], v5 offset:2048
    s_waitcnt vmcnt(13)
    v_mfma_f32_16x16x32_bf16 v[44:47], v[200:203], v[172:175], v[44:47]
    buffer_load_dwordx4 v[104:107], v2, s[16:19], s40 offen offset:2048 sc1
    v_mfma_f32_16x16x32_bf16 v[40:43], v[196:199], v[172:175], v[40:43]
    ds_read_b128 v[148:151], v5 offset:3072
    v_mfma_f32_16x16x32_bf16 v[36:39], v[192:195], v[172:175], v[36:39]
    buffer_load_dwordx4 v[108:111], v2, s[16:19], s40 offen offset:3072 sc1
    v_mfma_f32_16x16x32_bf16 v[32:35], v[188:191], v[172:175], v[32:35]
    ds_read_b128 v[152:155], v5 offset:4096
    v_mfma_f32_16x16x32_bf16 v[28:31], v[184:187], v[172:175], v[28:31]
    buffer_load_dwordx2 v[112:113], v4, s[16:19], s41 offen offset:0 sc1
    s_waitcnt vmcnt(15)
    v_mfma_f32_16x16x32_bf16 v[48:51], v[184:187], v[176:179], v[48:51]
    v_mfma_f32_16x16x32_bf16 v[52:55], v[188:191], v[176:179], v[52:55]
    buffer_load_dwordx2 v[114:115], v4, s[16:19], s41 offen offset:128 sc1
    s_add_u32 s40, s40, 20480
    s_add_u32 s41, s41, 20480
    v_mfma_f32_16x16x32_bf16 v[56:59], v[192:195], v[176:179], v[56:59]
    v_mfma_f32_16x16x32_bf16 v[60:63], v[196:199], v[176:179], v[60:63]
    buffer_load_dwordx4 v[116:119], v2, s[16:19], s40 offen offset:0 sc1
    v_mfma_f32_16x16x32_bf16 v[64:67], v[200:203], v[176:179], v[64:67]
    s_waitcnt vmcnt(16)
    v_mfma_f32_16x16x32_bf16 v[84:87], v[200:203], v[180:183], v[84:87]
    buffer_load_dwordx4 v[120:123], v2, s[16:19], s40 offen offset:1024 sc1
    v_mfma_f32_16x16x32_bf16 v[80:83], v[196:199], v[180:183], v[80:83]
    v_mfma_f32_16x16x32_bf16 v[76:79], v[192:195], v[180:183], v[76:79]
    buffer_load_dwordx4 v[124:127], v2, s[16:19], s40 offen offset:2048 sc1
    v_mfma_f32_16x16x32_bf16 v[72:75], v[188:191], v[180:183], v[72:75]
    v_mfma_f32_16x16x32_bf16 v[68:71], v[184:187], v[180:183], v[68:71]
    s_waitcnt vmcnt(12)
    v_mfma_f32_16x16x32_bf16 v[8:11], v[220:223], v[204:207], v[8:11]
    ds_read_b128 v[156:159], v5 offset:5120
    v_mfma_f32_16x16x32_bf16 v[12:15], v[224:227], v[204:207], v[12:15]
    buffer_load_dwordx4 v[128:131], v2, s[16:19], s40 offen offset:3072 sc1
    v_mfma_f32_16x16x32_bf16 v[16:19], v[228:231], v[204:207], v[16:19]
    ds_read_b128 v[160:163], v5 offset:6144
    v_mfma_f32_16x16x32_bf16 v[20:23], v[232:235], v[204:207], v[20:23]
    buffer_load_dwordx2 v[132:133], v4, s[16:19], s41 offen offset:0 sc1
    v_mfma_f32_16x16x32_bf16 v[24:27], v[236:239], v[204:207], v[24:27]
    ds_read_b128 v[164:167], v5 offset:7168
    s_waitcnt vmcnt(13)
    v_mfma_f32_16x16x32_bf16 v[44:47], v[236:239], v[208:211], v[44:47]
    buffer_load_dwordx2 v[134:135], v4, s[16:19], s41 offen offset:128 sc1
    s_add_u32 s40, s40, 20480
    s_add_u32 s41, s41, 20480
    v_mfma_f32_16x16x32_bf16 v[40:43], v[232:235], v[208:211], v[40:43]
    ds_read_b128 v[168:171], v5 offset:8192
    v_mfma_f32_16x16x32_bf16 v[36:39], v[228:231], v[208:211], v[36:39]
    v_mfma_f32_16x16x32_bf16 v[32:35], v[224:227], v[208:211], v[32:35]
    ds_read_b128 v[172:175], v5 offset:9216
    v_mfma_f32_16x16x32_bf16 v[28:31], v[220:223], v[208:211], v[28:31]
    s_waitcnt vmcnt(13)
    v_mfma_f32_16x16x32_bf16 v[48:51], v[220:223], v[212:215], v[48:51]
    ds_read_b128 v[176:179], v5 offset:10240
    v_mfma_f32_16x16x32_bf16 v[52:55], v[224:227], v[212:215], v[52:55]
    v_mfma_f32_16x16x32_bf16 v[56:59], v[228:231], v[212:215], v[56:59]
    ds_read_b128 v[180:183], v5 offset:11264
    v_mfma_f32_16x16x32_bf16 v[60:63], v[232:235], v[212:215], v[60:63]
    v_mfma_f32_16x16x32_bf16 v[64:67], v[236:239], v[212:215], v[64:67]
    ds_read_b128 v[184:187], v5 offset:12288
    s_waitcnt vmcnt(12)
    v_mfma_f32_16x16x32_bf16 v[84:87], v[236:239], v[216:219], v[84:87]
    v_mfma_f32_16x16x32_bf16 v[80:83], v[232:235], v[216:219], v[80:83]
    ds_read_b128 v[188:191], v5 offset:13312
    v_mfma_f32_16x16x32_bf16 v[76:79], v[228:231], v[216:219], v[76:79]
    v_mfma_f32_16x16x32_bf16 v[72:75], v[224:227], v[216:219], v[72:75]
    ds_read_b128 v[192:195], v5 offset:14336
    v_mfma_f32_16x16x32_bf16 v[68:71], v[220:223], v[216:219], v[68:71]
    ds_read_b128 v[196:199], v5 offset:15360
    ds_read_b128 v[200:203], v5 offset:16384
    ds_read_b128 v[204:207], v5 offset:17408
    ds_read_b128 v[208:211], v5 offset:18432
    ds_read_b128 v[212:215], v5 offset:19456
    ds_read_b128 v[216:219], v5 offset:20480
    ds_read_b128 v[220:223], v5 offset:21504
    ds_read_b128 v[224:227], v5 offset:22528
    ds_read_b128 v[228:231], v5 offset:23552
    ds_read_b128 v[232:235], v5 offset:24576
L_omerge:
    s_waitcnt vmcnt(11) lgkmcnt(15)
    v_mfma_f32_16x16x32_bf16 v[8:11], v[136:139], v[96:99], v[8:11]
    buffer_load_dwordx4 v[236:239], v2, s[16:19], s40 offen offset:0 sc1
    v_mfma_f32_16x16x32_bf16 v[12:15], v[140:143], v[96:99], v[12:15]
    v_mfma_f32_16x16x32_bf16 v[16:19], v[144:147], v[96:99], v[16:19]
    v_mfma_f32_16x16x32_bf16 v[20:23], v[148:151], v[96:99], v[20:23]
    buffer_load_dwordx4 v[240:243], v2, s[16:19], s40 offen offset:1024 sc1
    v_mfma_f32_16x16x32_bf16 v[24:27], v[152:155], v[96:99], v[24:27]
    s_waitcnt vmcnt(12)
    v_mfma_f32_16x16x32_bf16 v[8:11], v[156:159], v[100:103], v[8:11]
    v_mfma_f32_16x16x32_bf16 v[12:15], v[160:163], v[100:103], v[12:15]
    buffer_load_dwordx4 v[244:247], v2, s[16:19], s40 offen offset:2048 sc1
    v_mfma_f32_16x16x32_bf16 v[16:19], v[164:167], v[100:103], v[16:19]
    v_mfma_f32_16x16x32_bf16 v[20:23], v[168:171], v[100:103], v[20:23]
    v_mfma_f32_16x16x32_bf16 v[24:27], v[172:175], v[100:103], v[24:27]
    buffer_load_dwordx4 v[248:251], v2, s[16:19], s40 offen offset:3072 sc1
    s_waitcnt vmcnt(13) lgkmcnt(10)
    v_mfma_f32_16x16x32_bf16 v[8:11], v[176:179], v[104:107], v[8:11]
    v_mfma_f32_16x16x32_bf16 v[12:15], v[180:183], v[104:107], v[12:15]
    v_mfma_f32_16x16x32_bf16 v[16:19], v[184:187], v[104:107], v[16:19]
    buffer_load_dwordx2 v[252:253], v4, s[16:19], s41 offen offset:0 sc1
    v_mfma_f32_16x16x32_bf16 v[20:23], v[188:191], v[104:107], v[20:23]
    v_mfma_f32_16x16x32_bf16 v[24:27], v[192:195], v[104:107], v[24:27]
    s_waitcnt vmcnt(13) lgkmcnt(5)
    v_mfma_f32_16x16x32_bf16 v[8:11], v[196:199], v[108:111], v[8:11]
    buffer_load_dwordx2 v[254:255], v4, s[16:19], s41 offen offset:128 sc1
    s_add_u32 s40, s40, 20480
    s_add_u32 s41, s41, 20480
    v_mfma_f32_16x16x32_bf16 v[12:15], v[200:203], v[108:111], v[12:15]
    v_mfma_f32_16x16x32_bf16 v[16:19], v[204:207], v[108:111], v[16:19]
    v_mfma_f32_16x16x32_bf16 v[20:23], v[208:211], v[108:111], v[20:23]
    v_mfma_f32_16x16x32_bf16 v[24:27], v[212:215], v[108:111], v[24:27]
    s_waitcnt vmcnt(12) lgkmcnt(0)
    v_mfma_f32_16x16x32_bf16 v[8:11], v[216:219], v[112:115], v[8:11]
    v_mfma_f32_16x16x32_bf16 v[12:15], v[220:223], v[112:115], v[12:15]
    v_mfma_f32_16x16x32_bf16 v[16:19], v[224:227], v[112:115], v[16:19]
    v_mfma_f32_16x16x32_bf16 v[20:23], v[228:231], v[112:115], v[20:23]
    v_mfma_f32_16x16x32_bf16 v[24:27], v[232:235], v[112:115], v[24:27]
    s_waitcnt vmcnt(11)
    v_mfma_f32_16x16x32_bf16 v[28:31], v[136:139], v[116:119], v[28:31]
    buffer_load_dwordx4 v[96:99], v2, s[16:19], s40 offen offset:0 sc1
    v_mfma_f32_16x16x32_bf16 v[32:35], v[140:143], v[116:119], v[32:35]
    v_mfma_f32_16x16x32_bf16 v[36:39], v[144:147], v[116:119], v[36:39]
    ds_write_b128 v95, v[8:11] offset:0
    v_mfma_f32_16x16x32_bf16 v[40:43], v[148:151], v[116:119], v[40:43]
    buffer_load_dwordx4 v[100:103], v2, s[16:19], s40 offen offset:1024 sc1
    v_mfma_f32_16x16x32_bf16 v[44:47], v[152:155], v[116:119], v[44:47]
    ds_write_b128 v95, v[12:15] offset:32
    s_waitcnt vmcnt(12)
    v_mfma_f32_16x16x32_bf16 v[28:31], v[156:159], v[120:123], v[28:31]
    v_mfma_f32_16x16x32_bf16 v[32:35], v[160:163], v[120:123], v[32:35]
    buffer_load_dwordx4 v[104:107], v2, s[16:19], s40 offen offset:2048 sc1
    ds_write_b128 v95, v[16:19] offset:64
    v_mfma_f32_16x16x32_bf16 v[36:39], v[164:167], v[120:123], v[36:39]
    v_mfma_f32_16x16x32_bf16 v[40:43], v[168:171], v[120:123], v[40:43]
    ds_write_b128 v95, v[20:23] offset:96
    v_mfma_f32_16x16x32_bf16 v[44:47], v[172:175], v[120:123], v[44:47]
    buffer_load_dwordx4 v[108:111], v2, s[16:19], s40 offen offset:3072 sc1
    s_waitcnt vmcnt(13)
    v_mfma_f32_16x16x32_bf16 v[28:31], v[176:179], v[124:127], v[28:31]
    ds_write_b128 v95, v[24:27] offset:128
    ds_add_u32 v7, v1 offset:64
    v_mfma_f32_16x16x32_bf16 v[32:35], v[180:183], v[124:127], v[32:35]
    v_mfma_f32_16x16x32_bf16 v[36:39], v[184:187], v[124:127], v[36:39]
    buffer_load_dwordx2 v[112:113], v4, s[16:19], s41 offen offset:0 sc1
    v_mfma_f32_16x16x32_bf16 v[40:43], v[188:191], v[124:127], v[40:43]
    v_mfma_f32_16x16x32_bf16 v[44:47], v[192:195], v[124:127], v[44:47]
    s_waitcnt vmcnt(13)
    v_mfma_f32_16x16x32_bf16 v[28:31], v[196:199], v[128:131], v[28:31]
    buffer_load_dwordx2 v[114:115], v4, s[16:19], s41 offen offset:128 sc1
    s_add_u32 s40, s40, 20480
    s_add_u32 s41, s41, 20480
    v_mfma_f32_16x16x32_bf16 v[32:35], v[200:203], v[128:131], v[32:35]
    v_mfma_f32_16x16x32_bf16 v[36:39], v[204:207], v[128:131], v[36:39]
    v_mfma_f32_16x16x32_bf16 v[40:43], v[208:211], v[128:131], v[40:43]
    v_mfma_f32_16x16x32_bf16 v[44:47], v[212:215], v[128:131], v[44:47]
    s_waitcnt vmcnt(12)
    v_mfma_f32_16x16x32_bf16 v[28:31], v[216:219], v[132:135], v[28:31]
    v_mfma_f32_16x16x32_bf16 v[32:35], v[220:223], v[132:135], v[32:35]
    v_mfma_f32_16x16x32_bf16 v[36:39], v[224:227], v[132:135], v[36:39]
    v_mfma_f32_16x16x32_bf16 v[40:43], v[228:231], v[132:135], v[40:43]
    v_mfma_f32_16x16x32_bf16 v[44:47], v[232:235], v[132:135], v[44:47]
    s_waitcnt vmcnt(11)
    v_mfma_f32_16x16x32_bf16 v[48:51], v[136:139], v[236:239], v[48:51]
    v_mfma_f32_16x16x32_bf16 v[52:55], v[140:143], v[236:239], v[52:55]
    v_mfma_f32_16x16x32_bf16 v[56:59], v[144:147], v[236:239], v[56:59]
    ds_write_b128 v95, v[28:31] offset:2560
    v_mfma_f32_16x16x32_bf16 v[60:63], v[148:151], v[236:239], v[60:63]
    v_mfma_f32_16x16x32_bf16 v[64:67], v[152:155], v[236:239], v[64:67]
    ds_write_b128 v95, v[32:35] offset:2592
    s_waitcnt vmcnt(10)
    v_mfma_f32_16x16x32_bf16 v[48:51], v[156:159], v[240:243], v[48:51]
    v_mfma_f32_16x16x32_bf16 v[52:55], v[160:163], v[240:243], v[52:55]
    ds_write_b128 v95, v[36:39] offset:2624
    v_mfma_f32_16x16x32_bf16 v[56:59], v[164:167], v[240:243], v[56:59]
    v_mfma_f32_16x16x32_bf16 v[60:63], v[168:171], v[240:243], v[60:63]
    ds_write_b128 v95, v[40:43] offset:2656
    v_mfma_f32_16x16x32_bf16 v[64:67], v[172:175], v[240:243], v[64:67]
    s_waitcnt vmcnt(9)
    v_mfma_f32_16x16x32_bf16 v[48:51], v[176:179], v[244:247], v[48:51]
    ds_write_b128 v95, v[44:47] offset:2688
    ds_add_u32 v7, v1 offset:68
    v_mfma_f32_16x16x32_bf16 v[52:55], v[180:183], v[244:247], v[52:55]
    v_mfma_f32_16x16x32_bf16 v[56:59], v[184:187], v[244:247], v[56:59]
    v_mfma_f32_16x16x32_bf16 v[60:63], v[188:191], v[244:247], v[60:63]
    v_mfma_f32_16x16x32_bf16 v[64:67], v[192:195], v[244:247], v[64:67]
    s_waitcnt vmcnt(8)
    v_mfma_f32_16x16x32_bf16 v[48:51], v[196:199], v[248:251], v[48:51]
    v_mfma_f32_16x16x32_bf16 v[52:55], v[200:203], v[248:251], v[52:55]
    v_mfma_f32_16x16x32_bf16 v[56:59], v[204:207], v[248:251], v[56:59]
    v_mfma_f32_16x16x32_bf16 v[60:63], v[208:211], v[248:251], v[60:63]
    v_mfma_f32_16x16x32_bf16 v[64:67], v[212:215], v[248:251], v[64:67]
    s_waitcnt vmcnt(6)
    v_mfma_f32_16x16x32_bf16 v[48:51], v[216:219], v[252:255], v[48:51]
    v_mfma_f32_16x16x32_bf16 v[52:55], v[220:223], v[252:255], v[52:55]
    v_mfma_f32_16x16x32_bf16 v[56:59], v[224:227], v[252:255], v[56:59]
    v_mfma_f32_16x16x32_bf16 v[60:63], v[228:231], v[252:255], v[60:63]
    v_mfma_f32_16x16x32_bf16 v[64:67], v[232:235], v[252:255], v[64:67]
    s_waitcnt vmcnt(5)
    v_mfma_f32_16x16x32_bf16 v[68:71], v[136:139], v[96:99], v[68:71]
    s_waitcnt vmcnt(4)
    v_mfma_f32_16x16x32_bf16 v[68:71], v[156:159], v[100:103], v[68:71]
    s_waitcnt vmcnt(3)
    v_mfma_f32_16x16x32_bf16 v[68:71], v[176:179], v[104:107], v[68:71]
    s_waitcnt vmcnt(2)
    v_mfma_f32_16x16x32_bf16 v[68:71], v[196:199], v[108:111], v[68:71]
    ds_write_b128 v95, v[48:51] offset:5120
    s_waitcnt vmcnt(0)
    v_mfma_f32_16x16x32_bf16 v[68:71], v[216:219], v[112:115], v[68:71]
    v_mfma_f32_16x16x32_bf16 v[72:75], v[140:143], v[96:99], v[72:75]
    ds_write_b128 v95, v[52:55] offset:5152
    v_mfma_f32_16x16x32_bf16 v[72:75], v[160:163], v[100:103], v[72:75]
    v_mfma_f32_16x16x32_bf16 v[72:75], v[180:183], v[104:107], v[72:75]
    ds_write_b128 v95, v[56:59] offset:5184
    v_mfma_f32_16x16x32_bf16 v[72:75], v[200:203], v[108:111], v[72:75]
    v_mfma_f32_16x16x32_bf16 v[72:75], v[220:223], v[112:115], v[72:75]
    ds_write_b128 v95, v[60:63] offset:5216
    v_mfma_f32_16x16x32_bf16 v[76:79], v[144:147], v[96:99], v[76:79]
    v_mfma_f32_16x16x32_bf16 v[76:79], v[164:167], v[100:103], v[76:79]
    ds_write_b128 v95, v[64:67] offset:5248
    v_mfma_f32_16x16x32_bf16 v[76:79], v[184:187], v[104:107], v[76:79]
    ds_add_u32 v7, v1 offset:72
    v_mfma_f32_16x16x32_bf16 v[76:79], v[204:207], v[108:111], v[76:79]
    v_mfma_f32_16x16x32_bf16 v[76:79], v[224:227], v[112:115], v[76:79]
    ds_write_b128 v95, v[68:71] offset:7680
    v_mfma_f32_16x16x32_bf16 v[80:83], v[148:151], v[96:99], v[80:83]
    v_mfma_f32_16x16x32_bf16 v[80:83], v[168:171], v[100:103], v[80:83]
    v_mfma_f32_16x16x32_bf16 v[80:83], v[188:191], v[104:107], v[80:83]
    v_mfma_f32_16x16x32_bf16 v[80:83], v[208:211], v[108:111], v[80:83]
    ds_write_b128 v95, v[72:75] offset:7712
    v_mfma_f32_16x16x32_bf16 v[80:83], v[228:231], v[112:115], v[80:83]
    v_mfma_f32_16x16x32_bf16 v[84:87], v[152:155], v[96:99], v[84:87]
    v_mfma_f32_16x16x32_bf16 v[84:87], v[172:175], v[100:103], v[84:87]
    v_mfma_f32_16x16x32_bf16 v[84:87], v[192:195], v[104:107], v[84:87]
    ds_write_b128 v95, v[76:79] offset:7744
    v_mfma_f32_16x16x32_bf16 v[84:87], v[212:215], v[108:111], v[84:87]
    v_mfma_f32_16x16x32_bf16 v[84:87], v[232:235], v[112:115], v[84:87]
    s_nop 1
    ds_write_b128 v95, v[80:83] offset:7776
    s_nop 4
    ds_write_b128 v95, v[84:87] offset:7808
    ds_add_u32 v7, v1 offset:76
    s_branch L_fin
L_rdys_2:
    v_mov_b32 v87, 0
    v_mov_b32 v86, 0
    v_cmp_gt_u32 vcc, 16, v87
    s_cbranch_vccnz L_vspin_21_s
L_vspun_22:
    s_branch L_rdy_3
L_aw_4_s:
    s_mov_b32 s75, 0
L_aw_4:
    ds_read_b32 v86, v7 offset:12
    s_add_u32 s75, s75, 1
    s_cmp_gt_u32 s75, 4000000
    s_waitcnt lgkmcnt(0)
    s_cbranch_scc1 L_awd_5
    v_readfirstlane_b32 s74, v86
    s_cmp_lt_u32 s74, 4
    s_cbranch_scc1 L_aw_4
    s_branch L_awd_5
L_aw_6_s:
    s_mov_b32 s75, 0
L_aw_6:
    ds_read_b32 v86, v7 offset:16
    s_add_u32 s75, s75, 1
    s_cmp_gt_u32 s75, 4000000
    s_waitcnt lgkmcnt(0)
    s_cbranch_scc1 L_awd_7
    v_readfirstlane_b32 s74, v86
    s_cmp_lt_u32 s74, 4
    s_cbranch_scc1 L_aw_6
    s_branch L_awd_7
L_aw_8_s:
    s_mov_b32 s75, 0
L_aw_8:
    ds_read_b32 v86, v7 offset:20
    s_add_u32 s75, s75, 1
    s_cmp_gt_u32 s75, 4000000
    s_waitcnt lgkmcnt(0)
    s_cbranch_scc1 L_awd_9
    v_readfirstlane_b32 s74, v86
    s_cmp_lt_u32 s74, 4
    s_cbranch_scc1 L_aw_8
    s_branch L_awd_9
L_aw_10_s:
    s_mov_b32 s75, 0
L_aw_10:
    ds_read_b32 v86, v7 offset:24
    s_add_u32 s75, s75, 1
    s_cmp_gt_u32 s75, 4000000
    s_waitcnt lgkmcnt(0)
    s_cbranch_scc1 L_awd_11
    v_readfirstlane_b32 s74, v86
    s_cmp_lt_u32 s74, 4
    s_cbranch_scc1 L_aw_10
    s_branch L_awd_11
L_gslow:
    s_mov_b32 s75, 0
L_gspin:
    buffer_load_dword v92, v6, s[16:19], s42 offen offset:0 sc1
    buffer_load_dword v93, v6, s[16:19], s42 offen offset:64 sc1
    s_add_u32 s75, s75, 1
    s_cmp_gt_u32 s75, 200000
    s_waitcnt vmcnt(0)
    s_cbranch_scc1 L_gok
    v_cmp_eq_u32 vcc, 0xbf800000, v92
    s_cbranch_vccnz L_gspin
    v_cmp_eq_u32 vcc, 0xbf800000, v93
    s_cbranch_vccnz L_gspin
    s_branch L_gok
L_aw_12_s:
    s_mov_b32 s75, 0
L_aw_12:
    ds_read_b32 v87, v7 offset:4
    s_add_u32 s75, s75, 1
    s_cmp_gt_u32 s75, 4000000
    s_waitcnt lgkmcnt(0)
    s_cbranch_scc1 L_awd_13
    v_readfirstlane_b32 s74, v87
    s_cmp_lt_u32 s74, 1
    s_cbranch_scc1 L_aw_12
    s_branch L_awd_13
L_aw_19_s:
    s_mov_b32 s75, 0
L_aw_19:
    ds_read_b32 v93, v7 offset:40
    s_add_u32 s75, s75, 1
    s_cmp_gt_u32 s75, 4000000
    s_waitcnt lgkmcnt(0)
    s_cbranch_scc1 L_awd_20
    v_readfirstlane_b32 s74, v93
    s_cmp_lt_u32 s74, 8
    s_cbranch_scc1 L_aw_19
    s_branch L_awd_20
L_olate:
    s_waitcnt vmcnt(12)
    v_mfma_f32_16x16x32_bf16 v[8:11], v[184:187], v[168:171], v[8:11]
    ds_read_b128 v[136:139], v5 offset:0
    v_mfma_f32_16x16x32_bf16 v[12:15], v[188:191], v[168:171], v[12:15]
    v_mfma_f32_16x16x32_bf16 v[16:19], v[192:195], v[168:171], v[16:19]
    ds_read_b128 v[140:143], v5 offset:1024
    v_mfma_f32_16x16x32_bf16 v[20:23], v[196:199], v[168:171], v[20:23]
    v_mfma_f32_16x16x32_bf16 v[24:27], v[200:203], v[168:171], v[24:27]
    ds_read_b128 v[144:147], v5 offset:2048
    s_waitcnt vmcnt(11)
    v_mfma_f32_16x16x32_bf16 v[44:47], v[200:203], v[172:175], v[44:47]
    v_mfma_f32_16x16x32_bf16 v[40:43], v[196:199], v[172:175], v[40:43]
    ds_read_b128 v[148:151], v5 offset:3072
    v_mfma_f32_16x16x32_bf16 v[36:39], v[192:195], v[172:175], v[36:39]
    v_mfma_f32_16x16x32_bf16 v[32:35], v[188:191], v[172:175], v[32:35]
    ds_read_b128 v[152:155], v5 offset:4096
    v_mfma_f32_16x16x32_bf16 v[28:31], v[184:187], v[172:175], v[28:31]
    s_waitcnt vmcnt(10)
    v_mfma_f32_16x16x32_bf16 v[48:51], v[184:187], v[176:179], v[48:51]
    v_mfma_f32_16x16x32_bf16 v[52:55], v[188:191], v[176:179], v[52:55]
    v_mfma_f32_16x16x32_bf16 v[56:59], v[192:195], v[176:179], v[56:59]
    v_mfma_f32_16x16x32_bf16 v[60:63], v[196:199], v[176:179], v[60:63]
    v_mfma_f32_16x16x32_bf16 v[64:67], v[200:203], v[176:179], v[64:67]
    ds_read_b32 v93, v3 offset:96
    s_waitcnt vmcnt(9)
    v_mfma_f32_16x16x32_bf16 v[84:87], v[200:203], v[180:183], v[84:87]
    v_mfma_f32_16x16x32_bf16 v[80:83], v[196:199], v[180:183], v[80:83]
    v_mfma_f32_16x16x32_bf16 v[76:79], v[192:195], v[180:183], v[76:79]
    v_mfma_f32_16x16x32_bf16 v[72:75], v[188:191], v[180:183], v[72:75]
    v_mfma_f32_16x16x32_bf16 v[68:71], v[184:187], v[180:183], v[68:71]
    s_waitcnt lgkmcnt(0)
    v_readfirstlane_b32 s74, v93
    s_cmp_lt_u32 s74, 1
    s_cbranch_scc1 L_olate2
    s_setprio 2
    s_waitcnt vmcnt(3)
    v_mfma_f32_16x16x32_bf16 v[8:11], v[220:223], v[204:207], v[8:11]
    ds_read_b128 v[156:159], v5 offset:5120
    v_mfma_f32_16x16x32_bf16 v[12:15], v[224:227], v[204:207], v[12:15]
    buffer_load_dwordx4 v[96:99], v2, s[16:19], s40 offen offset:0 sc1
    v_mfma_f32_16x16x32_bf16 v[16:19], v[228:231], v[204:207], v[16:19]
    ds_read_b128 v[160:163], v5 offset:6144
    v_mfma_f32_16x16x32_bf16 v[20:23], v[232:235], v[204:207], v[20:23]
    buffer_load_dwordx4 v[100:103], v2, s[16:19], s40 offen offset:1024 sc1
    v_mfma_f32_16x16x32_bf16 v[24:27], v[236:239], v[204:207], v[24:27]
    ds_read_b128 v[164:167], v5 offset:7168
    s_waitcnt vmcnt(4)
    v_mfma_f32_16x16x32_bf16 v[44:47], v[236:239], v[208:211], v[44:47]
    buffer_load_dwordx4 v[104:107], v2, s[16:19], s40 offen offset:2048 sc1
    v_mfma_f32_16x16x32_bf16 v[40:43], v[232:235], v[208:211], v[40:43]
    ds_read_b128 v[168:171], v5 offset:8192
    v_mfma_f32_16x16x32_bf16 v[36:39], v[228:231], v[208:211], v[36:39]
    buffer_load_dwordx4 v[108:111], v2, s[16:19], s40 offen offset:3072 sc1
    v_mfma_f32_16x16x32_bf16 v[32:35], v[224:227], v[208:211], v[32:35]
    ds_read_b128 v[172:175], v5 offset:9216
    v_mfma_f32_16x16x32_bf16 v[28:31], v[220:223], v[208:211], v[28:31]
    buffer_load_dwordx2 v[112:113], v4, s[16:19], s41 offen offset:0 sc1
    s_waitcnt vmcnt(6)
    v_mfma_f32_16x16x32_bf16 v[48:51], v[220:223], v[212:215], v[48:51]
    ds_read_b128 v[176:179], v5 offset:10240
    v_mfma_f32_16x16x32_bf16 v[52:55], v[224:227], v[212:215], v[52:55]
    buffer_load_dwordx2 v[114:115], v4, s[16:19], s41 offen offset:128 sc1
    s_add_u32 s40, s40, 20480
    s_add_u32 s41, s41, 20480
    v_mfma_f32_16x16x32_bf16 v[56:59], v[228:231], v[212:215], v[56:59]
    ds_read_b128 v[180:183], v5 offset:11264
    v_mfma_f32_16x16x32_bf16 v[60:63], v[232:235], v[212:215], v[60:63]
    buffer_load_dwordx4 v[116:119], v2, s[16:19], s40 offen offset:0 sc1
    v_mfma_f32_16x16x32_bf16 v[64:67], v[236:239], v[212:215], v[64:67]
    ds_read_b128 v[184:187], v5 offset:12288
    s_waitcnt vmcnt(7)
    v_mfma_f32_16x16x32_bf16 v[84:87], v[236:239], v[216:219], v[84:87]
    buffer_load_dwordx4 v[120:123], v2, s[16:19], s40 offen offset:1024 sc1
    v_mfma_f32_16x16x32_bf16 v[80:83], v[232:235], v[216:219], v[80:83]
    ds_read_b128 v[188:191], v5 offset:13312
    v_mfma_f32_16x16x32_bf16 v[76:79], v[228:231], v[216:219], v[76:79]
    buffer_load_dwordx4 v[124:127], v2, s[16:19], s40 offen offset:2048 sc1
    v_mfma_f32_16x16x32_bf16 v[72:75], v[224:227], v[216:219], v[72:75]
    ds_read_b128 v[192:195], v5 offset:14336
    v_mfma_f32_16x16x32_bf16 v[68:71], v[220:223], v[216:219], v[68:71]
    buffer_load_dwordx4 v[128:131], v2, s[16:19], s40 offen offset:3072 sc1
    buffer_load_dwordx2 v[132:133], v4, s[16:19], s41 offen offset:0 sc1
    buffer_load_dwordx2 v[134:135], v4, s[16:19], s41 offen offset:128 sc1
    s_add_u32 s40, s40, 20480
    s_add_u32 s41, s41, 20480
    ds_read_b128 v[196:199], v5 offset:15360
    ds_read_b128 v[200:203], v5 offset:16384
    ds_read_b128 v[204:207], v5 offset:17408
    ds_read_b128 v[208:211], v5 offset:18432
    ds_read_b128 v[212:215], v5 offset:19456
    ds_read_b128 v[216:219], v5 offset:20480
    ds_read_b128 v[220:223], v5 offset:21504
    ds_read_b128 v[224:227], v5 offset:22528
    ds_read_b128 v[228:231], v5 offset:23552
    ds_read_b128 v[232:235], v5 offset:24576
    s_branch L_omerge
L_olate2:
    s_waitcnt vmcnt(3)
    v_mfma_f32_16x16x32_bf16 v[8:11], v[220:223], v[204:207], v[8:11]
    ds_read_b128 v[156:159], v5 offset:5120
    v_mfma_f32_16x16x32_bf16 v[12:15], v[224:227], v[204:207], v[12:15]
    v_mfma_f32_16x16x32_bf16 v[16:19], v[228:231], v[204:207], v[16:19]
    ds_read_b128 v[160:163], v5 offset:6144
    v_mfma_f32_16x16x32_bf16 v[20:23], v[232:235], v[204:207], v[20:23]
    v_mfma_f32_16x16x32_bf16 v[24:27], v[236:239], v[204:207], v[24:27]
    ds_read_b128 v[164:167], v5 offset:7168
    s_waitcnt vmcnt(2)
    v_mfma_f32_16x16x32_bf16 v[44:47], v[236:239], v[208:211], v[44:47]
    v_mfma_f32_16x16x32_bf16 v[40:43], v[232:235], v[208:211], v[40:43]
    ds_read_b128 v[168:171], v5 offset:8192
    v_mfma_f32_16x16x32_bf16 v[36:39], v[228:231], v[208:211], v[36:39]
    v_mfma_f32_16x16x32_bf16 v[32:35], v[224:227], v[208:211], v[32:35]
    ds_read_b128 v[172:175], v5 offset:9216
    v_mfma_f32_16x16x32_bf16 v[28:31], v[220:223], v[208:211], v[28:31]
    s_waitcnt vmcnt(1)
    v_mfma_f32_16x16x32_bf16 v[48:51], v[220:223], v[212:215], v[48:51]
    ds_read_b128 v[176:179], v5 offset:10240
    v_mfma_f32_16x16x32_bf16 v[52:55], v[224:227], v[212:215], v[52:55]
    v_mfma_f32_16x16x32_bf16 v[56:59], v[228:231], v[212:215], v[56:59]
    ds_read_b128 v[180:183], v5 offset:11264
    v_mfma_f32_16x16x32_bf16 v[60:63], v[232:235], v[212:215], v[60:63]
    v_mfma_f32_16x16x32_bf16 v[64:67], v[236:239], v[212:215], v[64:67]
    ds_read_b128 v[184:187], v5 offset:12288
    s_waitcnt vmcnt(0)
    v_mfma_f32_16x16x32_bf16 v[84:87], v[236:239], v[216:219], v[84:87]
    v_mfma_f32_16x16x32_bf16 v[80:83], v[232:235], v[216:219], v[80:83]
    ds_read_b128 v[188:191], v5 offset:13312
    v_mfma_f32_16x16x32_bf16 v[76:79], v[228:231], v[216:219], v[76:79]
    v_mfma_f32_16x16x32_bf16 v[72:75], v[224:227], v[216:219], v[72:75]
    ds_read_b128 v[192:195], v5 offset:14336
    v_mfma_f32_16x16x32_bf16 v[68:71], v[220:223], v[216:219], v[68:71]
    ds_read_b128 v[196:199], v5 offset:15360
    ds_read_b128 v[200:203], v5 offset:16384
    ds_read_b128 v[204:207], v5 offset:17408
    ds_read_b128 v[208:211], v5 offset:18432
    ds_read_b128 v[212:215], v5 offset:19456
    ds_read_b128 v[216:219], v5 offset:20480
    ds_read_b128 v[220:223], v5 offset:21504
    ds_read_b128 v[224:227], v5 offset:22528
    ds_read_b128 v[228:231], v5 offset:23552
    ds_read_b128 v[232:235], v5 offset:24576
    s_setprio 0
    s_mov_b32 s75, 0
L_aw_23:
    ds_read_b32 v93, v3 offset:96
    s_add_u32 s75, s75, 1
    s_cmp_gt_u32 s75, 4000000
    s_waitcnt lgkmcnt(0)
    s_cbranch_scc1 L_awd_24
    v_readfirstlane_b32 s74, v93
    s_cmp_lt_u32 s74, 1
    s_cbranch_scc1 L_aw_23
L_awd_24:
    s_setprio 2
    buffer_load_dwordx4 v[96:99], v2, s[16:19], s40 offen offset:0 sc1
    buffer_load_dwordx4 v[100:103], v2, s[16:19], s40 offen offset:1024 sc1
    buffer_load_dwordx4 v[104:107], v2, s[16:19], s40 offen offset:2048 sc1
    buffer_load_dwordx4 v[108:111], v2, s[16:19], s40 offen offset:3072 sc1
    buffer_load_dwordx2 v[112:113], v4, s[16:19], s41 offen offset:0 sc1
    buffer_load_dwordx2 v[114:115], v4, s[16:19], s41 offen offset:128 sc1
    s_add_u32 s40, s40, 20480
    s_add_u32 s41, s41, 20480
    buffer_load_dwordx4 v[116:119], v2, s[16:19], s40 offen offset:0 sc1
    buffer_load_dwordx4 v[120:123], v2, s[16:19], s40 offen offset:1024 sc1
    buffer_load_dwordx4 v[124:127], v2, s[16:19], s40 offen offset:2048 sc1
    buffer_load_dwordx4 v[128:131], v2, s[16:19], s40 offen offset:3072 sc1
    buffer_load_dwordx2 v[132:133], v4, s[16:19], s41 offen offset:0 sc1
    buffer_load_dwordx2 v[134:135], v4, s[16:19], s41 offen offset:128 sc1
    s_add_u32 s40, s40, 20480
    s_add_u32 s41, s41, 20480
    s_branch L_omerge
L_vspin_21_s:
    s_mov_b32 s75, 0
L_vspin_21:
    buffer_load_dword v87, v86, s[28:31], 0 offen sc1
    s_add_u32 s75, s75, 1
    s_cmp_gt_u32 s75, 200000
    s_waitcnt vmcnt(0)
    s_cbranch_scc1 L_vspun_22
    v_cmp_gt_u32 vcc, 16, v87
    s_cbranch_vccnz L_vspin_21
    s_branch L_vspun_22
L_qwave:
    v_min_u32 v126, 59, v0
    s_mul_i32 s66, s2, 7680
    v_lshl_add_u32 v182, v126, 7, s66
    s_waitcnt lgkmcnt(0)
    s_and_b32 s66, s2, 7
    s_lshr_b32 s68, s2, 6
    s_lshl2_add_u32 s56, s66, s68
    s_lshr_b32 s69, s66, 1
    s_lshl3_add_u32 s57, s69, s55
    s_and_b32 s69, s66, 1
    s_lshl2_add_u32 s58, s69, s68
    s_mov_b32 s14, 1966080
    s_mov_b32 s18, 20971520
    s_mov_b32 s26, 2621440
    s_mov_b32 s30, 256
    s_mov_b32 s15, 0x20000
    s_mov_b32 s19, 0x20000
    s_mov_b32 s23, 0x20000
    s_mov_b32 s27, 0x20000
    s_mov_b32 s31, 0x20000
    s_mov_b64 s[12:13], s[40:41]
    s_mov_b64 s[16:17], s[50:51]
    s_mov_b64 s[24:25], s[46:47]
    s_mov_b64 s[28:29], s[48:49]
    s_mov_b32 s3, 1
    s_mov_b32 s70, 0x76543210
    s_mov_b32 s71, 0xfedcba98
    s_lshl_b32 s69, s54, 2
    s_lshr_b64 s[70:71], s[70:71], s69
    s_and_b32 s35, s70, 15
    v_min_u32 v7, 1, v0
    v_lshlrev_b32 v7, 18, v7
    v_add_u32 v7, 163712, v7
    v_mov_b32 v1, 1
    v_lshlrev_b32 v2, 4, v0
    v_mov_b32 v3, 0
    v_lshlrev_b32 v8, 2, v0
    v_and_b32 v8, 0x7f, v8
    v_add_u32 v8, 163712, v8
    ds_write_b32 v8, v3
    s_cmp_lg_u32 s52, 3
    s_cbranch_scc1 L_notlb2
    v_lshlrev_b32 v9, 21, v0
    s_mov_b64 exec, 0x3ff
    buffer_load_dword v184, v9, s[16:19], 0 offen
    buffer_load_dword v184, v9, s[24:27], 0 offen
    buffer_load_dword v184, v9, s[12:15], 0 offen
    s_mov_b64 exec, -1
L_notlb2:
    s_lshl_b32 s66, s59, 8
    s_add_u32 s66, s66, s2
    s_lshr_b32 s68, s2, 2
    s_and_b32 s69, s2, 3
    s_lshl_b32 s70, s59, 6
    s_add_u32 s70, s70, s68
    s_add_u32 s71, s70, 512
    s_add_u32 s70, s70, 384
    s_cmp_eq_u32 s69, 0
    s_cselect_b32 s71, s71, 1000
    s_cmp_eq_u32 s69, 3
    s_cselect_b32 s71, s70, s71
    s_cmp_lt_u32 s59, 2
    s_cselect_b32 s66, s66, s71
    s_mul_hi_u32 s67, s66, 0x1999999a
    s_mul_i32 s68, s67, 10
    s_sub_u32 s65, s66, s68
    s_mov_b64 s[20:21], s[42:43]
    s_mov_b32 s22, 1966080
    s_lshl_b32 s68, s67, 5
    s_mov_b32 s69, 16
    s_mov_b32 s70, 4
    s_mov_b32 s71, 8
    s_cmp_lt_u32 s67, 48
    s_cbranch_scc1 L_rl0
    s_mov_b64 s[20:21], s[36:37]
    s_mov_b32 s22, 819200
    s_sub_u32 s68, s67, 48
    s_mul_hi_u32 s72, s68, 0x33333334
    s_mul_i32 s73, s72, 5
    s_sub_u32 s73, s68, s73
    s_sub_u32 s68, s68, s72
    s_mul_i32 s68, s68, 40
    s_mov_b32 s69, 8
    s_mov_b32 s70, 4
    s_mov_b32 s71, 20
    s_cmp_lt_u32 s73, 4
    s_cbranch_scc1 L_rl0
    s_mul_i32 s68, s72, 160
    s_add_u32 s68, s68, 16
    s_mov_b32 s69, 20
    s_mov_b32 s70, 40
    s_mov_b32 s71, 80
L_rl0:
    s_mul_i32 s68, s68, 1280
    s_lshl_b32 s72, s65, 7
    s_add_u32 s60, s68, s72
    s_mul_i32 s70, s70, 1280
    s_mul_i32 s71, s71, 1280
    s_add_u32 s61, s60, s70
    s_add_u32 s62, s60, s71
    s_add_u32 s63, s62, s70
    s_mul_i32 s64, s67, 5120
    s_add_u32 s64, s64, 16777216
    s_cmp_lt_u32 s67, 68
    s_cselect_b32 s64, s64, 1073741824
    s_cselect_b32 s22, s22, 0
    v_bfe_u32 v126, v0, 3, 2
    v_lshrrev_b32 v127, 5, v0
    v_mad_u32_u24 v126, v127, s69, v126
    v_mul_u32_u24 v126, 1280, v126
    v_and_b32 v127, 7, v0
    v_lshl_add_u32 v5, v127, 4, v126
    v_lshrrev_b32 v126, 4, v0
    v_bfe_u32 v127, v0, 2, 2
    v_lshl_add_u32 v126, v126, 3, v127
    v_and_b32 v127, 3, v0
    v_lshlrev_b32 v127, 3, v127
    v_lshl_add_u32 v126, v126, 7, v127
    s_lshl_b32 s66, s59, 12
    s_add_u32 s66, s66, 122880
    v_add_u32 v6, s66, v126
    v_add_u32 v126, 0, v0
    v_mul_u32_u24 v127, 0xaaab, v126
    v_lshrrev_b32 v127, 19, v127
    v_mul_u32_u24 v128, 2880, v127
    v_lshrrev_b32 v126, 3, v127
    v_lshlrev_b32 v126, 1, v126
    v_xor_b32 v126, v0, v126
    v_lshl_add_u32 v157, v126, 4, v128
    v_add_u32 v126, 64, v0
    v_mul_u32_u24 v127, 0xaaab, v126
    v_lshrrev_b32 v127, 19, v127
    v_mul_u32_u24 v128, 2880, v127
    v_lshrrev_b32 v126, 3, v127
    v_lshlrev_b32 v126, 1, v126
    v_xor_b32 v126, v0, v126
    v_lshl_add_u32 v158, v126, 4, v128
    v_add_u32 v126, 128, v0
    v_mul_u32_u24 v127, 0xaaab, v126
    v_lshrrev_b32 v127, 19, v127
    v_mul_u32_u24 v128, 2880, v127
    v_lshrrev_b32 v126, 3, v127
    v_lshlrev_b32 v126, 1, v126
    v_xor_b32 v126, v0, v126
    v_lshl_add_u32 v159, v126, 4, v128
    s_mul_i32 s96, s59, 98304
    s_mul_i32 s66, s35, 192
    s_add_u32 s96, s96, s66
    s_mul_i32 s97, s59, 6144
    s_add_u32 s66, s53, s54
    s_and_b32 s66, s66, 1
    s_mul_i32 s66, s66, 5
    s_lshr_b32 s67, s2, 2
    s_xor_b32 s67, s67, s2
    s_bitcmp1_b32 s67, 0
    s_cselect_b32 s67, 3, 0
    s_add_u32 s66, s66, s67
    s_mul_i32 s66, s66, 196608
    s_add_u32 s96, s96, s66
    v_add_u32 v126, 0, v0
    v_mul_u32_u24 v127, 0xcccd, v126
    v_lshrrev_b32 v127, 20, v127
    v_mul_u32_u24 v127, 9920, v127
    v_lshl_add_u32 v168, v0, 4, v127
    v_add_u32 v126, 64, v0
    v_mul_u32_u24 v127, 0xcccd, v126
    v_lshrrev_b32 v127, 20, v127
    v_mul_u32_u24 v127, 9920, v127
    v_lshl_add_u32 v169, v0, 4, v127
    v_add_u32 v126, 128, v0
    v_mul_u32_u24 v127, 0xcccd, v126
    v_lshrrev_b32 v127, 20, v127
    v_mul_u32_u24 v127, 9920, v127
    v_lshl_add_u32 v170, v0, 4, v127
    s_lshr_b32 s66, s56, 1
    s_mul_i32 s66, s66, 5
    s_add_u32 s37, s66, 2
    s_and_b32 s67, s56, 1
    s_mul_i32 s67, s67, 3
    s_add_u32 s36, s66, s67
    s_lshl_b32 s36, s36, 11
    s_lshl_b32 s37, s37, 11
    s_lshl2_add_u32 s66, s55, s59
    s_lshr_b32 s67, s66, 1
    s_mul_i32 s67, s67, 325632
    s_lshl_b32 s38, s66, 10
    s_add_u32 s38, s38, s67
    s_sub_u32 s39, s38, 491520
    s_mul_i32 s40, s66, 81920
    s_mul_i32 s67, s56, 320
    s_add_u32 s40, s40, s67
    s_add_u32 s40, s40, 5242880
    s_sub_u32 s41, s40, 327680
    s_cmp_eq_u32 s55, 0
    s_cselect_b32 s39, 1073741824, s39
    s_cselect_b32 s41, 1073741824, s41
    s_cselect_b32 s46, 6, 10
    s_mul_i32 s42, s66, 81920
    s_add_u32 s42, s42, 14155776
    s_lshl1_add_u32 s78, s66, 1
    s_lshl_b32 s43, s66, 8
    s_add_u32 s43, s43, 19562496
    v_and_b32 v126, 31, v0
    v_lshlrev_b32 v178, 2, v126
    v_lshlrev_b32 v176, 8, v0
    v_add_u32 v176, 20160512, v176
    s_lshl_b32 s45, s59, 10
    s_mul_i32 s44, s58, 348160
    s_add_u32 s44, s44, s45
    s_add_u32 s6, 0, 20160512
    s_add_u32 s6, s50, s6
    s_addc_u32 s7, s51, 0
    s_mov_b32 s8, 64
    v_mov_b32 v177, 0
    s_bitcmp1_b32 0x2081040, s56
    s_cselect_b32 s67, 1, 0
    s_lshl_b32 s46, s46, s67
    s_add_u32 s46, s46, 2
    s_lshl_b32 s67, s55, 5
    s_add_u32 s67, s67, s56
    s_lshl_b32 s67, s67, 8
    s_add_u32 s32, s67, 19570688
    s_add_u32 s32, s50, s32
    s_addc_u32 s33, s51, 0
    s_mul_hi_u32 s66, s54, 0x33333334
    s_mul_i32 s67, s66, 5
    s_sub_u32 s47, s54, s67
    s_lshl_b32 s69, s47, 5
    s_mul_hi_u32 s69, s69, 0x33333334
    s_lshr_b32 s66, s53, 1
    s_lshl_b32 s66, s66, 5
    s_add_u32 s66, s66, s69
    s_lshl_b32 s66, s66, 8
    s_add_u32 s4, s66, 19570688
    s_add_u32 s4, s50, s4
    s_addc_u32 s5, s51, 0
    v_and_b32 v126, 31, v0
    v_lshrrev_b32 v127, 5, v0
    s_lshl_b32 s66, s59, 10
    v_lshl_add_u32 v128, v126, 4, s66
    v_lshl_add_u32 v160, v127, 13, v128
    v_add_u32 v160, 118656, v160
    s_and_b32 s67, s56, 1
    s_lshl_b32 s67, s67, 3
    s_add_u32 s66, s67, 135040
    v_add_u32 v161, s66, v128
    v_lshlrev_b32 v128, 4, v126
    v_lshl_add_u32 v174, v127, 11, v128
    v_lshl_add_u32 v175, v127, 30, v128
    v_add_u32 v175, s67, v175
    s_mul_i32 s66, s59, 2560
    s_add_u32 s66, s66, 143232
    v_mul_u32_u24 v162, 320, v127
    v_add3_u32 v162, v162, v128, s66
    v_bfe_u32 v128, v0, 4, 1
    v_mul_u32_u24 v128, 20480, v128
    v_and_b32 v129, 15, v0
    v_lshl_add_u32 v164, v129, 3, v128
    v_lshl_add_u32 v163, v129, 4, v128
    v_lshl_add_u32 v163, v127, 8, v163
    v_lshl_add_u32 v164, v127, 30, v164
    v_lshlrev_b32 v127, 2, v127
    v_sub_u32 v127, v126, v127
    v_mov_b32 v128, 0xff800000
    v_cmp_le_i32 s[66:67], 0, v127
    v_cmp_le_i32 s[68:69], 1, v127
    v_cmp_le_i32 s[70:71], 2, v127
    v_cmp_le_i32 s[72:73], 3, v127
    v_cndmask_b32 v192, v128, v3, s[66:67]
    v_cndmask_b32 v208, v3, v128, s[66:67]
    v_cndmask_b32 v193, v128, v3, s[68:69]
    v_cndmask_b32 v209, v3, v128, s[68:69]
    v_cndmask_b32 v194, v128, v3, s[70:71]
    v_cndmask_b32 v210, v3, v128, s[70:71]
    v_cndmask_b32 v195, v128, v3, s[72:73]
    v_cndmask_b32 v211, v3, v128, s[72:73]
    v_cmp_le_i32 s[66:67], 8, v127
    v_cmp_le_i32 s[68:69], 9, v127
    v_cmp_le_i32 s[70:71], 10, v127
    v_cmp_le_i32 s[72:73], 11, v127
    v_cndmask_b32 v196, v128, v3, s[66:67]
    v_cndmask_b32 v212, v3, v128, s[66:67]
    v_cndmask_b32 v197, v128, v3, s[68:69]
    v_cndmask_b32 v213, v3, v128, s[68:69]
    v_cndmask_b32 v198, v128, v3, s[70:71]
    v_cndmask_b32 v214, v3, v128, s[70:71]
    v_cndmask_b32 v199, v128, v3, s[72:73]
    v_cndmask_b32 v215, v3, v128, s[72:73]
    v_cmp_le_i32 s[66:67], 16, v127
    v_cmp_le_i32 s[68:69], 17, v127
    v_cmp_le_i32 s[70:71], 18, v127
    v_cmp_le_i32 s[72:73], 19, v127
    v_cndmask_b32 v200, v128, v3, s[66:67]
    v_cndmask_b32 v216, v3, v128, s[66:67]
    v_cndmask_b32 v201, v128, v3, s[68:69]
    v_cndmask_b32 v217, v3, v128, s[68:69]
    v_cndmask_b32 v202, v128, v3, s[70:71]
    v_cndmask_b32 v218, v3, v128, s[70:71]
    v_cndmask_b32 v203, v128, v3, s[72:73]
    v_cndmask_b32 v219, v3, v128, s[72:73]
    v_cmp_le_i32 s[66:67], 24, v127
    v_cmp_le_i32 s[68:69], 25, v127
    v_cmp_le_i32 s[70:71], 26, v127
    v_cmp_le_i32 s[72:73], 27, v127
    v_cndmask_b32 v204, v128, v3, s[66:67]
    v_cndmask_b32 v220, v3, v128, s[66:67]
    v_cndmask_b32 v205, v128, v3, s[68:69]
    v_cndmask_b32 v221, v3, v128, s[68:69]
    v_cndmask_b32 v206, v128, v3, s[70:71]
    v_cndmask_b32 v222, v3, v128, s[70:71]
    v_cndmask_b32 v207, v128, v3, s[72:73]
    v_cndmask_b32 v223, v3, v128, s[72:73]
    v_and_b32 v127, 27, v0
    v_cmp_eq_u32 vcc, 24, v127
    v_mov_b32 v128, 0x3f803f80
    s_mov_b32 s76, 0xfffff
    s_mov_b32 s77, 0xfffff
    v_cndmask_b32 v224, v3, v128, vcc
    v_cndmask_b32 v225, v3, v128, vcc
    v_cndmask_b32 v226, v3, v128, vcc
    v_cndmask_b32 v227, v3, v128, vcc
    v_cndmask_b32 v228, v3, v128, vcc
    v_cndmask_b32 v229, v3, v128, vcc
    v_cndmask_b32 v230, v3, v128, vcc
    v_cndmask_b32 v231, v3, v128, vcc
    v_cndmask_b32 v232, v3, v128, vcc
    v_cndmask_b32 v233, v3, v128, vcc
    v_cndmask_b32 v234, v3, v128, vcc
    v_cndmask_b32 v235, v3, v128, vcc
    v_cndmask_b32 v236, v3, v128, vcc
    v_cndmask_b32 v237, v3, v128, vcc
    v_cndmask_b32 v238, v3, v128, vcc
    v_cndmask_b32 v239, v3, v128, vcc
    s_cmp_eq_u32 s54, 15
    s_cbranch_scc1 L_qg
    s_cmp_ge_u32 s54, 10
    s_cbranch_scc1 L_qv
    s_and_b32 s66, s52, 1
    s_lshl_b32 s66, s66, 13
    v_and_b32 v126, 15, v0
    v_lshrrev_b32 v127, 1, v126
    v_lshrrev_b32 v128, 4, v0
    v_xor_b32 v127, v127, v128
    v_lshl_add_u32 v126, v126, 7, s66
    v_lshl_add_u32 v152, v127, 4, v126
    v_xor_b32 v153, 64, v152
    v_add_u32 v154, 0x10000, v152
    v_add_u32 v155, 0x10000, v153
    v_bfe_u32 v126, v0, 2, 2
    v_lshl_add_u32 v127, v128, 3, v126
    v_and_b32 v128, 1, v128
    v_lshl_add_u32 v126, v126, 1, v128
    s_and_b32 s66, s52, 2
    s_lshl_b32 s66, s66, 1
    v_xor_b32 v126, s66, v126
    v_lshlrev_b32 v126, 5, v126
    v_lshl_add_u32 v126, v127, 8, v126
    v_and_b32 v127, 3, v0
    v_lshl_add_u32 v240, v127, 3, v126
    v_xor_b32 v241, 32, v240
    v_xor_b32 v242, 64, v240
    v_xor_b32 v243, 96, v240
    v_add_u32 v244, 0x10000, v240
    v_add_u32 v245, 0x10000, v241
    v_add_u32 v246, 0x10000, v242
    v_add_u32 v247, 0x10000, v243
    v_lshrrev_b32 v126, 5, v0
    v_mul_u32_u24 v126, 2048, v126
    v_and_b32 v127, 31, v0
    v_lshl_add_u32 v156, v127, 4, v126
    s_and_b32 s66, s52, 1
    s_lshr_b32 s67, s52, 1
    s_lshl1_add_u32 s66, s53, s66
    s_lshl1_add_u32 s67, s54, s67
    s_lshl_b32 s67, s67, 14
    s_lshl_b32 s66, s66, 10
    s_add_u32 s72, s66, s67
    s_mul_i32 s66, s53, 325632
    s_add_u32 s72, s72, s66
    s_cmp_lt_u32 s54, 5
    s_cselect_b32 s73, 0x3ea52b5c, 1.0
    s_waitcnt lgkmcnt(0)
    s_barrier
    ds_read_b128 v[72:75], v152 offset:0
    ds_read_b64_tr_b16 v[88:89], v240 offset:16384
    ds_read_b64_tr_b16 v[90:91], v240 offset:17408
    ds_read_b64_tr_b16 v[92:93], v241 offset:16384
    ds_read_b64_tr_b16 v[94:95], v241 offset:17408
    ds_read_b64_tr_b16 v[96:97], v242 offset:16384
    ds_read_b64_tr_b16 v[98:99], v242 offset:17408
    ds_read_b64_tr_b16 v[100:101], v243 offset:16384
    ds_read_b64_tr_b16 v[102:103], v243 offset:17408
    ds_read_b128 v[76:79], v152 offset:2048
    ds_read_b128 v[80:83], v152 offset:4096
    ds_read_b128 v[84:87], v152 offset:6144
    s_waitcnt lgkmcnt(9)
    v_mfma_f32_16x16x32_bf16 v[8:11], v[88:91], v[72:75], 0
    ds_read_b128 v[104:107], v153 offset:0
    s_waitcnt lgkmcnt(8)
    v_mfma_f32_16x16x32_bf16 v[12:15], v[92:95], v[72:75], 0
    ds_read_b64_tr_b16 v[120:121], v240 offset:24576
    s_waitcnt lgkmcnt(7)
    v_mfma_f32_16x16x32_bf16 v[16:19], v[96:99], v[72:75], 0
    ds_read_b64_tr_b16 v[122:123], v240 offset:25600
    s_waitcnt lgkmcnt(6)
    v_mfma_f32_16x16x32_bf16 v[20:23], v[100:103], v[72:75], 0
    ds_read_b64_tr_b16 v[124:125], v241 offset:24576
    s_waitcnt lgkmcnt(6)
    v_mfma_f32_16x16x32_bf16 v[36:39], v[100:103], v[76:79], 0
    ds_read_b64_tr_b16 v[126:127], v241 offset:25600
    v_mfma_f32_16x16x32_bf16 v[32:35], v[96:99], v[76:79], 0
    ds_read_b64_tr_b16 v[128:129], v242 offset:24576
    v_mfma_f32_16x16x32_bf16 v[28:31], v[92:95], v[76:79], 0
    ds_read_b64_tr_b16 v[130:131], v242 offset:25600
    v_mfma_f32_16x16x32_bf16 v[24:27], v[88:91], v[76:79], 0
    ds_read_b64_tr_b16 v[132:133], v243 offset:24576
    s_waitcnt lgkmcnt(9)
    v_mfma_f32_16x16x32_bf16 v[40:43], v[88:91], v[80:83], 0
    ds_read_b64_tr_b16 v[134:135], v243 offset:25600
    v_mfma_f32_16x16x32_bf16 v[44:47], v[92:95], v[80:83], 0
    ds_read_b128 v[108:111], v153 offset:2048
    v_mfma_f32_16x16x32_bf16 v[48:51], v[96:99], v[80:83], 0
    ds_read_b128 v[112:115], v153 offset:4096
    v_mfma_f32_16x16x32_bf16 v[52:55], v[100:103], v[80:83], 0
    ds_read_b128 v[116:119], v153 offset:6144
    s_waitcnt lgkmcnt(12)
    v_mfma_f32_16x16x32_bf16 v[68:71], v[100:103], v[84:87], 0
    s_lshl_b32 s66, s59, 12
    s_add_u32 m0, s66, 122880
    s_nop 0
    buffer_load_dwordx4 v5, s[20:23], s60 offen  lds
    s_add_u32 m0, s66, 123904
    s_nop 0
    buffer_load_dwordx4 v5, s[20:23], s61 offen  lds
    s_add_u32 m0, s66, 124928
    s_nop 0
    buffer_load_dwordx4 v5, s[20:23], s62 offen  lds
    s_add_u32 m0, s66, 125952
    s_nop 0
    buffer_load_dwordx4 v5, s[20:23], s63 offen  lds
    v_mfma_f32_16x16x32_bf16 v[64:67], v[96:99], v[84:87], 0
    v_mfma_f32_16x16x32_bf16 v[60:63], v[92:95], v[84:87], 0
    v_mfma_f32_16x16x32_bf16 v[56:59], v[88:91], v[84:87], 0
    s_waitcnt lgkmcnt(3)
    v_mfma_f32_16x16x32_bf16 v[8:11], v[120:123], v[104:107], v[8:11]
    v_mfma_f32_16x16x32_bf16 v[12:15], v[124:127], v[104:107], v[12:15]
    v_mfma_f32_16x16x32_bf16 v[16:19], v[128:131], v[104:107], v[16:19]
    s_waitcnt lgkmcnt(0)
    s_barrier
    ds_read_b128 v[72:75], v152 offset:32768
    v_mfma_f32_16x16x32_bf16 v[20:23], v[132:135], v[104:107], v[20:23]
    ds_read_b64_tr_b16 v[88:89], v240 offset:49152
    v_mfma_f32_16x16x32_bf16 v[36:39], v[132:135], v[108:111], v[36:39]
    ds_read_b64_tr_b16 v[90:91], v240 offset:50176
    v_mfma_f32_16x16x32_bf16 v[32:35], v[128:131], v[108:111], v[32:35]
    ds_read_b64_tr_b16 v[92:93], v241 offset:49152
    v_mfma_f32_16x16x32_bf16 v[28:31], v[124:127], v[108:111], v[28:31]
    ds_read_b64_tr_b16 v[94:95], v241 offset:50176
    v_mfma_f32_16x16x32_bf16 v[24:27], v[120:123], v[108:111], v[24:27]
    ds_read_b64_tr_b16 v[96:97], v242 offset:49152
    v_mfma_f32_16x16x32_bf16 v[40:43], v[120:123], v[112:115], v[40:43]
    ds_read_b64_tr_b16 v[98:99], v242 offset:50176
    v_mfma_f32_16x16x32_bf16 v[44:47], v[124:127], v[112:115], v[44:47]
    ds_read_b64_tr_b16 v[100:101], v243 offset:49152
    v_mfma_f32_16x16x32_bf16 v[48:51], v[128:131], v[112:115], v[48:51]
    ds_read_b64_tr_b16 v[102:103], v243 offset:50176
    v_mfma_f32_16x16x32_bf16 v[52:55], v[132:135], v[112:115], v[52:55]
    ds_read_b128 v[76:79], v152 offset:34816
    v_mfma_f32_16x16x32_bf16 v[68:71], v[132:135], v[116:119], v[68:71]
    ds_read_b128 v[80:83], v152 offset:36864
    v_mfma_f32_16x16x32_bf16 v[64:67], v[128:131], v[116:119], v[64:67]
    ds_read_b128 v[84:87], v152 offset:38912
    v_mfma_f32_16x16x32_bf16 v[60:63], v[124:127], v[116:119], v[60:63]
    v_mfma_f32_16x16x32_bf16 v[56:59], v[120:123], v[116:119], v[56:59]
    s_waitcnt lgkmcnt(3)
    v_mfma_f32_16x16x32_bf16 v[8:11], v[88:91], v[72:75], v[8:11]
    ds_read_b128 v[104:107], v153 offset:32768
    v_mfma_f32_16x16x32_bf16 v[12:15], v[92:95], v[72:75], v[12:15]
    ds_read_b64_tr_b16 v[120:121], v240 offset:57344
    v_mfma_f32_16x16x32_bf16 v[16:19], v[96:99], v[72:75], v[16:19]
    ds_read_b64_tr_b16 v[122:123], v240 offset:58368
    v_mfma_f32_16x16x32_bf16 v[20:23], v[100:103], v[72:75], v[20:23]
    s_waitcnt lgkmcnt(3)
    ds_read_b64_tr_b16 v[124:125], v241 offset:57344
    v_mfma_f32_16x16x32_bf16 v[36:39], v[100:103], v[76:79], v[36:39]
    ds_read_b64_tr_b16 v[126:127], v241 offset:58368
    v_mfma_f32_16x16x32_bf16 v[32:35], v[96:99], v[76:79], v[32:35]
    ds_read_b64_tr_b16 v[128:129], v242 offset:57344
    v_mfma_f32_16x16x32_bf16 v[28:31], v[92:95], v[76:79], v[28:31]
    ds_read_b64_tr_b16 v[130:131], v242 offset:58368
    v_mfma_f32_16x16x32_bf16 v[24:27], v[88:91], v[76:79], v[24:27]
    ds_read_b64_tr_b16 v[132:133], v243 offset:57344
    v_mfma_f32_16x16x32_bf16 v[40:43], v[88:91], v[80:83], v[40:43]
    ds_read_b64_tr_b16 v[134:135], v243 offset:58368
    v_mfma_f32_16x16x32_bf16 v[44:47], v[92:95], v[80:83], v[44:47]
    ds_read_b128 v[108:111], v153 offset:34816
    v_mfma_f32_16x16x32_bf16 v[48:51], v[96:99], v[80:83], v[48:51]
    ds_read_b128 v[112:115], v153 offset:36864
    v_mfma_f32_16x16x32_bf16 v[52:55], v[100:103], v[80:83], v[52:55]
    ds_read_b128 v[116:119], v153 offset:38912
    v_mfma_f32_16x16x32_bf16 v[68:71], v[100:103], v[84:87], v[68:71]
    v_mfma_f32_16x16x32_bf16 v[64:67], v[96:99], v[84:87], v[64:67]
    v_mfma_f32_16x16x32_bf16 v[60:63], v[92:95], v[84:87], v[60:63]
    v_mfma_f32_16x16x32_bf16 v[56:59], v[88:91], v[84:87], v[56:59]
    s_waitcnt lgkmcnt(3)
    v_mfma_f32_16x16x32_bf16 v[8:11], v[120:123], v[104:107], v[8:11]
    v_mfma_f32_16x16x32_bf16 v[12:15], v[124:127], v[104:107], v[12:15]
    v_mfma_f32_16x16x32_bf16 v[16:19], v[128:131], v[104:107], v[16:19]
    s_waitcnt lgkmcnt(0)
    s_barrier
    ds_read_b128 v[72:75], v154 offset:0
    v_mfma_f32_16x16x32_bf16 v[20:23], v[132:135], v[104:107], v[20:23]
    ds_read_b64_tr_b16 v[88:89], v244 offset:16384
    v_mfma_f32_16x16x32_bf16 v[36:39], v[132:135], v[108:111], v[36:39]
    ds_read_b64_tr_b16 v[90:91], v244 offset:17408
    v_mfma_f32_16x16x32_bf16 v[32:35], v[128:131], v[108:111], v[32:35]
    ds_read_b64_tr_b16 v[92:93], v245 offset:16384
    v_mfma_f32_16x16x32_bf16 v[28:31], v[124:127], v[108:111], v[28:31]
    ds_read_b64_tr_b16 v[94:95], v245 offset:17408
    v_mfma_f32_16x16x32_bf16 v[24:27], v[120:123], v[108:111], v[24:27]
    ds_read_b64_tr_b16 v[96:97], v246 offset:16384
    v_mfma_f32_16x16x32_bf16 v[40:43], v[120:123], v[112:115], v[40:43]
    ds_read_b64_tr_b16 v[98:99], v246 offset:17408
    v_mfma_f32_16x16x32_bf16 v[44:47], v[124:127], v[112:115], v[44:47]
    ds_read_b64_tr_b16 v[100:101], v247 offset:16384
    v_mfma_f32_16x16x32_bf16 v[48:51], v[128:131], v[112:115], v[48:51]
    ds_read_b64_tr_b16 v[102:103], v247 offset:17408
    v_mfma_f32_16x16x32_bf16 v[52:55], v[132:135], v[112:115], v[52:55]
    ds_read_b128 v[76:79], v154 offset:2048
    v_mfma_f32_16x16x32_bf16 v[68:71], v[132:135], v[116:119], v[68:71]
    ds_read_b128 v[80:83], v154 offset:4096
    v_mfma_f32_16x16x32_bf16 v[64:67], v[128:131], v[116:119], v[64:67]
    ds_read_b128 v[84:87], v154 offset:6144
    v_mfma_f32_16x16x32_bf16 v[60:63], v[124:127], v[116:119], v[60:63]
    v_mfma_f32_16x16x32_bf16 v[56:59], v[120:123], v[116:119], v[56:59]
    s_waitcnt lgkmcnt(3)
    v_mfma_f32_16x16x32_bf16 v[8:11], v[88:91], v[72:75], v[8:11]
    ds_read_b128 v[104:107], v155 offset:0
    v_mfma_f32_16x16x32_bf16 v[12:15], v[92:95], v[72:75], v[12:15]
    ds_read_b64_tr_b16 v[120:121], v244 offset:24576
    v_mfma_f32_16x16x32_bf16 v[16:19], v[96:99], v[72:75], v[16:19]
    ds_read_b64_tr_b16 v[122:123], v244 offset:25600
    v_mfma_f32_16x16x32_bf16 v[20:23], v[100:103], v[72:75], v[20:23]
    s_waitcnt lgkmcnt(3)
    ds_read_b64_tr_b16 v[124:125], v245 offset:24576
    v_mfma_f32_16x16x32_bf16 v[36:39], v[100:103], v[76:79], v[36:39]
    ds_read_b64_tr_b16 v[126:127], v245 offset:25600
    v_mfma_f32_16x16x32_bf16 v[32:35], v[96:99], v[76:79], v[32:35]
    ds_read_b64_tr_b16 v[128:129], v246 offset:24576
    v_mfma_f32_16x16x32_bf16 v[28:31], v[92:95], v[76:79], v[28:31]
    ds_read_b64_tr_b16 v[130:131], v246 offset:25600
    v_mfma_f32_16x16x32_bf16 v[24:27], v[88:91], v[76:79], v[24:27]
    ds_read_b64_tr_b16 v[132:133], v247 offset:24576
    v_mfma_f32_16x16x32_bf16 v[40:43], v[88:91], v[80:83], v[40:43]
    ds_read_b64_tr_b16 v[134:135], v247 offset:25600
    v_mfma_f32_16x16x32_bf16 v[44:47], v[92:95], v[80:83], v[44:47]
    ds_read_b128 v[108:111], v155 offset:2048
    v_mfma_f32_16x16x32_bf16 v[48:51], v[96:99], v[80:83], v[48:51]
    ds_read_b128 v[112:115], v155 offset:4096
    v_mfma_f32_16x16x32_bf16 v[52:55], v[100:103], v[80:83], v[52:55]
    ds_read_b128 v[116:119], v155 offset:6144
    v_mfma_f32_16x16x32_bf16 v[68:71], v[100:103], v[84:87], v[68:71]
    s_cmp_lg_u32 s52, 2
    s_cbranch_scc1 L_tch_25
    buffer_load_dword v184, v182, s[12:15], 0 offen
L_tch_25:
    v_mfma_f32_16x16x32_bf16 v[64:67], v[96:99], v[84:87], v[64:67]
    v_mfma_f32_16x16x32_bf16 v[60:63], v[92:95], v[84:87], v[60:63]
    v_mfma_f32_16x16x32_bf16 v[56:59], v[88:91], v[84:87], v[56:59]
    s_waitcnt lgkmcnt(3)
    v_mfma_f32_16x16x32_bf16 v[8:11], v[120:123], v[104:107], v[8:11]
    v_mfma_f32_16x16x32_bf16 v[12:15], v[124:127], v[104:107], v[12:15]
    v_mfma_f32_16x16x32_bf16 v[16:19], v[128:131], v[104:107], v[16:19]
    s_waitcnt lgkmcnt(0)
    s_barrier
    ds_read_b128 v[72:75], v152 offset:0
    v_mfma_f32_16x16x32_bf16 v[20:23], v[132:135], v[104:107], v[20:23]
    ds_read_b64_tr_b16 v[88:89], v240 offset:16384
    v_mfma_f32_16x16x32_bf16 v[36:39], v[132:135], v[108:111], v[36:39]
    ds_read_b64_tr_b16 v[90:91], v240 offset:17408
    v_mfma_f32_16x16x32_bf16 v[32:35], v[128:131], v[108:111], v[32:35]
    ds_read_b64_tr_b16 v[92:93], v241 offset:16384
    v_mfma_f32_16x16x32_bf16 v[28:31], v[124:127], v[108:111], v[28:31]
    ds_read_b64_tr_b16 v[94:95], v241 offset:17408
    v_mfma_f32_16x16x32_bf16 v[24:27], v[120:123], v[108:111], v[24:27]
    ds_read_b64_tr_b16 v[96:97], v242 offset:16384
    v_mfma_f32_16x16x32_bf16 v[40:43], v[120:123], v[112:115], v[40:43]
    ds_read_b64_tr_b16 v[98:99], v242 offset:17408
    v_mfma_f32_16x16x32_bf16 v[44:47], v[124:127], v[112:115], v[44:47]
    ds_read_b64_tr_b16 v[100:101], v243 offset:16384
    v_mfma_f32_16x16x32_bf16 v[48:51], v[128:131], v[112:115], v[48:51]
    ds_read_b64_tr_b16 v[102:103], v243 offset:17408
    v_mfma_f32_16x16x32_bf16 v[52:55], v[132:135], v[112:115], v[52:55]
    ds_read_b128 v[76:79], v152 offset:2048
    v_mfma_f32_16x16x32_bf16 v[68:71], v[132:135], v[116:119], v[68:71]
    ds_read_b128 v[80:83], v152 offset:4096
    v_mfma_f32_16x16x32_bf16 v[64:67], v[128:131], v[116:119], v[64:67]
    ds_read_b128 v[84:87], v152 offset:6144
    v_mfma_f32_16x16x32_bf16 v[60:63], v[124:127], v[116:119], v[60:63]
    v_mfma_f32_16x16x32_bf16 v[56:59], v[120:123], v[116:119], v[56:59]
    s_waitcnt lgkmcnt(3)
    v_mfma_f32_16x16x32_bf16 v[8:11], v[88:91], v[72:75], v[8:11]
    ds_read_b128 v[104:107], v153 offset:0
    v_mfma_f32_16x16x32_bf16 v[12:15], v[92:95], v[72:75], v[12:15]
    ds_read_b64_tr_b16 v[120:121], v240 offset:24576
    v_mfma_f32_16x16x32_bf16 v[16:19], v[96:99], v[72:75], v[16:19]
    ds_read_b64_tr_b16 v[122:123], v240 offset:25600
    v_mfma_f32_16x16x32_bf16 v[20:23], v[100:103], v[72:75], v[20:23]
    s_waitcnt lgkmcnt(3)
    ds_read_b64_tr_b16 v[124:125], v241 offset:24576
    v_mfma_f32_16x16x32_bf16 v[36:39], v[100:103], v[76:79], v[36:39]
    ds_read_b64_tr_b16 v[126:127], v241 offset:25600
    v_mfma_f32_16x16x32_bf16 v[32:35], v[96:99], v[76:79], v[32:35]
    ds_read_b64_tr_b16 v[128:129], v242 offset:24576
    v_mfma_f32_16x16x32_bf16 v[28:31], v[92:95], v[76:79], v[28:31]
    ds_read_b64_tr_b16 v[130:131], v242 offset:25600
    v_mfma_f32_16x16x32_bf16 v[24:27], v[88:91], v[76:79], v[24:27]
    ds_read_b64_tr_b16 v[132:133], v243 offset:24576
    v_mfma_f32_16x16x32_bf16 v[40:43], v[88:91], v[80:83], v[40:43]
    ds_read_b64_tr_b16 v[134:135], v243 offset:25600
    v_mfma_f32_16x16x32_bf16 v[44:47], v[92:95], v[80:83], v[44:47]
    ds_read_b128 v[108:111], v153 offset:2048
    v_mfma_f32_16x16x32_bf16 v[48:51], v[96:99], v[80:83], v[48:51]
    ds_read_b128 v[112:115], v153 offset:4096
    v_mfma_f32_16x16x32_bf16 v[52:55], v[100:103], v[80:83], v[52:55]
    ds_read_b128 v[116:119], v153 offset:6144
    v_mfma_f32_16x16x32_bf16 v[68:71], v[100:103], v[84:87], v[68:71]
    s_waitcnt vmcnt(0)
    ds_read_b64_tr_b16 v[136:137], v6 offset:0
    ds_read_b64_tr_b16 v[138:139], v6 offset:512
    ds_read_b64_tr_b16 v[140:141], v6 offset:32
    ds_read_b64_tr_b16 v[142:143], v6 offset:544
    ds_read_b64_tr_b16 v[144:145], v6 offset:64
    ds_read_b64_tr_b16 v[146:147], v6 offset:576
    ds_read_b64_tr_b16 v[148:149], v6 offset:96
    ds_read_b64_tr_b16 v[150:151], v6 offset:608
    v_mfma_f32_16x16x32_bf16 v[64:67], v[96:99], v[84:87], v[64:67]
    v_mfma_f32_16x16x32_bf16 v[60:63], v[92:95], v[84:87], v[60:63]
    v_mfma_f32_16x16x32_bf16 v[56:59], v[88:91], v[84:87], v[56:59]
    s_waitcnt lgkmcnt(11)
    s_lshl2_add_u32 s66, s65, 0
    s_mul_hi_u32 s67, s66, 0x33333334
    s_mul_i32 s67, s67, 343040
    s_lshl_b32 s66, s66, 10
    s_add_u32 s66, s66, s67
    s_add_u32 s66, s66, s64
    s_waitcnt lgkmcnt(6)
    buffer_store_dwordx4 v[136:139], v2, s[16:19], s66 offen sc1
    v_mfma_f32_16x16x32_bf16 v[8:11], v[120:123], v[104:107], v[8:11]
    v_mfma_f32_16x16x32_bf16 v[12:15], v[124:127], v[104:107], v[12:15]
    v_mfma_f32_16x16x32_bf16 v[16:19], v[128:131], v[104:107], v[16:19]
    s_waitcnt lgkmcnt(0)
    s_barrier
    ds_read_b128 v[72:75], v152 offset:32768
    v_mfma_f32_16x16x32_bf16 v[20:23], v[132:135], v[104:107], v[20:23]
    ds_read_b64_tr_b16 v[88:89], v240 offset:49152
    v_mfma_f32_16x16x32_bf16 v[36:39], v[132:135], v[108:111], v[36:39]
    ds_read_b64_tr_b16 v[90:91], v240 offset:50176
    v_mfma_f32_16x16x32_bf16 v[32:35], v[128:131], v[108:111], v[32:35]
    ds_read_b64_tr_b16 v[92:93], v241 offset:49152
    v_mfma_f32_16x16x32_bf16 v[28:31], v[124:127], v[108:111], v[28:31]
    ds_read_b64_tr_b16 v[94:95], v241 offset:50176
    v_mfma_f32_16x16x32_bf16 v[24:27], v[120:123], v[108:111], v[24:27]
    ds_read_b64_tr_b16 v[96:97], v242 offset:49152
    v_mfma_f32_16x16x32_bf16 v[40:43], v[120:123], v[112:115], v[40:43]
    ds_read_b64_tr_b16 v[98:99], v242 offset:50176
    v_mfma_f32_16x16x32_bf16 v[44:47], v[124:127], v[112:115], v[44:47]
    ds_read_b64_tr_b16 v[100:101], v243 offset:49152
    v_mfma_f32_16x16x32_bf16 v[48:51], v[128:131], v[112:115], v[48:51]
    ds_read_b64_tr_b16 v[102:103], v243 offset:50176
    v_mfma_f32_16x16x32_bf16 v[52:55], v[132:135], v[112:115], v[52:55]
    ds_read_b128 v[76:79], v152 offset:34816
    v_mfma_f32_16x16x32_bf16 v[68:71], v[132:135], v[116:119], v[68:71]
    ds_read_b128 v[80:83], v152 offset:36864
    s_lshl2_add_u32 s66, s65, 1
    s_mul_hi_u32 s67, s66, 0x33333334
    s_mul_i32 s67, s67, 343040
    s_lshl_b32 s66, s66, 10
    s_add_u32 s66, s66, s67
    s_add_u32 s66, s66, s64
    buffer_store_dwordx4 v[140:143], v2, s[16:19], s66 offen sc1
    v_mfma_f32_16x16x32_bf16 v[64:67], v[128:131], v[116:119], v[64:67]
    ds_read_b128 v[84:87], v152 offset:38912
    v_mfma_f32_16x16x32_bf16 v[60:63], v[124:127], v[116:119], v[60:63]
    v_mfma_f32_16x16x32_bf16 v[56:59], v[120:123], v[116:119], v[56:59]
    s_waitcnt lgkmcnt(3)
    s_lshl2_add_u32 s66, s65, 2
    s_mul_hi_u32 s67, s66, 0x33333334
    s_mul_i32 s67, s67, 343040
    s_lshl_b32 s66, s66, 10
    s_add_u32 s66, s66, s67
    s_add_u32 s66, s66, s64
    buffer_store_dwordx4 v[144:147], v2, s[16:19], s66 offen sc1
    v_mfma_f32_16x16x32_bf16 v[8:11], v[88:91], v[72:75], v[8:11]
    ds_read_b128 v[104:107], v153 offset:32768
    v_mfma_f32_16x16x32_bf16 v[12:15], v[92:95], v[72:75], v[12:15]
    ds_read_b64_tr_b16 v[120:121], v240 offset:57344
    v_mfma_f32_16x16x32_bf16 v[16:19], v[96:99], v[72:75], v[16:19]
    ds_read_b64_tr_b16 v[122:123], v240 offset:58368
    v_mfma_f32_16x16x32_bf16 v[20:23], v[100:103], v[72:75], v[20:23]
    s_waitcnt lgkmcnt(3)
    ds_read_b64_tr_b16 v[124:125], v241 offset:57344
    v_mfma_f32_16x16x32_bf16 v[36:39], v[100:103], v[76:79], v[36:39]
    ds_read_b64_tr_b16 v[126:127], v241 offset:58368
    v_mfma_f32_16x16x32_bf16 v[32:35], v[96:99], v[76:79], v[32:35]
    ds_read_b64_tr_b16 v[128:129], v242 offset:57344
    v_mfma_f32_16x16x32_bf16 v[28:31], v[92:95], v[76:79], v[28:31]
    ds_read_b64_tr_b16 v[130:131], v242 offset:58368
    v_mfma_f32_16x16x32_bf16 v[24:27], v[88:91], v[76:79], v[24:27]
    ds_read_b64_tr_b16 v[132:133], v243 offset:57344
    v_mfma_f32_16x16x32_bf16 v[40:43], v[88:91], v[80:83], v[40:43]
    ds_read_b64_tr_b16 v[134:135], v243 offset:58368
    v_mfma_f32_16x16x32_bf16 v[44:47], v[92:95], v[80:83], v[44:47]
    ds_read_b128 v[108:111], v153 offset:34816
    v_mfma_f32_16x16x32_bf16 v[48:51], v[96:99], v[80:83], v[48:51]
    ds_read_b128 v[112:115], v153 offset:36864
    v_mfma_f32_16x16x32_bf16 v[52:55], v[100:103], v[80:83], v[52:55]
    ds_read_b128 v[116:119], v153 offset:38912
    v_mfma_f32_16x16x32_bf16 v[68:71], v[100:103], v[84:87], v[68:71]
    s_lshl2_add_u32 s66, s65, 3
    s_mul_hi_u32 s67, s66, 0x33333334
    s_mul_i32 s67, s67, 343040
    s_lshl_b32 s66, s66, 10
    s_add_u32 s66, s66, s67
    s_add_u32 s66, s66, s64
    buffer_store_dwordx4 v[148:151], v2, s[16:19], s66 offen sc1
    v_mfma_f32_16x16x32_bf16 v[64:67], v[96:99], v[84:87], v[64:67]
    v_mfma_f32_16x16x32_bf16 v[60:63], v[92:95], v[84:87], v[60:63]
    v_mfma_f32_16x16x32_bf16 v[56:59], v[88:91], v[84:87], v[56:59]
    s_waitcnt lgkmcnt(3)
    v_mfma_f32_16x16x32_bf16 v[8:11], v[120:123], v[104:107], v[8:11]
    v_mfma_f32_16x16x32_bf16 v[12:15], v[124:127], v[104:107], v[12:15]
    v_mfma_f32_16x16x32_bf16 v[16:19], v[128:131], v[104:107], v[16:19]
    s_waitcnt lgkmcnt(0)
    s_barrier
    ds_read_b128 v[72:75], v154 offset:0
    v_mfma_f32_16x16x32_bf16 v[20:23], v[132:135], v[104:107], v[20:23]
    ds_read_b64_tr_b16 v[88:89], v244 offset:16384
    v_mfma_f32_16x16x32_bf16 v[36:39], v[132:135], v[108:111], v[36:39]
    ds_read_b64_tr_b16 v[90:91], v244 offset:17408
    v_mfma_f32_16x16x32_bf16 v[32:35], v[128:131], v[108:111], v[32:35]
    ds_read_b64_tr_b16 v[92:93], v245 offset:16384
    v_mfma_f32_16x16x32_bf16 v[28:31], v[124:127], v[108:111], v[28:31]
    ds_read_b64_tr_b16 v[94:95], v245 offset:17408
    v_mfma_f32_16x16x32_bf16 v[24:27], v[120:123], v[108:111], v[24:27]
    ds_read_b64_tr_b16 v[96:97], v246 offset:16384
    v_mfma_f32_16x16x32_bf16 v[40:43], v[120:123], v[112:115], v[40:43]
    ds_read_b64_tr_b16 v[98:99], v246 offset:17408
    v_mfma_f32_16x16x32_bf16 v[44:47], v[124:127], v[112:115], v[44:47]
    ds_read_b64_tr_b16 v[100:101], v247 offset:16384
    v_mfma_f32_16x16x32_bf16 v[48:51], v[128:131], v[112:115], v[48:51]
    ds_read_b64_tr_b16 v[102:103], v247 offset:17408
    v_mfma_f32_16x16x32_bf16 v[52:55], v[132:135], v[112:115], v[52:55]
    ds_read_b128 v[76:79], v154 offset:2048
    v_mfma_f32_16x16x32_bf16 v[68:71], v[132:135], v[116:119], v[68:71]
    ds_read_b128 v[80:83], v154 offset:4096
    v_mfma_f32_16x16x32_bf16 v[64:67], v[128:131], v[116:119], v[64:67]
    ds_read_b128 v[84:87], v154 offset:6144
    v_mfma_f32_16x16x32_bf16 v[60:63], v[124:127], v[116:119], v[60:63]
    v_mfma_f32_16x16x32_bf16 v[56:59], v[120:123], v[116:119], v[56:59]
    s_waitcnt lgkmcnt(3)
    v_mfma_f32_16x16x32_bf16 v[8:11], v[88:91], v[72:75], v[8:11]
    ds_read_b128 v[104:107], v155 offset:0
    v_mfma_f32_16x16x32_bf16 v[12:15], v[92:95], v[72:75], v[12:15]
    ds_read_b64_tr_b16 v[120:121], v244 offset:24576
    v_mfma_f32_16x16x32_bf16 v[16:19], v[96:99], v[72:75], v[16:19]
    ds_read_b64_tr_b16 v[122:123], v244 offset:25600
    v_mfma_f32_16x16x32_bf16 v[20:23], v[100:103], v[72:75], v[20:23]
    s_waitcnt lgkmcnt(3)
    ds_read_b64_tr_b16 v[124:125], v245 offset:24576
    v_mfma_f32_16x16x32_bf16 v[36:39], v[100:103], v[76:79], v[36:39]
    ds_read_b64_tr_b16 v[126:127], v245 offset:25600
    v_mfma_f32_16x16x32_bf16 v[32:35], v[96:99], v[76:79], v[32:35]
    ds_read_b64_tr_b16 v[128:129], v246 offset:24576
    v_mfma_f32_16x16x32_bf16 v[28:31], v[92:95], v[76:79], v[28:31]
    ds_read_b64_tr_b16 v[130:131], v246 offset:25600
    v_mfma_f32_16x16x32_bf16 v[24:27], v[88:91], v[76:79], v[24:27]
    ds_read_b64_tr_b16 v[132:133], v247 offset:24576
    v_mfma_f32_16x16x32_bf16 v[40:43], v[88:91], v[80:83], v[40:43]
    ds_read_b64_tr_b16 v[134:135], v247 offset:25600
    v_mfma_f32_16x16x32_bf16 v[44:47], v[92:95], v[80:83], v[44:47]
    ds_read_b128 v[108:111], v155 offset:2048
    v_mfma_f32_16x16x32_bf16 v[48:51], v[96:99], v[80:83], v[48:51]
    ds_read_b128 v[112:115], v155 offset:4096
    v_mfma_f32_16x16x32_bf16 v[52:55], v[100:103], v[80:83], v[52:55]
    ds_read_b128 v[116:119], v155 offset:6144
    v_mfma_f32_16x16x32_bf16 v[68:71], v[100:103], v[84:87], v[68:71]
    v_mfma_f32_16x16x32_bf16 v[64:67], v[96:99], v[84:87], v[64:67]
    v_mfma_f32_16x16x32_bf16 v[60:63], v[92:95], v[84:87], v[60:63]
    v_mfma_f32_16x16x32_bf16 v[56:59], v[88:91], v[84:87], v[56:59]
    s_waitcnt lgkmcnt(3)
    v_mfma_f32_16x16x32_bf16 v[8:11], v[120:123], v[104:107], v[8:11]
    v_mfma_f32_16x16x32_bf16 v[12:15], v[124:127], v[104:107], v[12:15]
    v_mfma_f32_16x16x32_bf16 v[16:19], v[128:131], v[104:107], v[16:19]
    s_waitcnt lgkmcnt(0)
    s_barrier
    ds_read_b128 v[72:75], v152 offset:0
    v_mfma_f32_16x16x32_bf16 v[20:23], v[132:135], v[104:107], v[20:23]
    ds_read_b64_tr_b16 v[88:89], v240 offset:16384
    v_mfma_f32_16x16x32_bf16 v[36:39], v[132:135], v[108:111], v[36:39]
    ds_read_b64_tr_b16 v[90:91], v240 offset:17408
    v_mfma_f32_16x16x32_bf16 v[32:35], v[128:131], v[108:111], v[32:35]
    ds_read_b64_tr_b16 v[92:93], v241 offset:16384
    v_mfma_f32_16x16x32_bf16 v[28:31], v[124:127], v[108:111], v[28:31]
    ds_read_b64_tr_b16 v[94:95], v241 offset:17408
    v_mfma_f32_16x16x32_bf16 v[24:27], v[120:123], v[108:111], v[24:27]
    ds_read_b64_tr_b16 v[96:97], v242 offset:16384
    v_mfma_f32_16x16x32_bf16 v[40:43], v[120:123], v[112:115], v[40:43]
    ds_read_b64_tr_b16 v[98:99], v242 offset:17408
    v_mfma_f32_16x16x32_bf16 v[44:47], v[124:127], v[112:115], v[44:47]
    ds_read_b64_tr_b16 v[100:101], v243 offset:16384
    v_mfma_f32_16x16x32_bf16 v[48:51], v[128:131], v[112:115], v[48:51]
    ds_read_b64_tr_b16 v[102:103], v243 offset:17408
    v_mfma_f32_16x16x32_bf16 v[52:55], v[132:135], v[112:115], v[52:55]
    ds_read_b128 v[76:79], v152 offset:2048
    v_mfma_f32_16x16x32_bf16 v[68:71], v[132:135], v[116:119], v[68:71]
    ds_read_b128 v[80:83], v152 offset:4096
    v_mfma_f32_16x16x32_bf16 v[64:67], v[128:131], v[116:119], v[64:67]
    ds_read_b128 v[84:87], v152 offset:6144
    v_mfma_f32_16x16x32_bf16 v[60:63], v[124:127], v[116:119], v[60:63]
    v_mfma_f32_16x16x32_bf16 v[56:59], v[120:123], v[116:119], v[56:59]
    s_waitcnt lgkmcnt(3)
    v_mfma_f32_16x16x32_bf16 v[8:11], v[88:91], v[72:75], v[8:11]
    ds_read_b128 v[104:107], v153 offset:0
    v_mfma_f32_16x16x32_bf16 v[12:15], v[92:95], v[72:75], v[12:15]
    ds_read_b64_tr_b16 v[120:121], v240 offset:24576
    v_mfma_f32_16x16x32_bf16 v[16:19], v[96:99], v[72:75], v[16:19]
    ds_read_b64_tr_b16 v[122:123], v240 offset:25600
    v_mfma_f32_16x16x32_bf16 v[20:23], v[100:103], v[72:75], v[20:23]
    s_waitcnt lgkmcnt(3)
    ds_read_b64_tr_b16 v[124:125], v241 offset:24576
    v_mfma_f32_16x16x32_bf16 v[36:39], v[100:103], v[76:79], v[36:39]
    ds_read_b64_tr_b16 v[126:127], v241 offset:25600
    v_mfma_f32_16x16x32_bf16 v[32:35], v[96:99], v[76:79], v[32:35]
    ds_read_b64_tr_b16 v[128:129], v242 offset:24576
    v_mfma_f32_16x16x32_bf16 v[28:31], v[92:95], v[76:79], v[28:31]
    ds_read_b64_tr_b16 v[130:131], v242 offset:25600
    v_mfma_f32_16x16x32_bf16 v[24:27], v[88:91], v[76:79], v[24:27]
    ds_read_b64_tr_b16 v[132:133], v243 offset:24576
    v_mfma_f32_16x16x32_bf16 v[40:43], v[88:91], v[80:83], v[40:43]
    ds_read_b64_tr_b16 v[134:135], v243 offset:25600
    v_mfma_f32_16x16x32_bf16 v[44:47], v[92:95], v[80:83], v[44:47]
    ds_read_b128 v[108:111], v153 offset:2048
    v_mfma_f32_16x16x32_bf16 v[48:51], v[96:99], v[80:83], v[48:51]
    ds_read_b128 v[112:115], v153 offset:4096
    v_mfma_f32_16x16x32_bf16 v[52:55], v[100:103], v[80:83], v[52:55]
    ds_read_b128 v[116:119], v153 offset:6144
    v_mfma_f32_16x16x32_bf16 v[68:71], v[100:103], v[84:87], v[68:71]
    v_mfma_f32_16x16x32_bf16 v[64:67], v[96:99], v[84:87], v[64:67]
    v_mfma_f32_16x16x32_bf16 v[60:63], v[92:95], v[84:87], v[60:63]
    v_mfma_f32_16x16x32_bf16 v[56:59], v[88:91], v[84:87], v[56:59]
    s_waitcnt lgkmcnt(3)
    s_waitcnt vmcnt(0)
    v_mfma_f32_16x16x32_bf16 v[8:11], v[120:123], v[104:107], v[8:11]
    v_mfma_f32_16x16x32_bf16 v[12:15], v[124:127], v[104:107], v[12:15]
    v_mfma_f32_16x16x32_bf16 v[16:19], v[128:131], v[104:107], v[16:19]
    s_waitcnt lgkmcnt(0)
    s_barrier
    ds_read_b128 v[72:75], v152 offset:32768
    v_mfma_f32_16x16x32_bf16 v[20:23], v[132:135], v[104:107], v[20:23]
    ds_read_b64_tr_b16 v[88:89], v240 offset:49152
    v_mfma_f32_16x16x32_bf16 v[36:39], v[132:135], v[108:111], v[36:39]
    ds_read_b64_tr_b16 v[90:91], v240 offset:50176
    v_mfma_f32_16x16x32_bf16 v[32:35], v[128:131], v[108:111], v[32:35]
    ds_read_b64_tr_b16 v[92:93], v241 offset:49152
    v_mfma_f32_16x16x32_bf16 v[28:31], v[124:127], v[108:111], v[28:31]
    ds_read_b64_tr_b16 v[94:95], v241 offset:50176
    v_mfma_f32_16x16x32_bf16 v[24:27], v[120:123], v[108:111], v[24:27]
    ds_read_b64_tr_b16 v[96:97], v242 offset:49152
    v_mfma_f32_16x16x32_bf16 v[40:43], v[120:123], v[112:115], v[40:43]
    ds_read_b64_tr_b16 v[98:99], v242 offset:50176
    v_mfma_f32_16x16x32_bf16 v[44:47], v[124:127], v[112:115], v[44:47]
    ds_read_b64_tr_b16 v[100:101], v243 offset:49152
    v_mfma_f32_16x16x32_bf16 v[48:51], v[128:131], v[112:115], v[48:51]
    ds_read_b64_tr_b16 v[102:103], v243 offset:50176
    v_mfma_f32_16x16x32_bf16 v[52:55], v[132:135], v[112:115], v[52:55]
    ds_read_b128 v[76:79], v152 offset:34816
    v_mfma_f32_16x16x32_bf16 v[68:71], v[132:135], v[116:119], v[68:71]
    ds_read_b128 v[80:83], v152 offset:36864
    v_mfma_f32_16x16x32_bf16 v[64:67], v[128:131], v[116:119], v[64:67]
    ds_read_b128 v[84:87], v152 offset:38912
    v_mfma_f32_16x16x32_bf16 v[60:63], v[124:127], v[116:119], v[60:63]
    v_mfma_f32_16x16x32_bf16 v[56:59], v[120:123], v[116:119], v[56:59]
    s_waitcnt lgkmcnt(3)
    v_mfma_f32_16x16x32_bf16 v[8:11], v[88:91], v[72:75], v[8:11]
    ds_read_b128 v[104:107], v153 offset:32768
    v_mfma_f32_16x16x32_bf16 v[12:15], v[92:95], v[72:75], v[12:15]
    ds_read_b64_tr_b16 v[120:121], v240 offset:57344
    v_mfma_f32_16x16x32_bf16 v[16:19], v[96:99], v[72:75], v[16:19]
    ds_read_b64_tr_b16 v[122:123], v240 offset:58368
    v_mfma_f32_16x16x32_bf16 v[20:23], v[100:103], v[72:75], v[20:23]
    s_waitcnt lgkmcnt(3)
    ds_read_b64_tr_b16 v[124:125], v241 offset:57344
    v_mfma_f32_16x16x32_bf16 v[36:39], v[100:103], v[76:79], v[36:39]
    ds_read_b64_tr_b16 v[126:127], v241 offset:58368
    v_mfma_f32_16x16x32_bf16 v[32:35], v[96:99], v[76:79], v[32:35]
    ds_read_b64_tr_b16 v[128:129], v242 offset:57344
    v_mfma_f32_16x16x32_bf16 v[28:31], v[92:95], v[76:79], v[28:31]
    ds_read_b64_tr_b16 v[130:131], v242 offset:58368
    v_mfma_f32_16x16x32_bf16 v[24:27], v[88:91], v[76:79], v[24:27]
    ds_read_b64_tr_b16 v[132:133], v243 offset:57344
    v_mfma_f32_16x16x32_bf16 v[40:43], v[88:91], v[80:83], v[40:43]
    ds_read_b64_tr_b16 v[134:135], v243 offset:58368
    v_mfma_f32_16x16x32_bf16 v[44:47], v[92:95], v[80:83], v[44:47]
    ds_read_b128 v[108:111], v153 offset:34816
    v_mfma_f32_16x16x32_bf16 v[48:51], v[96:99], v[80:83], v[48:51]
    ds_read_b128 v[112:115], v153 offset:36864
    v_mfma_f32_16x16x32_bf16 v[52:55], v[100:103], v[80:83], v[52:55]
    ds_read_b128 v[116:119], v153 offset:38912
    v_mfma_f32_16x16x32_bf16 v[68:71], v[100:103], v[84:87], v[68:71]
    s_cmp_lg_u32 s52, 0
    s_cbranch_scc1 L_nodb_26
    s_bfe_u32 s66, s2, 0x20003
    s_lshl_b32 s66, s66, 8
    s_add_u32 s66, s66, 20160512
    s_mov_b64 exec, 1
    buffer_atomic_add v1, v3, s[16:19], s66 offen sc1
    s_mov_b64 exec, -1
L_nodb_26:
    v_mfma_f32_16x16x32_bf16 v[64:67], v[96:99], v[84:87], v[64:67]
    v_mfma_f32_16x16x32_bf16 v[60:63], v[92:95], v[84:87], v[60:63]
    v_mfma_f32_16x16x32_bf16 v[56:59], v[88:91], v[84:87], v[56:59]
    s_waitcnt lgkmcnt(3)
    v_mfma_f32_16x16x32_bf16 v[8:11], v[120:123], v[104:107], v[8:11]
    v_mfma_f32_16x16x32_bf16 v[12:15], v[124:127], v[104:107], v[12:15]
    v_mfma_f32_16x16x32_bf16 v[16:19], v[128:131], v[104:107], v[16:19]
    s_waitcnt lgkmcnt(0)
    s_barrier
    ds_read_b128 v[72:75], v154 offset:0
    v_mfma_f32_16x16x32_bf16 v[20:23], v[132:135], v[104:107], v[20:23]
    ds_read_b64_tr_b16 v[88:89], v244 offset:16384
    v_mfma_f32_16x16x32_bf16 v[36:39], v[132:135], v[108:111], v[36:39]
    ds_read_b64_tr_b16 v[90:91], v244 offset:17408
    v_mfma_f32_16x16x32_bf16 v[32:35], v[128:131], v[108:111], v[32:35]
    ds_read_b64_tr_b16 v[92:93], v245 offset:16384
    v_mfma_f32_16x16x32_bf16 v[28:31], v[124:127], v[108:111], v[28:31]
    ds_read_b64_tr_b16 v[94:95], v245 offset:17408
    v_mfma_f32_16x16x32_bf16 v[24:27], v[120:123], v[108:111], v[24:27]
    ds_read_b64_tr_b16 v[96:97], v246 offset:16384
    v_mfma_f32_16x16x32_bf16 v[40:43], v[120:123], v[112:115], v[40:43]
    ds_read_b64_tr_b16 v[98:99], v246 offset:17408
    v_mfma_f32_16x16x32_bf16 v[44:47], v[124:127], v[112:115], v[44:47]
    ds_read_b64_tr_b16 v[100:101], v247 offset:16384
    v_mfma_f32_16x16x32_bf16 v[48:51], v[128:131], v[112:115], v[48:51]
    ds_read_b64_tr_b16 v[102:103], v247 offset:17408
    v_mfma_f32_16x16x32_bf16 v[52:55], v[132:135], v[112:115], v[52:55]
    ds_read_b128 v[76:79], v154 offset:2048
    v_mfma_f32_16x16x32_bf16 v[68:71], v[132:135], v[116:119], v[68:71]
    ds_read_b128 v[80:83], v154 offset:4096
    v_mfma_f32_16x16x32_bf16 v[64:67], v[128:131], v[116:119], v[64:67]
    ds_read_b128 v[84:87], v154 offset:6144
    v_mfma_f32_16x16x32_bf16 v[60:63], v[124:127], v[116:119], v[60:63]
    v_mfma_f32_16x16x32_bf16 v[56:59], v[120:123], v[116:119], v[56:59]
    s_waitcnt lgkmcnt(3)
    v_mfma_f32_16x16x32_bf16 v[8:11], v[88:91], v[72:75], v[8:11]
    ds_read_b128 v[104:107], v155 offset:0
    v_mfma_f32_16x16x32_bf16 v[12:15], v[92:95], v[72:75], v[12:15]
    ds_read_b64_tr_b16 v[120:121], v244 offset:24576
    v_mfma_f32_16x16x32_bf16 v[16:19], v[96:99], v[72:75], v[16:19]
    ds_read_b64_tr_b16 v[122:123], v244 offset:25600
    v_mfma_f32_16x16x32_bf16 v[20:23], v[100:103], v[72:75], v[20:23]
    s_waitcnt lgkmcnt(3)
    ds_read_b64_tr_b16 v[124:125], v245 offset:24576
    v_mfma_f32_16x16x32_bf16 v[36:39], v[100:103], v[76:79], v[36:39]
    ds_read_b64_tr_b16 v[126:127], v245 offset:25600
    v_mfma_f32_16x16x32_bf16 v[32:35], v[96:99], v[76:79], v[32:35]
    ds_read_b64_tr_b16 v[128:129], v246 offset:24576
    v_mfma_f32_16x16x32_bf16 v[28:31], v[92:95], v[76:79], v[28:31]
    ds_read_b64_tr_b16 v[130:131], v246 offset:25600
    v_mfma_f32_16x16x32_bf16 v[24:27], v[88:91], v[76:79], v[24:27]
    ds_read_b64_tr_b16 v[132:133], v247 offset:24576
    v_mfma_f32_16x16x32_bf16 v[40:43], v[88:91], v[80:83], v[40:43]
    ds_read_b64_tr_b16 v[134:135], v247 offset:25600
    v_mfma_f32_16x16x32_bf16 v[44:47], v[92:95], v[80:83], v[44:47]
    ds_read_b128 v[108:111], v155 offset:2048
    v_mfma_f32_16x16x32_bf16 v[48:51], v[96:99], v[80:83], v[48:51]
    ds_read_b128 v[112:115], v155 offset:4096
    v_mfma_f32_16x16x32_bf16 v[52:55], v[100:103], v[80:83], v[52:55]
    ds_read_b128 v[116:119], v155 offset:6144
    v_mfma_f32_16x16x32_bf16 v[68:71], v[100:103], v[84:87], v[68:71]
    v_mfma_f32_16x16x32_bf16 v[64:67], v[96:99], v[84:87], v[64:67]
    v_mfma_f32_16x16x32_bf16 v[60:63], v[92:95], v[84:87], v[60:63]
    v_mfma_f32_16x16x32_bf16 v[56:59], v[88:91], v[84:87], v[56:59]
    s_waitcnt lgkmcnt(3)
    v_mfma_f32_16x16x32_bf16 v[8:11], v[120:123], v[104:107], v[8:11]
    v_mfma_f32_16x16x32_bf16 v[12:15], v[124:127], v[104:107], v[12:15]
    v_mfma_f32_16x16x32_bf16 v[16:19], v[128:131], v[104:107], v[16:19]
    s_waitcnt lgkmcnt(0)
    s_barrier
    ds_read_b128 v[72:75], v152 offset:0
    v_mfma_f32_16x16x32_bf16 v[20:23], v[132:135], v[104:107], v[20:23]
    ds_read_b64_tr_b16 v[88:89], v240 offset:16384
    v_mfma_f32_16x16x32_bf16 v[36:39], v[132:135], v[108:111], v[36:39]
    ds_read_b64_tr_b16 v[90:91], v240 offset:17408
    v_mfma_f32_16x16x32_bf16 v[32:35], v[128:131], v[108:111], v[32:35]
    ds_read_b64_tr_b16 v[92:93], v241 offset:16384
    v_mfma_f32_16x16x32_bf16 v[28:31], v[124:127], v[108:111], v[28:31]
    ds_read_b64_tr_b16 v[94:95], v241 offset:17408
    v_mfma_f32_16x16x32_bf16 v[24:27], v[120:123], v[108:111], v[24:27]
    ds_read_b64_tr_b16 v[96:97], v242 offset:16384
    v_mfma_f32_16x16x32_bf16 v[40:43], v[120:123], v[112:115], v[40:43]
    ds_read_b64_tr_b16 v[98:99], v242 offset:17408
    v_mfma_f32_16x16x32_bf16 v[44:47], v[124:127], v[112:115], v[44:47]
    ds_read_b64_tr_b16 v[100:101], v243 offset:16384
    v_mfma_f32_16x16x32_bf16 v[48:51], v[128:131], v[112:115], v[48:51]
    ds_read_b64_tr_b16 v[102:103], v243 offset:17408
    v_mfma_f32_16x16x32_bf16 v[52:55], v[132:135], v[112:115], v[52:55]
    ds_read_b128 v[76:79], v152 offset:2048
    v_mfma_f32_16x16x32_bf16 v[68:71], v[132:135], v[116:119], v[68:71]
    ds_read_b128 v[80:83], v152 offset:4096
    v_mfma_f32_16x16x32_bf16 v[64:67], v[128:131], v[116:119], v[64:67]
    ds_read_b128 v[84:87], v152 offset:6144
    v_mfma_f32_16x16x32_bf16 v[60:63], v[124:127], v[116:119], v[60:63]
    v_mfma_f32_16x16x32_bf16 v[56:59], v[120:123], v[116:119], v[56:59]
    s_waitcnt lgkmcnt(3)
    v_mfma_f32_16x16x32_bf16 v[8:11], v[88:91], v[72:75], v[8:11]
    ds_read_b128 v[104:107], v153 offset:0
    v_mfma_f32_16x16x32_bf16 v[12:15], v[92:95], v[72:75], v[12:15]
    ds_read_b64_tr_b16 v[120:121], v240 offset:24576
    v_mfma_f32_16x16x32_bf16 v[16:19], v[96:99], v[72:75], v[16:19]
    ds_read_b64_tr_b16 v[122:123], v240 offset:25600
    v_mfma_f32_16x16x32_bf16 v[20:23], v[100:103], v[72:75], v[20:23]
    s_waitcnt lgkmcnt(3)
    ds_read_b64_tr_b16 v[124:125], v241 offset:24576
    v_mfma_f32_16x16x32_bf16 v[36:39], v[100:103], v[76:79], v[36:39]
    ds_read_b64_tr_b16 v[126:127], v241 offset:25600
    v_mfma_f32_16x16x32_bf16 v[32:35], v[96:99], v[76:79], v[32:35]
    ds_read_b64_tr_b16 v[128:129], v242 offset:24576
    v_mfma_f32_16x16x32_bf16 v[28:31], v[92:95], v[76:79], v[28:31]
    ds_read_b64_tr_b16 v[130:131], v242 offset:25600
    v_mfma_f32_16x16x32_bf16 v[24:27], v[88:91], v[76:79], v[24:27]
    ds_read_b64_tr_b16 v[132:133], v243 offset:24576
    v_mfma_f32_16x16x32_bf16 v[40:43], v[88:91], v[80:83], v[40:43]
    ds_read_b64_tr_b16 v[134:135], v243 offset:25600
    v_mfma_f32_16x16x32_bf16 v[44:47], v[92:95], v[80:83], v[44:47]
    ds_read_b128 v[108:111], v153 offset:2048
    v_mfma_f32_16x16x32_bf16 v[48:51], v[96:99], v[80:83], v[48:51]
    ds_read_b128 v[112:115], v153 offset:4096
    v_mfma_f32_16x16x32_bf16 v[52:55], v[100:103], v[80:83], v[52:55]
    ds_read_b128 v[116:119], v153 offset:6144
    v_mfma_f32_16x16x32_bf16 v[68:71], v[100:103], v[84:87], v[68:71]
    v_mfma_f32_16x16x32_bf16 v[64:67], v[96:99], v[84:87], v[64:67]
    v_mfma_f32_16x16x32_bf16 v[60:63], v[92:95], v[84:87], v[60:63]
    v_mfma_f32_16x16x32_bf16 v[56:59], v[88:91], v[84:87], v[56:59]
    s_waitcnt lgkmcnt(3)
    v_mfma_f32_16x16x32_bf16 v[8:11], v[120:123], v[104:107], v[8:11]
    v_mfma_f32_16x16x32_bf16 v[12:15], v[124:127], v[104:107], v[12:15]
    v_mfma_f32_16x16x32_bf16 v[16:19], v[128:131], v[104:107], v[16:19]
    v_mfma_f32_16x16x32_bf16 v[20:23], v[132:135], v[104:107], v[20:23]
    s_waitcnt lgkmcnt(0)
    v_mfma_f32_16x16x32_bf16 v[36:39], v[132:135], v[108:111], v[36:39]
    v_mfma_f32_16x16x32_bf16 v[32:35], v[128:131], v[108:111], v[32:35]
    v_mfma_f32_16x16x32_bf16 v[28:31], v[124:127], v[108:111], v[28:31]
    v_mfma_f32_16x16x32_bf16 v[24:27], v[120:123], v[108:111], v[24:27]
    v_mfma_f32_16x16x32_bf16 v[40:43], v[120:123], v[112:115], v[40:43]
    v_mfma_f32_16x16x32_bf16 v[44:47], v[124:127], v[112:115], v[44:47]
    v_mfma_f32_16x16x32_bf16 v[48:51], v[128:131], v[112:115], v[48:51]
    v_mfma_f32_16x16x32_bf16 v[52:55], v[132:135], v[112:115], v[52:55]
    v_mfma_f32_16x16x32_bf16 v[68:71], v[132:135], v[116:119], v[68:71]
    v_mfma_f32_16x16x32_bf16 v[64:67], v[128:131], v[116:119], v[64:67]
    v_mfma_f32_16x16x32_bf16 v[60:63], v[124:127], v[116:119], v[60:63]
    v_mfma_f32_16x16x32_bf16 v[56:59], v[120:123], v[116:119], v[56:59]
    s_waitcnt lgkmcnt(0)
    s_barrier
    s_add_u32 m0, s97, 49152
    s_add_u32 s71, s96, 786432
    s_sub_u32 s70, s71, 1966080
    s_cselect_b32 s71, s71, s70
    buffer_load_dwordx4 v157, s[12:15], s71 offen offset:0  lds
    buffer_load_dwordx4 v158, s[12:15], s71 offen offset:1024  lds
    buffer_load_dwordx4 v159, s[12:15], s71 offen offset:2048  lds
    s_add_u32 m0, s97, 52224
    s_add_u32 s71, s96, 835584
    s_sub_u32 s70, s71, 1966080
    s_cselect_b32 s71, s71, s70
    buffer_load_dwordx4 v157, s[12:15], s71 offen offset:0  lds
    buffer_load_dwordx4 v158, s[12:15], s71 offen offset:1024  lds
    buffer_load_dwordx4 v159, s[12:15], s71 offen offset:2048  lds
    s_cmp_ge_u32 s54, 5
    s_cbranch_scc1 L_nosc_27
    v_mul_f32 v8, s73, v8
    v_mul_f32 v9, s73, v9
    v_mul_f32 v10, s73, v10
    v_mul_f32 v11, s73, v11
    v_mul_f32 v24, s73, v24
    v_mul_f32 v25, s73, v25
    v_mul_f32 v26, s73, v26
    v_mul_f32 v27, s73, v27
    v_mul_f32 v40, s73, v40
    v_mul_f32 v41, s73, v41
    v_mul_f32 v42, s73, v42
    v_mul_f32 v43, s73, v43
    v_mul_f32 v56, s73, v56
    v_mul_f32 v57, s73, v57
    v_mul_f32 v58, s73, v58
    v_mul_f32 v59, s73, v59
    v_mul_f32 v12, s73, v12
    v_mul_f32 v13, s73, v13
    v_mul_f32 v14, s73, v14
    v_mul_f32 v15, s73, v15
    v_mul_f32 v28, s73, v28
    v_mul_f32 v29, s73, v29
    v_mul_f32 v30, s73, v30
    v_mul_f32 v31, s73, v31
    v_mul_f32 v44, s73, v44
    v_mul_f32 v45, s73, v45
    v_mul_f32 v46, s73, v46
    v_mul_f32 v47, s73, v47
    v_mul_f32 v60, s73, v60
    v_mul_f32 v61, s73, v61
    v_mul_f32 v62, s73, v62
    v_mul_f32 v63, s73, v63
L_nosc_27:
    v_cvt_pk_bf16_f32 v72, v8, v9
    v_cvt_pk_bf16_f32 v73, v10, v11
    v_cvt_pk_bf16_f32 v74, v24, v25
    v_cvt_pk_bf16_f32 v75, v26, v27
    v_cvt_pk_bf16_f32 v76, v40, v41
    v_cvt_pk_bf16_f32 v77, v42, v43
    v_cvt_pk_bf16_f32 v78, v56, v57
    v_cvt_pk_bf16_f32 v79, v58, v59
    v_cvt_pk_bf16_f32 v80, v12, v13
    v_cvt_pk_bf16_f32 v81, v14, v15
    v_cvt_pk_bf16_f32 v82, v28, v29
    v_cvt_pk_bf16_f32 v83, v30, v31
    v_cvt_pk_bf16_f32 v84, v44, v45
    v_cvt_pk_bf16_f32 v85, v46, v47
    v_cvt_pk_bf16_f32 v86, v60, v61
    v_cvt_pk_bf16_f32 v87, v62, v63
    v_permlane16_swap_b32 v72, v74
    v_permlane16_swap_b32 v73, v75
    v_permlane16_swap_b32 v76, v78
    v_permlane16_swap_b32 v77, v79
    v_permlane16_swap_b32 v80, v82
    v_permlane16_swap_b32 v81, v83
    v_permlane16_swap_b32 v84, v86
    v_permlane16_swap_b32 v85, v87
    s_add_u32 s66, s72, 0
    buffer_store_dwordx4 v[72:75], v156, s[16:19], s66 offen offset:0 sc1
    s_add_u32 s66, s72, 0
    buffer_store_dwordx4 v[76:79], v156, s[16:19], s66 offen offset:512 sc1
    s_add_u32 m0, s97, 24576
    s_add_u32 s71, s96, 1179648
    s_sub_u32 s70, s71, 1966080
    s_cselect_b32 s71, s71, s70
    buffer_load_dwordx4 v157, s[12:15], s71 offen offset:0  lds
    buffer_load_dwordx4 v158, s[12:15], s71 offen offset:1024  lds
    buffer_load_dwordx4 v159, s[12:15], s71 offen offset:2048  lds
    s_add_u32 m0, s97, 27648
    s_add_u32 s71, s96, 1228800
    s_sub_u32 s70, s71, 1966080
    s_cselect_b32 s71, s71, s70
    buffer_load_dwordx4 v157, s[12:15], s71 offen offset:0  lds
    buffer_load_dwordx4 v158, s[12:15], s71 offen offset:1024  lds
    buffer_load_dwordx4 v159, s[12:15], s71 offen offset:2048  lds
    s_cmp_ge_u32 s54, 5
    s_cbranch_scc1 L_nosc_28
    v_mul_f32 v16, s73, v16
    v_mul_f32 v17, s73, v17
    v_mul_f32 v18, s73, v18
    v_mul_f32 v19, s73, v19
    v_mul_f32 v32, s73, v32
    v_mul_f32 v33, s73, v33
    v_mul_f32 v34, s73, v34
    v_mul_f32 v35, s73, v35
    v_mul_f32 v48, s73, v48
    v_mul_f32 v49, s73, v49
    v_mul_f32 v50, s73, v50
    v_mul_f32 v51, s73, v51
    v_mul_f32 v64, s73, v64
    v_mul_f32 v65, s73, v65
    v_mul_f32 v66, s73, v66
    v_mul_f32 v67, s73, v67
    v_mul_f32 v20, s73, v20
    v_mul_f32 v21, s73, v21
    v_mul_f32 v22, s73, v22
    v_mul_f32 v23, s73, v23
    v_mul_f32 v36, s73, v36
    v_mul_f32 v37, s73, v37
    v_mul_f32 v38, s73, v38
    v_mul_f32 v39, s73, v39
    v_mul_f32 v52, s73, v52
    v_mul_f32 v53, s73, v53
    v_mul_f32 v54, s73, v54
    v_mul_f32 v55, s73, v55
    v_mul_f32 v68, s73, v68
    v_mul_f32 v69, s73, v69
    v_mul_f32 v70, s73, v70
    v_mul_f32 v71, s73, v71
L_nosc_28:
    v_cvt_pk_bf16_f32 v88, v16, v17
    v_cvt_pk_bf16_f32 v89, v18, v19
    v_cvt_pk_bf16_f32 v90, v32, v33
    v_cvt_pk_bf16_f32 v91, v34, v35
    v_cvt_pk_bf16_f32 v92, v48, v49
    v_cvt_pk_bf16_f32 v93, v50, v51
    v_cvt_pk_bf16_f32 v94, v64, v65
    v_cvt_pk_bf16_f32 v95, v66, v67
    v_cvt_pk_bf16_f32 v96, v20, v21
    v_cvt_pk_bf16_f32 v97, v22, v23
    v_cvt_pk_bf16_f32 v98, v36, v37
    v_cvt_pk_bf16_f32 v99, v38, v39
    v_cvt_pk_bf16_f32 v100, v52, v53
    v_cvt_pk_bf16_f32 v101, v54, v55
    v_cvt_pk_bf16_f32 v102, v68, v69
    v_cvt_pk_bf16_f32 v103, v70, v71
    v_permlane16_swap_b32 v88, v90
    v_permlane16_swap_b32 v89, v91
    v_permlane16_swap_b32 v92, v94
    v_permlane16_swap_b32 v93, v95
    v_permlane16_swap_b32 v96, v98
    v_permlane16_swap_b32 v97, v99
    v_permlane16_swap_b32 v100, v102
    v_permlane16_swap_b32 v101, v103
    s_waitcnt vmcnt(8)
    ds_add_u32 v7, v1 offset:16
    s_add_u32 s66, s72, 4096
    buffer_store_dwordx4 v[80:83], v156, s[16:19], s66 offen offset:0 sc1
    s_add_u32 s66, s72, 4096
    buffer_store_dwordx4 v[84:87], v156, s[16:19], s66 offen offset:512 sc1
    s_add_u32 m0, s97, 0
    s_add_u32 s71, s96, 1572864
    s_sub_u32 s70, s71, 1966080
    s_cselect_b32 s71, s71, s70
    buffer_load_dwordx4 v157, s[12:15], s71 offen offset:0  lds
    buffer_load_dwordx4 v158, s[12:15], s71 offen offset:1024  lds
    buffer_load_dwordx4 v159, s[12:15], s71 offen offset:2048  lds
    s_add_u32 m0, s97, 3072
    s_add_u32 s71, s96, 1622016
    s_sub_u32 s70, s71, 1966080
    s_cselect_b32 s71, s71, s70
    buffer_load_dwordx4 v157, s[12:15], s71 offen offset:0  lds
    buffer_load_dwordx4 v158, s[12:15], s71 offen offset:1024  lds
    buffer_load_dwordx4 v159, s[12:15], s71 offen offset:2048  lds
    s_waitcnt vmcnt(8)
    ds_add_u32 v7, v1 offset:20
    s_cmp_lg_u32 s52, 0
    s_cbranch_scc1 L_db_29
    s_load_dword s8, s[6:7], 0
    s_load_dword s9, s[6:7], 256
    s_load_dword s10, s[6:7], 512
    s_load_dword s11, s[6:7], 768
L_db_29:
    s_add_u32 s66, s72, 8192
    buffer_store_dwordx4 v[88:91], v156, s[16:19], s66 offen offset:0 sc1
    s_add_u32 s66, s72, 8192
    buffer_store_dwordx4 v[92:95], v156, s[16:19], s66 offen offset:512 sc1
    s_add_u32 s66, s72, 12288
    buffer_store_dwordx4 v[96:99], v156, s[16:19], s66 offen offset:0 sc1
    s_add_u32 s66, s72, 12288
    buffer_store_dwordx4 v[100:103], v156, s[16:19], s66 offen offset:512 sc1
    s_waitcnt vmcnt(4)
    ds_add_u32 v7, v1 offset:24
    s_cmp_lg_u32 s52, 0
    s_cbranch_scc1 L_db_30
    s_waitcnt lgkmcnt(0)
    s_min_u32 s8, s8, s9
    s_min_u32 s8, s8, s10
    s_min_u32 s8, s8, s11
    s_cmp_lt_u32 s8, 64
    s_cbranch_scc1 L_db_30
    ds_add_u32 v7, v1 offset:4
L_db_30:
    s_branch L_qjoin
L_qv:
    s_and_b32 s66, s52, 1
    s_lshl_b32 s66, s66, 13
    v_and_b32 v126, 15, v0
    v_lshrrev_b32 v127, 1, v0
    v_xor_b32 v127, v127, v0
    v_bfe_u32 v127, v127, 2, 1
    v_mul_u32_u24 v127, 12, v127
    v_xor_b32 v126, v126, v127
    v_lshrrev_b32 v127, 1, v126
    v_lshrrev_b32 v128, 4, v0
    v_xor_b32 v127, v127, v128
    v_lshl_add_u32 v126, v126, 7, s66
    v_lshl_add_u32 v152, v127, 4, v126
    v_xor_b32 v153, 64, v152
    v_add_u32 v154, 0x10000, v152
    v_add_u32 v155, 0x10000, v153
    v_bfe_u32 v126, v0, 2, 2
    v_lshl_add_u32 v127, v128, 3, v126
    v_and_b32 v128, 1, v128
    v_lshl_add_u32 v126, v126, 1, v128
    s_and_b32 s66, s52, 2
    s_lshl_b32 s66, s66, 1
    v_xor_b32 v126, s66, v126
    v_lshlrev_b32 v126, 5, v126
    v_lshl_add_u32 v126, v127, 8, v126
    v_and_b32 v127, 3, v0
    v_lshl_add_u32 v240, v127, 3, v126
    v_xor_b32 v241, 32, v240
    v_xor_b32 v242, 64, v240
    v_xor_b32 v243, 96, v240
    v_add_u32 v244, 0x10000, v240
    v_add_u32 v245, 0x10000, v241
    v_add_u32 v246, 0x10000, v242
    v_add_u32 v247, 0x10000, v243
    v_lshrrev_b32 v126, 5, v0
    v_mul_u32_u24 v126, 10240, v126
    v_and_b32 v127, 31, v0
    v_lshl_add_u32 v156, v127, 4, v126
    s_and_b32 s66, s52, 1
    s_lshr_b32 s67, s52, 1
    s_lshl1_add_u32 s66, s53, s66
    s_lshl1_add_u32 s67, s54, s67
    s_lshl_b32 s67, s67, 10
    s_mul_i32 s66, s66, 81920
    s_add_u32 s72, s66, s67
    s_add_u32 s72, s72, 5222400
    s_waitcnt lgkmcnt(0)
    s_barrier
    ds_read_b128 v[72:75], v152 offset:0
    ds_read_b64_tr_b16 v[88:89], v240 offset:16384
    ds_read_b64_tr_b16 v[90:91], v240 offset:17408
    ds_read_b64_tr_b16 v[92:93], v241 offset:16384
    ds_read_b64_tr_b16 v[94:95], v241 offset:17408
    ds_read_b64_tr_b16 v[96:97], v242 offset:16384
    ds_read_b64_tr_b16 v[98:99], v242 offset:17408
    ds_read_b64_tr_b16 v[100:101], v243 offset:16384
    ds_read_b64_tr_b16 v[102:103], v243 offset:17408
    ds_read_b128 v[76:79], v152 offset:2048
    ds_read_b128 v[80:83], v152 offset:4096
    ds_read_b128 v[84:87], v152 offset:6144
    s_waitcnt lgkmcnt(9)
    v_mfma_f32_16x16x32_bf16 v[8:11], v[72:75], v[88:91], 0
    ds_read_b128 v[104:107], v153 offset:0
    s_waitcnt lgkmcnt(8)
    v_mfma_f32_16x16x32_bf16 v[12:15], v[72:75], v[92:95], 0
    ds_read_b64_tr_b16 v[120:121], v240 offset:24576
    s_waitcnt lgkmcnt(7)
    v_mfma_f32_16x16x32_bf16 v[16:19], v[72:75], v[96:99], 0
    ds_read_b64_tr_b16 v[122:123], v240 offset:25600
    s_waitcnt lgkmcnt(6)
    v_mfma_f32_16x16x32_bf16 v[20:23], v[72:75], v[100:103], 0
    ds_read_b64_tr_b16 v[124:125], v241 offset:24576
    s_waitcnt lgkmcnt(6)
    v_mfma_f32_16x16x32_bf16 v[36:39], v[76:79], v[100:103], 0
    ds_read_b64_tr_b16 v[126:127], v241 offset:25600
    v_mfma_f32_16x16x32_bf16 v[32:35], v[76:79], v[96:99], 0
    ds_read_b64_tr_b16 v[128:129], v242 offset:24576
    v_mfma_f32_16x16x32_bf16 v[28:31], v[76:79], v[92:95], 0
    ds_read_b64_tr_b16 v[130:131], v242 offset:25600
    v_mfma_f32_16x16x32_bf16 v[24:27], v[76:79], v[88:91], 0
    ds_read_b64_tr_b16 v[132:133], v243 offset:24576
    s_waitcnt lgkmcnt(9)
    v_mfma_f32_16x16x32_bf16 v[40:43], v[80:83], v[88:91], 0
    ds_read_b64_tr_b16 v[134:135], v243 offset:25600
    v_mfma_f32_16x16x32_bf16 v[44:47], v[80:83], v[92:95], 0
    ds_read_b128 v[108:111], v153 offset:2048
    v_mfma_f32_16x16x32_bf16 v[48:51], v[80:83], v[96:99], 0
    ds_read_b128 v[112:115], v153 offset:4096
    v_mfma_f32_16x16x32_bf16 v[52:55], v[80:83], v[100:103], 0
    ds_read_b128 v[116:119], v153 offset:6144
    s_waitcnt lgkmcnt(12)
    v_mfma_f32_16x16x32_bf16 v[68:71], v[84:87], v[100:103], 0
    s_lshl_b32 s66, s59, 12
    s_add_u32 m0, s66, 122880
    s_nop 0
    buffer_load_dwordx4 v5, s[20:23], s60 offen  lds
    s_add_u32 m0, s66, 123904
    s_nop 0
    buffer_load_dwordx4 v5, s[20:23], s61 offen  lds
    s_add_u32 m0, s66, 124928
    s_nop 0
    buffer_load_dwordx4 v5, s[20:23], s62 offen  lds
    s_add_u32 m0, s66, 125952
    s_nop 0
    buffer_load_dwordx4 v5, s[20:23], s63 offen  lds
    v_mfma_f32_16x16x32_bf16 v[64:67], v[84:87], v[96:99], 0
    v_mfma_f32_16x16x32_bf16 v[60:63], v[84:87], v[92:95], 0
    v_mfma_f32_16x16x32_bf16 v[56:59], v[84:87], v[88:91], 0
    s_waitcnt lgkmcnt(3)
    v_mfma_f32_16x16x32_bf16 v[8:11], v[104:107], v[120:123], v[8:11]
    v_mfma_f32_16x16x32_bf16 v[12:15], v[104:107], v[124:127], v[12:15]
    v_mfma_f32_16x16x32_bf16 v[16:19], v[104:107], v[128:131], v[16:19]
    s_waitcnt lgkmcnt(0)
    s_barrier
    ds_read_b128 v[72:75], v152 offset:32768
    v_mfma_f32_16x16x32_bf16 v[20:23], v[104:107], v[132:135], v[20:23]
    ds_read_b64_tr_b16 v[88:89], v240 offset:49152
    v_mfma_f32_16x16x32_bf16 v[36:39], v[108:111], v[132:135], v[36:39]
    ds_read_b64_tr_b16 v[90:91], v240 offset:50176
    v_mfma_f32_16x16x32_bf16 v[32:35], v[108:111], v[128:131], v[32:35]
    ds_read_b64_tr_b16 v[92:93], v241 offset:49152
    v_mfma_f32_16x16x32_bf16 v[28:31], v[108:111], v[124:127], v[28:31]
    ds_read_b64_tr_b16 v[94:95], v241 offset:50176
    v_mfma_f32_16x16x32_bf16 v[24:27], v[108:111], v[120:123], v[24:27]
    ds_read_b64_tr_b16 v[96:97], v242 offset:49152
    v_mfma_f32_16x16x32_bf16 v[40:43], v[112:115], v[120:123], v[40:43]
    ds_read_b64_tr_b16 v[98:99], v242 offset:50176
    v_mfma_f32_16x16x32_bf16 v[44:47], v[112:115], v[124:127], v[44:47]
    ds_read_b64_tr_b16 v[100:101], v243 offset:49152
    v_mfma_f32_16x16x32_bf16 v[48:51], v[112:115], v[128:131], v[48:51]
    ds_read_b64_tr_b16 v[102:103], v243 offset:50176
    v_mfma_f32_16x16x32_bf16 v[52:55], v[112:115], v[132:135], v[52:55]
    ds_read_b128 v[76:79], v152 offset:34816
    v_mfma_f32_16x16x32_bf16 v[68:71], v[116:119], v[132:135], v[68:71]
    ds_read_b128 v[80:83], v152 offset:36864
    v_mfma_f32_16x16x32_bf16 v[64:67], v[116:119], v[128:131], v[64:67]
    ds_read_b128 v[84:87], v152 offset:38912
    v_mfma_f32_16x16x32_bf16 v[60:63], v[116:119], v[124:127], v[60:63]
    v_mfma_f32_16x16x32_bf16 v[56:59], v[116:119], v[120:123], v[56:59]
    s_waitcnt lgkmcnt(3)
    v_mfma_f32_16x16x32_bf16 v[8:11], v[72:75], v[88:91], v[8:11]
    ds_read_b128 v[104:107], v153 offset:32768
    v_mfma_f32_16x16x32_bf16 v[12:15], v[72:75], v[92:95], v[12:15]
    ds_read_b64_tr_b16 v[120:121], v240 offset:57344
    v_mfma_f32_16x16x32_bf16 v[16:19], v[72:75], v[96:99], v[16:19]
    ds_read_b64_tr_b16 v[122:123], v240 offset:58368
    v_mfma_f32_16x16x32_bf16 v[20:23], v[72:75], v[100:103], v[20:23]
    s_waitcnt lgkmcnt(3)
    ds_read_b64_tr_b16 v[124:125], v241 offset:57344
    v_mfma_f32_16x16x32_bf16 v[36:39], v[76:79], v[100:103], v[36:39]
    ds_read_b64_tr_b16 v[126:127], v241 offset:58368
    v_mfma_f32_16x16x32_bf16 v[32:35], v[76:79], v[96:99], v[32:35]
    ds_read_b64_tr_b16 v[128:129], v242 offset:57344
    v_mfma_f32_16x16x32_bf16 v[28:31], v[76:79], v[92:95], v[28:31]
    ds_read_b64_tr_b16 v[130:131], v242 offset:58368
    v_mfma_f32_16x16x32_bf16 v[24:27], v[76:79], v[88:91], v[24:27]
    ds_read_b64_tr_b16 v[132:133], v243 offset:57344
    v_mfma_f32_16x16x32_bf16 v[40:43], v[80:83], v[88:91], v[40:43]
    ds_read_b64_tr_b16 v[134:135], v243 offset:58368
    v_mfma_f32_16x16x32_bf16 v[44:47], v[80:83], v[92:95], v[44:47]
    ds_read_b128 v[108:111], v153 offset:34816
    v_mfma_f32_16x16x32_bf16 v[48:51], v[80:83], v[96:99], v[48:51]
    ds_read_b128 v[112:115], v153 offset:36864
    v_mfma_f32_16x16x32_bf16 v[52:55], v[80:83], v[100:103], v[52:55]
    ds_read_b128 v[116:119], v153 offset:38912
    v_mfma_f32_16x16x32_bf16 v[68:71], v[84:87], v[100:103], v[68:71]
    v_mfma_f32_16x16x32_bf16 v[64:67], v[84:87], v[96:99], v[64:67]
    v_mfma_f32_16x16x32_bf16 v[60:63], v[84:87], v[92:95], v[60:63]
    v_mfma_f32_16x16x32_bf16 v[56:59], v[84:87], v[88:91], v[56:59]
    s_waitcnt lgkmcnt(3)
    v_mfma_f32_16x16x32_bf16 v[8:11], v[104:107], v[120:123], v[8:11]
    v_mfma_f32_16x16x32_bf16 v[12:15], v[104:107], v[124:127], v[12:15]
    v_mfma_f32_16x16x32_bf16 v[16:19], v[104:107], v[128:131], v[16:19]
    s_waitcnt lgkmcnt(0)
    s_barrier
    ds_read_b128 v[72:75], v154 offset:0
    v_mfma_f32_16x16x32_bf16 v[20:23], v[104:107], v[132:135], v[20:23]
    ds_read_b64_tr_b16 v[88:89], v244 offset:16384
    v_mfma_f32_16x16x32_bf16 v[36:39], v[108:111], v[132:135], v[36:39]
    ds_read_b64_tr_b16 v[90:91], v244 offset:17408
    v_mfma_f32_16x16x32_bf16 v[32:35], v[108:111], v[128:131], v[32:35]
    ds_read_b64_tr_b16 v[92:93], v245 offset:16384
    v_mfma_f32_16x16x32_bf16 v[28:31], v[108:111], v[124:127], v[28:31]
    ds_read_b64_tr_b16 v[94:95], v245 offset:17408
    v_mfma_f32_16x16x32_bf16 v[24:27], v[108:111], v[120:123], v[24:27]
    ds_read_b64_tr_b16 v[96:97], v246 offset:16384
    v_mfma_f32_16x16x32_bf16 v[40:43], v[112:115], v[120:123], v[40:43]
    ds_read_b64_tr_b16 v[98:99], v246 offset:17408
    v_mfma_f32_16x16x32_bf16 v[44:47], v[112:115], v[124:127], v[44:47]
    ds_read_b64_tr_b16 v[100:101], v247 offset:16384
    v_mfma_f32_16x16x32_bf16 v[48:51], v[112:115], v[128:131], v[48:51]
    ds_read_b64_tr_b16 v[102:103], v247 offset:17408
    v_mfma_f32_16x16x32_bf16 v[52:55], v[112:115], v[132:135], v[52:55]
    ds_read_b128 v[76:79], v154 offset:2048
    v_mfma_f32_16x16x32_bf16 v[68:71], v[116:119], v[132:135], v[68:71]
    ds_read_b128 v[80:83], v154 offset:4096
    v_mfma_f32_16x16x32_bf16 v[64:67], v[116:119], v[128:131], v[64:67]
    ds_read_b128 v[84:87], v154 offset:6144
    v_mfma_f32_16x16x32_bf16 v[60:63], v[116:119], v[124:127], v[60:63]
    v_mfma_f32_16x16x32_bf16 v[56:59], v[116:119], v[120:123], v[56:59]
    s_waitcnt lgkmcnt(3)
    v_mfma_f32_16x16x32_bf16 v[8:11], v[72:75], v[88:91], v[8:11]
    ds_read_b128 v[104:107], v155 offset:0
    v_mfma_f32_16x16x32_bf16 v[12:15], v[72:75], v[92:95], v[12:15]
    ds_read_b64_tr_b16 v[120:121], v244 offset:24576
    v_mfma_f32_16x16x32_bf16 v[16:19], v[72:75], v[96:99], v[16:19]
    ds_read_b64_tr_b16 v[122:123], v244 offset:25600
    v_mfma_f32_16x16x32_bf16 v[20:23], v[72:75], v[100:103], v[20:23]
    s_waitcnt lgkmcnt(3)
    ds_read_b64_tr_b16 v[124:125], v245 offset:24576
    v_mfma_f32_16x16x32_bf16 v[36:39], v[76:79], v[100:103], v[36:39]
    ds_read_b64_tr_b16 v[126:127], v245 offset:25600
    v_mfma_f32_16x16x32_bf16 v[32:35], v[76:79], v[96:99], v[32:35]
    ds_read_b64_tr_b16 v[128:129], v246 offset:24576
    v_mfma_f32_16x16x32_bf16 v[28:31], v[76:79], v[92:95], v[28:31]
    ds_read_b64_tr_b16 v[130:131], v246 offset:25600
    v_mfma_f32_16x16x32_bf16 v[24:27], v[76:79], v[88:91], v[24:27]
    ds_read_b64_tr_b16 v[132:133], v247 offset:24576
    v_mfma_f32_16x16x32_bf16 v[40:43], v[80:83], v[88:91], v[40:43]
    ds_read_b64_tr_b16 v[134:135], v247 offset:25600
    v_mfma_f32_16x16x32_bf16 v[44:47], v[80:83], v[92:95], v[44:47]
    ds_read_b128 v[108:111], v155 offset:2048
    v_mfma_f32_16x16x32_bf16 v[48:51], v[80:83], v[96:99], v[48:51]
    ds_read_b128 v[112:115], v155 offset:4096
    v_mfma_f32_16x16x32_bf16 v[52:55], v[80:83], v[100:103], v[52:55]
    ds_read_b128 v[116:119], v155 offset:6144
    v_mfma_f32_16x16x32_bf16 v[68:71], v[84:87], v[100:103], v[68:71]
    s_cmp_lg_u32 s52, 2
    s_cbranch_scc1 L_tch_31
    buffer_load_dword v184, v182, s[12:15], 0 offen
L_tch_31:
    v_mfma_f32_16x16x32_bf16 v[64:67], v[84:87], v[96:99], v[64:67]
    v_mfma_f32_16x16x32_bf16 v[60:63], v[84:87], v[92:95], v[60:63]
    v_mfma_f32_16x16x32_bf16 v[56:59], v[84:87], v[88:91], v[56:59]
    s_waitcnt lgkmcnt(3)
    v_mfma_f32_16x16x32_bf16 v[8:11], v[104:107], v[120:123], v[8:11]
    v_mfma_f32_16x16x32_bf16 v[12:15], v[104:107], v[124:127], v[12:15]
    v_mfma_f32_16x16x32_bf16 v[16:19], v[104:107], v[128:131], v[16:19]
    s_waitcnt lgkmcnt(0)
    s_barrier
    ds_read_b128 v[72:75], v152 offset:0
    v_mfma_f32_16x16x32_bf16 v[20:23], v[104:107], v[132:135], v[20:23]
    ds_read_b64_tr_b16 v[88:89], v240 offset:16384
    v_mfma_f32_16x16x32_bf16 v[36:39], v[108:111], v[132:135], v[36:39]
    ds_read_b64_tr_b16 v[90:91], v240 offset:17408
    v_mfma_f32_16x16x32_bf16 v[32:35], v[108:111], v[128:131], v[32:35]
    ds_read_b64_tr_b16 v[92:93], v241 offset:16384
    v_mfma_f32_16x16x32_bf16 v[28:31], v[108:111], v[124:127], v[28:31]
    ds_read_b64_tr_b16 v[94:95], v241 offset:17408
    v_mfma_f32_16x16x32_bf16 v[24:27], v[108:111], v[120:123], v[24:27]
    ds_read_b64_tr_b16 v[96:97], v242 offset:16384
    v_mfma_f32_16x16x32_bf16 v[40:43], v[112:115], v[120:123], v[40:43]
    ds_read_b64_tr_b16 v[98:99], v242 offset:17408
    v_mfma_f32_16x16x32_bf16 v[44:47], v[112:115], v[124:127], v[44:47]
    ds_read_b64_tr_b16 v[100:101], v243 offset:16384
    v_mfma_f32_16x16x32_bf16 v[48:51], v[112:115], v[128:131], v[48:51]
    ds_read_b64_tr_b16 v[102:103], v243 offset:17408
    v_mfma_f32_16x16x32_bf16 v[52:55], v[112:115], v[132:135], v[52:55]
    ds_read_b128 v[76:79], v152 offset:2048
    v_mfma_f32_16x16x32_bf16 v[68:71], v[116:119], v[132:135], v[68:71]
    ds_read_b128 v[80:83], v152 offset:4096
    v_mfma_f32_16x16x32_bf16 v[64:67], v[116:119], v[128:131], v[64:67]
    ds_read_b128 v[84:87], v152 offset:6144
    v_mfma_f32_16x16x32_bf16 v[60:63], v[116:119], v[124:127], v[60:63]
    v_mfma_f32_16x16x32_bf16 v[56:59], v[116:119], v[120:123], v[56:59]
    s_waitcnt lgkmcnt(3)
    v_mfma_f32_16x16x32_bf16 v[8:11], v[72:75], v[88:91], v[8:11]
    ds_read_b128 v[104:107], v153 offset:0
    v_mfma_f32_16x16x32_bf16 v[12:15], v[72:75], v[92:95], v[12:15]
    ds_read_b64_tr_b16 v[120:121], v240 offset:24576
    v_mfma_f32_16x16x32_bf16 v[16:19], v[72:75], v[96:99], v[16:19]
    ds_read_b64_tr_b16 v[122:123], v240 offset:25600
    v_mfma_f32_16x16x32_bf16 v[20:23], v[72:75], v[100:103], v[20:23]
    s_waitcnt lgkmcnt(3)
    ds_read_b64_tr_b16 v[124:125], v241 offset:24576
    v_mfma_f32_16x16x32_bf16 v[36:39], v[76:79], v[100:103], v[36:39]
    ds_read_b64_tr_b16 v[126:127], v241 offset:25600
    v_mfma_f32_16x16x32_bf16 v[32:35], v[76:79], v[96:99], v[32:35]
    ds_read_b64_tr_b16 v[128:129], v242 offset:24576
    v_mfma_f32_16x16x32_bf16 v[28:31], v[76:79], v[92:95], v[28:31]
    ds_read_b64_tr_b16 v[130:131], v242 offset:25600
    v_mfma_f32_16x16x32_bf16 v[24:27], v[76:79], v[88:91], v[24:27]
    ds_read_b64_tr_b16 v[132:133], v243 offset:24576
    v_mfma_f32_16x16x32_bf16 v[40:43], v[80:83], v[88:91], v[40:43]
    ds_read_b64_tr_b16 v[134:135], v243 offset:25600
    v_mfma_f32_16x16x32_bf16 v[44:47], v[80:83], v[92:95], v[44:47]
    ds_read_b128 v[108:111], v153 offset:2048
    v_mfma_f32_16x16x32_bf16 v[48:51], v[80:83], v[96:99], v[48:51]
    ds_read_b128 v[112:115], v153 offset:4096
    v_mfma_f32_16x16x32_bf16 v[52:55], v[80:83], v[100:103], v[52:55]
    ds_read_b128 v[116:119], v153 offset:6144
    v_mfma_f32_16x16x32_bf16 v[68:71], v[84:87], v[100:103], v[68:71]
    s_waitcnt vmcnt(0)
    ds_read_b64_tr_b16 v[136:137], v6 offset:0
    ds_read_b64_tr_b16 v[138:139], v6 offset:512
    ds_read_b64_tr_b16 v[140:141], v6 offset:32
    ds_read_b64_tr_b16 v[142:143], v6 offset:544
    ds_read_b64_tr_b16 v[144:145], v6 offset:64
    ds_read_b64_tr_b16 v[146:147], v6 offset:576
    ds_read_b64_tr_b16 v[148:149], v6 offset:96
    ds_read_b64_tr_b16 v[150:151], v6 offset:608
    v_mfma_f32_16x16x32_bf16 v[64:67], v[84:87], v[96:99], v[64:67]
    v_mfma_f32_16x16x32_bf16 v[60:63], v[84:87], v[92:95], v[60:63]
    v_mfma_f32_16x16x32_bf16 v[56:59], v[84:87], v[88:91], v[56:59]
    s_waitcnt lgkmcnt(11)
    s_lshl2_add_u32 s66, s65, 0
    s_mul_hi_u32 s67, s66, 0x33333334
    s_mul_i32 s67, s67, 343040
    s_lshl_b32 s66, s66, 10
    s_add_u32 s66, s66, s67
    s_add_u32 s66, s66, s64
    s_waitcnt lgkmcnt(6)
    buffer_store_dwordx4 v[136:139], v2, s[16:19], s66 offen sc1
    v_mfma_f32_16x16x32_bf16 v[8:11], v[104:107], v[120:123], v[8:11]
    v_mfma_f32_16x16x32_bf16 v[12:15], v[104:107], v[124:127], v[12:15]
    v_mfma_f32_16x16x32_bf16 v[16:19], v[104:107], v[128:131], v[16:19]
    s_waitcnt lgkmcnt(0)
    s_barrier
    ds_read_b128 v[72:75], v152 offset:32768
    v_mfma_f32_16x16x32_bf16 v[20:23], v[104:107], v[132:135], v[20:23]
    ds_read_b64_tr_b16 v[88:89], v240 offset:49152
    v_mfma_f32_16x16x32_bf16 v[36:39], v[108:111], v[132:135], v[36:39]
    ds_read_b64_tr_b16 v[90:91], v240 offset:50176
    v_mfma_f32_16x16x32_bf16 v[32:35], v[108:111], v[128:131], v[32:35]
    ds_read_b64_tr_b16 v[92:93], v241 offset:49152
    v_mfma_f32_16x16x32_bf16 v[28:31], v[108:111], v[124:127], v[28:31]
    ds_read_b64_tr_b16 v[94:95], v241 offset:50176
    v_mfma_f32_16x16x32_bf16 v[24:27], v[108:111], v[120:123], v[24:27]
    ds_read_b64_tr_b16 v[96:97], v242 offset:49152
    v_mfma_f32_16x16x32_bf16 v[40:43], v[112:115], v[120:123], v[40:43]
    ds_read_b64_tr_b16 v[98:99], v242 offset:50176
    v_mfma_f32_16x16x32_bf16 v[44:47], v[112:115], v[124:127], v[44:47]
    ds_read_b64_tr_b16 v[100:101], v243 offset:49152
    v_mfma_f32_16x16x32_bf16 v[48:51], v[112:115], v[128:131], v[48:51]
    ds_read_b64_tr_b16 v[102:103], v243 offset:50176
    v_mfma_f32_16x16x32_bf16 v[52:55], v[112:115], v[132:135], v[52:55]
    ds_read_b128 v[76:79], v152 offset:34816
    v_mfma_f32_16x16x32_bf16 v[68:71], v[116:119], v[132:135], v[68:71]
    ds_read_b128 v[80:83], v152 offset:36864
    s_lshl2_add_u32 s66, s65, 1
    s_mul_hi_u32 s67, s66, 0x33333334
    s_mul_i32 s67, s67, 343040
    s_lshl_b32 s66, s66, 10
    s_add_u32 s66, s66, s67
    s_add_u32 s66, s66, s64
    buffer_store_dwordx4 v[140:143], v2, s[16:19], s66 offen sc1
    v_mfma_f32_16x16x32_bf16 v[64:67], v[116:119], v[128:131], v[64:67]
    ds_read_b128 v[84:87], v152 offset:38912
    v_mfma_f32_16x16x32_bf16 v[60:63], v[116:119], v[124:127], v[60:63]
    v_mfma_f32_16x16x32_bf16 v[56:59], v[116:119], v[120:123], v[56:59]
    s_waitcnt lgkmcnt(3)
    s_lshl2_add_u32 s66, s65, 2
    s_mul_hi_u32 s67, s66, 0x33333334
    s_mul_i32 s67, s67, 343040
    s_lshl_b32 s66, s66, 10
    s_add_u32 s66, s66, s67
    s_add_u32 s66, s66, s64
    buffer_store_dwordx4 v[144:147], v2, s[16:19], s66 offen sc1
    v_mfma_f32_16x16x32_bf16 v[8:11], v[72:75], v[88:91], v[8:11]
    ds_read_b128 v[104:107], v153 offset:32768
    v_mfma_f32_16x16x32_bf16 v[12:15], v[72:75], v[92:95], v[12:15]
    ds_read_b64_tr_b16 v[120:121], v240 offset:57344
    v_mfma_f32_16x16x32_bf16 v[16:19], v[72:75], v[96:99], v[16:19]
    ds_read_b64_tr_b16 v[122:123], v240 offset:58368
    v_mfma_f32_16x16x32_bf16 v[20:23], v[72:75], v[100:103], v[20:23]
    s_waitcnt lgkmcnt(3)
    ds_read_b64_tr_b16 v[124:125], v241 offset:57344
    v_mfma_f32_16x16x32_bf16 v[36:39], v[76:79], v[100:103], v[36:39]
    ds_read_b64_tr_b16 v[126:127], v241 offset:58368
    v_mfma_f32_16x16x32_bf16 v[32:35], v[76:79], v[96:99], v[32:35]
    ds_read_b64_tr_b16 v[128:129], v242 offset:57344
    v_mfma_f32_16x16x32_bf16 v[28:31], v[76:79], v[92:95], v[28:31]
    ds_read_b64_tr_b16 v[130:131], v242 offset:58368
    v_mfma_f32_16x16x32_bf16 v[24:27], v[76:79], v[88:91], v[24:27]
    ds_read_b64_tr_b16 v[132:133], v243 offset:57344
    v_mfma_f32_16x16x32_bf16 v[40:43], v[80:83], v[88:91], v[40:43]
    ds_read_b64_tr_b16 v[134:135], v243 offset:58368
    v_mfma_f32_16x16x32_bf16 v[44:47], v[80:83], v[92:95], v[44:47]
    ds_read_b128 v[108:111], v153 offset:34816
    v_mfma_f32_16x16x32_bf16 v[48:51], v[80:83], v[96:99], v[48:51]
    ds_read_b128 v[112:115], v153 offset:36864
    v_mfma_f32_16x16x32_bf16 v[52:55], v[80:83], v[100:103], v[52:55]
    ds_read_b128 v[116:119], v153 offset:38912
    v_mfma_f32_16x16x32_bf16 v[68:71], v[84:87], v[100:103], v[68:71]
    s_lshl2_add_u32 s66, s65, 3
    s_mul_hi_u32 s67, s66, 0x33333334
    s_mul_i32 s67, s67, 343040
    s_lshl_b32 s66, s66, 10
    s_add_u32 s66, s66, s67
    s_add_u32 s66, s66, s64
    buffer_store_dwordx4 v[148:151], v2, s[16:19], s66 offen sc1
    v_mfma_f32_16x16x32_bf16 v[64:67], v[84:87], v[96:99], v[64:67]
    v_mfma_f32_16x16x32_bf16 v[60:63], v[84:87], v[92:95], v[60:63]
    v_mfma_f32_16x16x32_bf16 v[56:59], v[84:87], v[88:91], v[56:59]
    s_waitcnt lgkmcnt(3)
    v_mfma_f32_16x16x32_bf16 v[8:11], v[104:107], v[120:123], v[8:11]
    v_mfma_f32_16x16x32_bf16 v[12:15], v[104:107], v[124:127], v[12:15]
    v_mfma_f32_16x16x32_bf16 v[16:19], v[104:107], v[128:131], v[16:19]
    s_waitcnt lgkmcnt(0)
    s_barrier
    ds_read_b128 v[72:75], v154 offset:0
    v_mfma_f32_16x16x32_bf16 v[20:23], v[104:107], v[132:135], v[20:23]
    ds_read_b64_tr_b16 v[88:89], v244 offset:16384
    v_mfma_f32_16x16x32_bf16 v[36:39], v[108:111], v[132:135], v[36:39]
    ds_read_b64_tr_b16 v[90:91], v244 offset:17408
    v_mfma_f32_16x16x32_bf16 v[32:35], v[108:111], v[128:131], v[32:35]
    ds_read_b64_tr_b16 v[92:93], v245 offset:16384
    v_mfma_f32_16x16x32_bf16 v[28:31], v[108:111], v[124:127], v[28:31]
    ds_read_b64_tr_b16 v[94:95], v245 offset:17408
    v_mfma_f32_16x16x32_bf16 v[24:27], v[108:111], v[120:123], v[24:27]
    ds_read_b64_tr_b16 v[96:97], v246 offset:16384
    v_mfma_f32_16x16x32_bf16 v[40:43], v[112:115], v[120:123], v[40:43]
    ds_read_b64_tr_b16 v[98:99], v246 offset:17408
    v_mfma_f32_16x16x32_bf16 v[44:47], v[112:115], v[124:127], v[44:47]
    ds_read_b64_tr_b16 v[100:101], v247 offset:16384
    v_mfma_f32_16x16x32_bf16 v[48:51], v[112:115], v[128:131], v[48:51]
    ds_read_b64_tr_b16 v[102:103], v247 offset:17408
    v_mfma_f32_16x16x32_bf16 v[52:55], v[112:115], v[132:135], v[52:55]
    ds_read_b128 v[76:79], v154 offset:2048
    v_mfma_f32_16x16x32_bf16 v[68:71], v[116:119], v[132:135], v[68:71]
    ds_read_b128 v[80:83], v154 offset:4096
    v_mfma_f32_16x16x32_bf16 v[64:67], v[116:119], v[128:131], v[64:67]
    ds_read_b128 v[84:87], v154 offset:6144
    v_mfma_f32_16x16x32_bf16 v[60:63], v[116:119], v[124:127], v[60:63]
    v_mfma_f32_16x16x32_bf16 v[56:59], v[116:119], v[120:123], v[56:59]
    s_waitcnt lgkmcnt(3)
    v_mfma_f32_16x16x32_bf16 v[8:11], v[72:75], v[88:91], v[8:11]
    ds_read_b128 v[104:107], v155 offset:0
    v_mfma_f32_16x16x32_bf16 v[12:15], v[72:75], v[92:95], v[12:15]
    ds_read_b64_tr_b16 v[120:121], v244 offset:24576
    v_mfma_f32_16x16x32_bf16 v[16:19], v[72:75], v[96:99], v[16:19]
    ds_read_b64_tr_b16 v[122:123], v244 offset:25600
    v_mfma_f32_16x16x32_bf16 v[20:23], v[72:75], v[100:103], v[20:23]
    s_waitcnt lgkmcnt(3)
    ds_read_b64_tr_b16 v[124:125], v245 offset:24576
    v_mfma_f32_16x16x32_bf16 v[36:39], v[76:79], v[100:103], v[36:39]
    ds_read_b64_tr_b16 v[126:127], v245 offset:25600
    v_mfma_f32_16x16x32_bf16 v[32:35], v[76:79], v[96:99], v[32:35]
    ds_read_b64_tr_b16 v[128:129], v246 offset:24576
    v_mfma_f32_16x16x32_bf16 v[28:31], v[76:79], v[92:95], v[28:31]
    ds_read_b64_tr_b16 v[130:131], v246 offset:25600
    v_mfma_f32_16x16x32_bf16 v[24:27], v[76:79], v[88:91], v[24:27]
    ds_read_b64_tr_b16 v[132:133], v247 offset:24576
    v_mfma_f32_16x16x32_bf16 v[40:43], v[80:83], v[88:91], v[40:43]
    ds_read_b64_tr_b16 v[134:135], v247 offset:25600
    v_mfma_f32_16x16x32_bf16 v[44:47], v[80:83], v[92:95], v[44:47]
    ds_read_b128 v[108:111], v155 offset:2048
    v_mfma_f32_16x16x32_bf16 v[48:51], v[80:83], v[96:99], v[48:51]
    ds_read_b128 v[112:115], v155 offset:4096
    v_mfma_f32_16x16x32_bf16 v[52:55], v[80:83], v[100:103], v[52:55]
    ds_read_b128 v[116:119], v155 offset:6144
    v_mfma_f32_16x16x32_bf16 v[68:71], v[84:87], v[100:103], v[68:71]
    v_mfma_f32_16x16x32_bf16 v[64:67], v[84:87], v[96:99], v[64:67]
    v_mfma_f32_16x16x32_bf16 v[60:63], v[84:87], v[92:95], v[60:63]
    v_mfma_f32_16x16x32_bf16 v[56:59], v[84:87], v[88:91], v[56:59]
    s_waitcnt lgkmcnt(3)
    v_mfma_f32_16x16x32_bf16 v[8:11], v[104:107], v[120:123], v[8:11]
    v_mfma_f32_16x16x32_bf16 v[12:15], v[104:107], v[124:127], v[12:15]
    v_mfma_f32_16x16x32_bf16 v[16:19], v[104:107], v[128:131], v[16:19]
    s_waitcnt lgkmcnt(0)
    s_barrier
    ds_read_b128 v[72:75], v152 offset:0
    v_mfma_f32_16x16x32_bf16 v[20:23], v[104:107], v[132:135], v[20:23]
    ds_read_b64_tr_b16 v[88:89], v240 offset:16384
    v_mfma_f32_16x16x32_bf16 v[36:39], v[108:111], v[132:135], v[36:39]
    ds_read_b64_tr_b16 v[90:91], v240 offset:17408
    v_mfma_f32_16x16x32_bf16 v[32:35], v[108:111], v[128:131], v[32:35]
    ds_read_b64_tr_b16 v[92:93], v241 offset:16384
    v_mfma_f32_16x16x32_bf16 v[28:31], v[108:111], v[124:127], v[28:31]
    ds_read_b64_tr_b16 v[94:95], v241 offset:17408
    v_mfma_f32_16x16x32_bf16 v[24:27], v[108:111], v[120:123], v[24:27]
    ds_read_b64_tr_b16 v[96:97], v242 offset:16384
    v_mfma_f32_16x16x32_bf16 v[40:43], v[112:115], v[120:123], v[40:43]
    ds_read_b64_tr_b16 v[98:99], v242 offset:17408
    v_mfma_f32_16x16x32_bf16 v[44:47], v[112:115], v[124:127], v[44:47]
    ds_read_b64_tr_b16 v[100:101], v243 offset:16384
    v_mfma_f32_16x16x32_bf16 v[48:51], v[112:115], v[128:131], v[48:51]
    ds_read_b64_tr_b16 v[102:103], v243 offset:17408
    v_mfma_f32_16x16x32_bf16 v[52:55], v[112:115], v[132:135], v[52:55]
    ds_read_b128 v[76:79], v152 offset:2048
    v_mfma_f32_16x16x32_bf16 v[68:71], v[116:119], v[132:135], v[68:71]
    ds_read_b128 v[80:83], v152 offset:4096
    v_mfma_f32_16x16x32_bf16 v[64:67], v[116:119], v[128:131], v[64:67]
    ds_read_b128 v[84:87], v152 offset:6144
    v_mfma_f32_16x16x32_bf16 v[60:63], v[116:119], v[124:127], v[60:63]
    v_mfma_f32_16x16x32_bf16 v[56:59], v[116:119], v[120:123], v[56:59]
    s_waitcnt lgkmcnt(3)
    v_mfma_f32_16x16x32_bf16 v[8:11], v[72:75], v[88:91], v[8:11]
    ds_read_b128 v[104:107], v153 offset:0
    v_mfma_f32_16x16x32_bf16 v[12:15], v[72:75], v[92:95], v[12:15]
    ds_read_b64_tr_b16 v[120:121], v240 offset:24576
    v_mfma_f32_16x16x32_bf16 v[16:19], v[72:75], v[96:99], v[16:19]
    ds_read_b64_tr_b16 v[122:123], v240 offset:25600
    v_mfma_f32_16x16x32_bf16 v[20:23], v[72:75], v[100:103], v[20:23]
    s_waitcnt lgkmcnt(3)
    ds_read_b64_tr_b16 v[124:125], v241 offset:24576
    v_mfma_f32_16x16x32_bf16 v[36:39], v[76:79], v[100:103], v[36:39]
    ds_read_b64_tr_b16 v[126:127], v241 offset:25600
    v_mfma_f32_16x16x32_bf16 v[32:35], v[76:79], v[96:99], v[32:35]
    ds_read_b64_tr_b16 v[128:129], v242 offset:24576
    v_mfma_f32_16x16x32_bf16 v[28:31], v[76:79], v[92:95], v[28:31]
    ds_read_b64_tr_b16 v[130:131], v242 offset:25600
    v_mfma_f32_16x16x32_bf16 v[24:27], v[76:79], v[88:91], v[24:27]
    ds_read_b64_tr_b16 v[132:133], v243 offset:24576
    v_mfma_f32_16x16x32_bf16 v[40:43], v[80:83], v[88:91], v[40:43]
    ds_read_b64_tr_b16 v[134:135], v243 offset:25600
    v_mfma_f32_16x16x32_bf16 v[44:47], v[80:83], v[92:95], v[44:47]
    ds_read_b128 v[108:111], v153 offset:2048
    v_mfma_f32_16x16x32_bf16 v[48:51], v[80:83], v[96:99], v[48:51]
    ds_read_b128 v[112:115], v153 offset:4096
    v_mfma_f32_16x16x32_bf16 v[52:55], v[80:83], v[100:103], v[52:55]
    ds_read_b128 v[116:119], v153 offset:6144
    v_mfma_f32_16x16x32_bf16 v[68:71], v[84:87], v[100:103], v[68:71]
    v_mfma_f32_16x16x32_bf16 v[64:67], v[84:87], v[96:99], v[64:67]
    v_mfma_f32_16x16x32_bf16 v[60:63], v[84:87], v[92:95], v[60:63]
    v_mfma_f32_16x16x32_bf16 v[56:59], v[84:87], v[88:91], v[56:59]
    s_waitcnt lgkmcnt(3)
    s_waitcnt vmcnt(0)
    v_mfma_f32_16x16x32_bf16 v[8:11], v[104:107], v[120:123], v[8:11]
    v_mfma_f32_16x16x32_bf16 v[12:15], v[104:107], v[124:127], v[12:15]
    v_mfma_f32_16x16x32_bf16 v[16:19], v[104:107], v[128:131], v[16:19]
    s_waitcnt lgkmcnt(0)
    s_barrier
    ds_read_b128 v[72:75], v152 offset:32768
    v_mfma_f32_16x16x32_bf16 v[20:23], v[104:107], v[132:135], v[20:23]
    ds_read_b64_tr_b16 v[88:89], v240 offset:49152
    v_mfma_f32_16x16x32_bf16 v[36:39], v[108:111], v[132:135], v[36:39]
    ds_read_b64_tr_b16 v[90:91], v240 offset:50176
    v_mfma_f32_16x16x32_bf16 v[32:35], v[108:111], v[128:131], v[32:35]
    ds_read_b64_tr_b16 v[92:93], v241 offset:49152
    v_mfma_f32_16x16x32_bf16 v[28:31], v[108:111], v[124:127], v[28:31]
    ds_read_b64_tr_b16 v[94:95], v241 offset:50176
    v_mfma_f32_16x16x32_bf16 v[24:27], v[108:111], v[120:123], v[24:27]
    ds_read_b64_tr_b16 v[96:97], v242 offset:49152
    v_mfma_f32_16x16x32_bf16 v[40:43], v[112:115], v[120:123], v[40:43]
    ds_read_b64_tr_b16 v[98:99], v242 offset:50176
    v_mfma_f32_16x16x32_bf16 v[44:47], v[112:115], v[124:127], v[44:47]
    ds_read_b64_tr_b16 v[100:101], v243 offset:49152
    v_mfma_f32_16x16x32_bf16 v[48:51], v[112:115], v[128:131], v[48:51]
    ds_read_b64_tr_b16 v[102:103], v243 offset:50176
    v_mfma_f32_16x16x32_bf16 v[52:55], v[112:115], v[132:135], v[52:55]
    ds_read_b128 v[76:79], v152 offset:34816
    v_mfma_f32_16x16x32_bf16 v[68:71], v[116:119], v[132:135], v[68:71]
    ds_read_b128 v[80:83], v152 offset:36864
    v_mfma_f32_16x16x32_bf16 v[64:67], v[116:119], v[128:131], v[64:67]
    ds_read_b128 v[84:87], v152 offset:38912
    v_mfma_f32_16x16x32_bf16 v[60:63], v[116:119], v[124:127], v[60:63]
    v_mfma_f32_16x16x32_bf16 v[56:59], v[116:119], v[120:123], v[56:59]
    s_waitcnt lgkmcnt(3)
    v_mfma_f32_16x16x32_bf16 v[8:11], v[72:75], v[88:91], v[8:11]
    ds_read_b128 v[104:107], v153 offset:32768
    v_mfma_f32_16x16x32_bf16 v[12:15], v[72:75], v[92:95], v[12:15]
    ds_read_b64_tr_b16 v[120:121], v240 offset:57344
    v_mfma_f32_16x16x32_bf16 v[16:19], v[72:75], v[96:99], v[16:19]
    ds_read_b64_tr_b16 v[122:123], v240 offset:58368
    v_mfma_f32_16x16x32_bf16 v[20:23], v[72:75], v[100:103], v[20:23]
    s_waitcnt lgkmcnt(3)
    ds_read_b64_tr_b16 v[124:125], v241 offset:57344
    v_mfma_f32_16x16x32_bf16 v[36:39], v[76:79], v[100:103], v[36:39]
    ds_read_b64_tr_b16 v[126:127], v241 offset:58368
    v_mfma_f32_16x16x32_bf16 v[32:35], v[76:79], v[96:99], v[32:35]
    ds_read_b64_tr_b16 v[128:129], v242 offset:57344
    v_mfma_f32_16x16x32_bf16 v[28:31], v[76:79], v[92:95], v[28:31]
    ds_read_b64_tr_b16 v[130:131], v242 offset:58368
    v_mfma_f32_16x16x32_bf16 v[24:27], v[76:79], v[88:91], v[24:27]
    ds_read_b64_tr_b16 v[132:133], v243 offset:57344
    v_mfma_f32_16x16x32_bf16 v[40:43], v[80:83], v[88:91], v[40:43]
    ds_read_b64_tr_b16 v[134:135], v243 offset:58368
    v_mfma_f32_16x16x32_bf16 v[44:47], v[80:83], v[92:95], v[44:47]
    ds_read_b128 v[108:111], v153 offset:34816
    v_mfma_f32_16x16x32_bf16 v[48:51], v[80:83], v[96:99], v[48:51]
    ds_read_b128 v[112:115], v153 offset:36864
    v_mfma_f32_16x16x32_bf16 v[52:55], v[80:83], v[100:103], v[52:55]
    ds_read_b128 v[116:119], v153 offset:38912
    v_mfma_f32_16x16x32_bf16 v[68:71], v[84:87], v[100:103], v[68:71]
    s_cmp_lg_u32 s52, 0
    s_cbranch_scc1 L_nodb_32
    s_bfe_u32 s66, s2, 0x20003
    s_lshl_b32 s66, s66, 8
    s_add_u32 s66, s66, 20160512
    s_mov_b64 exec, 1
    buffer_atomic_add v1, v3, s[16:19], s66 offen sc1
    s_mov_b64 exec, -1
L_nodb_32:
    v_mfma_f32_16x16x32_bf16 v[64:67], v[84:87], v[96:99], v[64:67]
    v_mfma_f32_16x16x32_bf16 v[60:63], v[84:87], v[92:95], v[60:63]
    v_mfma_f32_16x16x32_bf16 v[56:59], v[84:87], v[88:91], v[56:59]
    s_waitcnt lgkmcnt(3)
    v_mfma_f32_16x16x32_bf16 v[8:11], v[104:107], v[120:123], v[8:11]
    v_mfma_f32_16x16x32_bf16 v[12:15], v[104:107], v[124:127], v[12:15]
    v_mfma_f32_16x16x32_bf16 v[16:19], v[104:107], v[128:131], v[16:19]
    s_waitcnt lgkmcnt(0)
    s_barrier
    ds_read_b128 v[72:75], v154 offset:0
    v_mfma_f32_16x16x32_bf16 v[20:23], v[104:107], v[132:135], v[20:23]
    ds_read_b64_tr_b16 v[88:89], v244 offset:16384
    v_mfma_f32_16x16x32_bf16 v[36:39], v[108:111], v[132:135], v[36:39]
    ds_read_b64_tr_b16 v[90:91], v244 offset:17408
    v_mfma_f32_16x16x32_bf16 v[32:35], v[108:111], v[128:131], v[32:35]
    ds_read_b64_tr_b16 v[92:93], v245 offset:16384
    v_mfma_f32_16x16x32_bf16 v[28:31], v[108:111], v[124:127], v[28:31]
    ds_read_b64_tr_b16 v[94:95], v245 offset:17408
    v_mfma_f32_16x16x32_bf16 v[24:27], v[108:111], v[120:123], v[24:27]
    ds_read_b64_tr_b16 v[96:97], v246 offset:16384
    v_mfma_f32_16x16x32_bf16 v[40:43], v[112:115], v[120:123], v[40:43]
    ds_read_b64_tr_b16 v[98:99], v246 offset:17408
    v_mfma_f32_16x16x32_bf16 v[44:47], v[112:115], v[124:127], v[44:47]
    ds_read_b64_tr_b16 v[100:101], v247 offset:16384
    v_mfma_f32_16x16x32_bf16 v[48:51], v[112:115], v[128:131], v[48:51]
    ds_read_b64_tr_b16 v[102:103], v247 offset:17408
    v_mfma_f32_16x16x32_bf16 v[52:55], v[112:115], v[132:135], v[52:55]
    ds_read_b128 v[76:79], v154 offset:2048
    v_mfma_f32_16x16x32_bf16 v[68:71], v[116:119], v[132:135], v[68:71]
    ds_read_b128 v[80:83], v154 offset:4096
    v_mfma_f32_16x16x32_bf16 v[64:67], v[116:119], v[128:131], v[64:67]
    ds_read_b128 v[84:87], v154 offset:6144
    v_mfma_f32_16x16x32_bf16 v[60:63], v[116:119], v[124:127], v[60:63]
    v_mfma_f32_16x16x32_bf16 v[56:59], v[116:119], v[120:123], v[56:59]
    s_waitcnt lgkmcnt(3)
    v_mfma_f32_16x16x32_bf16 v[8:11], v[72:75], v[88:91], v[8:11]
    ds_read_b128 v[104:107], v155 offset:0
    v_mfma_f32_16x16x32_bf16 v[12:15], v[72:75], v[92:95], v[12:15]
    ds_read_b64_tr_b16 v[120:121], v244 offset:24576
    v_mfma_f32_16x16x32_bf16 v[16:19], v[72:75], v[96:99], v[16:19]
    ds_read_b64_tr_b16 v[122:123], v244 offset:25600
    v_mfma_f32_16x16x32_bf16 v[20:23], v[72:75], v[100:103], v[20:23]
    s_waitcnt lgkmcnt(3)
    ds_read_b64_tr_b16 v[124:125], v245 offset:24576
    v_mfma_f32_16x16x32_bf16 v[36:39], v[76:79], v[100:103], v[36:39]
    ds_read_b64_tr_b16 v[126:127], v245 offset:25600
    v_mfma_f32_16x16x32_bf16 v[32:35], v[76:79], v[96:99], v[32:35]
    ds_read_b64_tr_b16 v[128:129], v246 offset:24576
    v_mfma_f32_16x16x32_bf16 v[28:31], v[76:79], v[92:95], v[28:31]
    ds_read_b64_tr_b16 v[130:131], v246 offset:25600
    v_mfma_f32_16x16x32_bf16 v[24:27], v[76:79], v[88:91], v[24:27]
    ds_read_b64_tr_b16 v[132:133], v247 offset:24576
    v_mfma_f32_16x16x32_bf16 v[40:43], v[80:83], v[88:91], v[40:43]
    ds_read_b64_tr_b16 v[134:135], v247 offset:25600
    v_mfma_f32_16x16x32_bf16 v[44:47], v[80:83], v[92:95], v[44:47]
    ds_read_b128 v[108:111], v155 offset:2048
    v_mfma_f32_16x16x32_bf16 v[48:51], v[80:83], v[96:99], v[48:51]
    ds_read_b128 v[112:115], v155 offset:4096
    v_mfma_f32_16x16x32_bf16 v[52:55], v[80:83], v[100:103], v[52:55]
    ds_read_b128 v[116:119], v155 offset:6144
    v_mfma_f32_16x16x32_bf16 v[68:71], v[84:87], v[100:103], v[68:71]
    v_mfma_f32_16x16x32_bf16 v[64:67], v[84:87], v[96:99], v[64:67]
    v_mfma_f32_16x16x32_bf16 v[60:63], v[84:87], v[92:95], v[60:63]
    v_mfma_f32_16x16x32_bf16 v[56:59], v[84:87], v[88:91], v[56:59]
    s_waitcnt lgkmcnt(3)
    v_mfma_f32_16x16x32_bf16 v[8:11], v[104:107], v[120:123], v[8:11]
    v_mfma_f32_16x16x32_bf16 v[12:15], v[104:107], v[124:127], v[12:15]
    v_mfma_f32_16x16x32_bf16 v[16:19], v[104:107], v[128:131], v[16:19]
    s_waitcnt lgkmcnt(0)
    s_barrier
    ds_read_b128 v[72:75], v152 offset:0
    v_mfma_f32_16x16x32_bf16 v[20:23], v[104:107], v[132:135], v[20:23]
    ds_read_b64_tr_b16 v[88:89], v240 offset:16384
    v_mfma_f32_16x16x32_bf16 v[36:39], v[108:111], v[132:135], v[36:39]
    ds_read_b64_tr_b16 v[90:91], v240 offset:17408
    v_mfma_f32_16x16x32_bf16 v[32:35], v[108:111], v[128:131], v[32:35]
    ds_read_b64_tr_b16 v[92:93], v241 offset:16384
    v_mfma_f32_16x16x32_bf16 v[28:31], v[108:111], v[124:127], v[28:31]
    ds_read_b64_tr_b16 v[94:95], v241 offset:17408
    v_mfma_f32_16x16x32_bf16 v[24:27], v[108:111], v[120:123], v[24:27]
    ds_read_b64_tr_b16 v[96:97], v242 offset:16384
    v_mfma_f32_16x16x32_bf16 v[40:43], v[112:115], v[120:123], v[40:43]
    ds_read_b64_tr_b16 v[98:99], v242 offset:17408
    v_mfma_f32_16x16x32_bf16 v[44:47], v[112:115], v[124:127], v[44:47]
    ds_read_b64_tr_b16 v[100:101], v243 offset:16384
    v_mfma_f32_16x16x32_bf16 v[48:51], v[112:115], v[128:131], v[48:51]
    ds_read_b64_tr_b16 v[102:103], v243 offset:17408
    v_mfma_f32_16x16x32_bf16 v[52:55], v[112:115], v[132:135], v[52:55]
    ds_read_b128 v[76:79], v152 offset:2048
    v_mfma_f32_16x16x32_bf16 v[68:71], v[116:119], v[132:135], v[68:71]
    ds_read_b128 v[80:83], v152 offset:4096
    v_mfma_f32_16x16x32_bf16 v[64:67], v[116:119], v[128:131], v[64:67]
    ds_read_b128 v[84:87], v152 offset:6144
    v_mfma_f32_16x16x32_bf16 v[60:63], v[116:119], v[124:127], v[60:63]
    v_mfma_f32_16x16x32_bf16 v[56:59], v[116:119], v[120:123], v[56:59]
    s_waitcnt lgkmcnt(3)
    v_mfma_f32_16x16x32_bf16 v[8:11], v[72:75], v[88:91], v[8:11]
    ds_read_b128 v[104:107], v153 offset:0
    v_mfma_f32_16x16x32_bf16 v[12:15], v[72:75], v[92:95], v[12:15]
    ds_read_b64_tr_b16 v[120:121], v240 offset:24576
    v_mfma_f32_16x16x32_bf16 v[16:19], v[72:75], v[96:99], v[16:19]
    ds_read_b64_tr_b16 v[122:123], v240 offset:25600
    v_mfma_f32_16x16x32_bf16 v[20:23], v[72:75], v[100:103], v[20:23]
    s_waitcnt lgkmcnt(3)
    ds_read_b64_tr_b16 v[124:125], v241 offset:24576
    v_mfma_f32_16x16x32_bf16 v[36:39], v[76:79], v[100:103], v[36:39]
    ds_read_b64_tr_b16 v[126:127], v241 offset:25600
    v_mfma_f32_16x16x32_bf16 v[32:35], v[76:79], v[96:99], v[32:35]
    ds_read_b64_tr_b16 v[128:129], v242 offset:24576
    v_mfma_f32_16x16x32_bf16 v[28:31], v[76:79], v[92:95], v[28:31]
    ds_read_b64_tr_b16 v[130:131], v242 offset:25600
    v_mfma_f32_16x16x32_bf16 v[24:27], v[76:79], v[88:91], v[24:27]
    ds_read_b64_tr_b16 v[132:133], v243 offset:24576
    v_mfma_f32_16x16x32_bf16 v[40:43], v[80:83], v[88:91], v[40:43]
    ds_read_b64_tr_b16 v[134:135], v243 offset:25600
    v_mfma_f32_16x16x32_bf16 v[44:47], v[80:83], v[92:95], v[44:47]
    ds_read_b128 v[108:111], v153 offset:2048
    v_mfma_f32_16x16x32_bf16 v[48:51], v[80:83], v[96:99], v[48:51]
    ds_read_b128 v[112:115], v153 offset:4096
    v_mfma_f32_16x16x32_bf16 v[52:55], v[80:83], v[100:103], v[52:55]
    ds_read_b128 v[116:119], v153 offset:6144
    v_mfma_f32_16x16x32_bf16 v[68:71], v[84:87], v[100:103], v[68:71]
    v_mfma_f32_16x16x32_bf16 v[64:67], v[84:87], v[96:99], v[64:67]
    v_mfma_f32_16x16x32_bf16 v[60:63], v[84:87], v[92:95], v[60:63]
    v_mfma_f32_16x16x32_bf16 v[56:59], v[84:87], v[88:91], v[56:59]
    s_waitcnt lgkmcnt(3)
    v_mfma_f32_16x16x32_bf16 v[8:11], v[104:107], v[120:123], v[8:11]
    v_mfma_f32_16x16x32_bf16 v[12:15], v[104:107], v[124:127], v[12:15]
    v_mfma_f32_16x16x32_bf16 v[16:19], v[104:107], v[128:131], v[16:19]
    v_mfma_f32_16x16x32_bf16 v[20:23], v[104:107], v[132:135], v[20:23]
    s_waitcnt lgkmcnt(0)
    v_mfma_f32_16x16x32_bf16 v[36:39], v[108:111], v[132:135], v[36:39]
    v_mfma_f32_16x16x32_bf16 v[32:35], v[108:111], v[128:131], v[32:35]
    v_mfma_f32_16x16x32_bf16 v[28:31], v[108:111], v[124:127], v[28:31]
    v_mfma_f32_16x16x32_bf16 v[24:27], v[108:111], v[120:123], v[24:27]
    v_mfma_f32_16x16x32_bf16 v[40:43], v[112:115], v[120:123], v[40:43]
    v_mfma_f32_16x16x32_bf16 v[44:47], v[112:115], v[124:127], v[44:47]
    v_mfma_f32_16x16x32_bf16 v[48:51], v[112:115], v[128:131], v[48:51]
    v_mfma_f32_16x16x32_bf16 v[52:55], v[112:115], v[132:135], v[52:55]
    v_mfma_f32_16x16x32_bf16 v[68:71], v[116:119], v[132:135], v[68:71]
    v_mfma_f32_16x16x32_bf16 v[64:67], v[116:119], v[128:131], v[64:67]
    v_mfma_f32_16x16x32_bf16 v[60:63], v[116:119], v[124:127], v[60:63]
    v_mfma_f32_16x16x32_bf16 v[56:59], v[116:119], v[120:123], v[56:59]
    s_waitcnt lgkmcnt(0)
    s_barrier
    s_add_u32 m0, s97, 49152
    s_add_u32 s71, s96, 786432
    s_sub_u32 s70, s71, 1966080
    s_cselect_b32 s71, s71, s70
    buffer_load_dwordx4 v157, s[12:15], s71 offen offset:0  lds
    buffer_load_dwordx4 v158, s[12:15], s71 offen offset:1024  lds
    buffer_load_dwordx4 v159, s[12:15], s71 offen offset:2048  lds
    s_add_u32 m0, s97, 52224
    s_add_u32 s71, s96, 835584
    s_sub_u32 s70, s71, 1966080
    s_cselect_b32 s71, s71, s70
    buffer_load_dwordx4 v157, s[12:15], s71 offen offset:0  lds
    buffer_load_dwordx4 v158, s[12:15], s71 offen offset:1024  lds
    buffer_load_dwordx4 v159, s[12:15], s71 offen offset:2048  lds
    v_cvt_pk_bf16_f32 v72, v8, v9
    v_cvt_pk_bf16_f32 v73, v10, v11
    v_cvt_pk_bf16_f32 v74, v12, v13
    v_cvt_pk_bf16_f32 v75, v14, v15
    v_cvt_pk_bf16_f32 v76, v16, v17
    v_cvt_pk_bf16_f32 v77, v18, v19
    v_cvt_pk_bf16_f32 v78, v20, v21
    v_cvt_pk_bf16_f32 v79, v22, v23
    v_cvt_pk_bf16_f32 v80, v24, v25
    v_cvt_pk_bf16_f32 v81, v26, v27
    v_cvt_pk_bf16_f32 v82, v28, v29
    v_cvt_pk_bf16_f32 v83, v30, v31
    v_cvt_pk_bf16_f32 v84, v32, v33
    v_cvt_pk_bf16_f32 v85, v34, v35
    v_cvt_pk_bf16_f32 v86, v36, v37
    v_cvt_pk_bf16_f32 v87, v38, v39
    v_permlane16_swap_b32 v72, v74
    v_permlane16_swap_b32 v73, v75
    v_permlane16_swap_b32 v76, v78
    v_permlane16_swap_b32 v77, v79
    v_permlane16_swap_b32 v80, v82
    v_permlane16_swap_b32 v81, v83
    v_permlane16_swap_b32 v84, v86
    v_permlane16_swap_b32 v85, v87
    s_add_u32 s66, s72, 0
    buffer_store_dwordx4 v[72:75], v156, s[16:19], s66 offen offset:0 sc1
    s_add_u32 s66, s72, 0
    buffer_store_dwordx4 v[76:79], v156, s[16:19], s66 offen offset:512 sc1
    s_add_u32 m0, s97, 24576
    s_add_u32 s71, s96, 1179648
    s_sub_u32 s70, s71, 1966080
    s_cselect_b32 s71, s71, s70
    buffer_load_dwordx4 v157, s[12:15], s71 offen offset:0  lds
    buffer_load_dwordx4 v158, s[12:15], s71 offen offset:1024  lds
    buffer_load_dwordx4 v159, s[12:15], s71 offen offset:2048  lds
    s_add_u32 m0, s97, 27648
    s_add_u32 s71, s96, 1228800
    s_sub_u32 s70, s71, 1966080
    s_cselect_b32 s71, s71, s70
    buffer_load_dwordx4 v157, s[12:15], s71 offen offset:0  lds
    buffer_load_dwordx4 v158, s[12:15], s71 offen offset:1024  lds
    buffer_load_dwordx4 v159, s[12:15], s71 offen offset:2048  lds
    v_cvt_pk_bf16_f32 v88, v40, v41
    v_cvt_pk_bf16_f32 v89, v42, v43
    v_cvt_pk_bf16_f32 v90, v44, v45
    v_cvt_pk_bf16_f32 v91, v46, v47
    v_cvt_pk_bf16_f32 v92, v48, v49
    v_cvt_pk_bf16_f32 v93, v50, v51
    v_cvt_pk_bf16_f32 v94, v52, v53
    v_cvt_pk_bf16_f32 v95, v54, v55
    v_cvt_pk_bf16_f32 v96, v56, v57
    v_cvt_pk_bf16_f32 v97, v58, v59
    v_cvt_pk_bf16_f32 v98, v60, v61
    v_cvt_pk_bf16_f32 v99, v62, v63
    v_cvt_pk_bf16_f32 v100, v64, v65
    v_cvt_pk_bf16_f32 v101, v66, v67
    v_cvt_pk_bf16_f32 v102, v68, v69
    v_cvt_pk_bf16_f32 v103, v70, v71
    v_permlane16_swap_b32 v88, v90
    v_permlane16_swap_b32 v89, v91
    v_permlane16_swap_b32 v92, v94
    v_permlane16_swap_b32 v93, v95
    v_permlane16_swap_b32 v96, v98
    v_permlane16_swap_b32 v97, v99
    v_permlane16_swap_b32 v100, v102
    v_permlane16_swap_b32 v101, v103
    s_waitcnt vmcnt(8)
    ds_add_u32 v7, v1 offset:16
    s_add_u32 s66, s72, 20480
    buffer_store_dwordx4 v[80:83], v156, s[16:19], s66 offen offset:0 sc1
    s_add_u32 s66, s72, 20480
    buffer_store_dwordx4 v[84:87], v156, s[16:19], s66 offen offset:512 sc1
    s_add_u32 m0, s97, 0
    s_add_u32 s71, s96, 1572864
    s_sub_u32 s70, s71, 1966080
    s_cselect_b32 s71, s71, s70
    buffer_load_dwordx4 v157, s[12:15], s71 offen offset:0  lds
    buffer_load_dwordx4 v158, s[12:15], s71 offen offset:1024  lds
    buffer_load_dwordx4 v159, s[12:15], s71 offen offset:2048  lds
    s_add_u32 m0, s97, 3072
    s_add_u32 s71, s96, 1622016
    s_sub_u32 s70, s71, 1966080
    s_cselect_b32 s71, s71, s70
    buffer_load_dwordx4 v157, s[12:15], s71 offen offset:0  lds
    buffer_load_dwordx4 v158, s[12:15], s71 offen offset:1024  lds
    buffer_load_dwordx4 v159, s[12:15], s71 offen offset:2048  lds
    s_waitcnt vmcnt(8)
    ds_add_u32 v7, v1 offset:20
    s_cmp_lg_u32 s52, 0
    s_cbranch_scc1 L_db_33
    s_load_dword s8, s[6:7], 0
    s_load_dword s9, s[6:7], 256
    s_load_dword s10, s[6:7], 512
    s_load_dword s11, s[6:7], 768
L_db_33:
    s_add_u32 s66, s72, 40960
    buffer_store_dwordx4 v[88:91], v156, s[16:19], s66 offen offset:0 sc1
    s_add_u32 s66, s72, 40960
    buffer_store_dwordx4 v[92:95], v156, s[16:19], s66 offen offset:512 sc1
    s_add_u32 s66, s72, 61440
    buffer_store_dwordx4 v[96:99], v156, s[16:19], s66 offen offset:0 sc1
    s_add_u32 s66, s72, 61440
    buffer_store_dwordx4 v[100:103], v156, s[16:19], s66 offen offset:512 sc1
    s_waitcnt vmcnt(4)
    ds_add_u32 v7, v1 offset:24
    s_cmp_lg_u32 s52, 0
    s_cbranch_scc1 L_db_34
    s_waitcnt lgkmcnt(0)
    s_min_u32 s8, s8, s9
    s_min_u32 s8, s8, s10
    s_min_u32 s8, s8, s11
    s_cmp_lt_u32 s8, 64
    s_cbranch_scc1 L_db_34
    ds_add_u32 v7, v1 offset:4
L_db_34:
    s_branch L_qjoin
L_qg:
    s_lshl_b32 s66, s59, 12
    v_and_b32 v126, 31, v0
    v_lshrrev_b32 v127, 5, v0
    v_bfe_u32 v128, v0, 1, 3
    v_xor_b32 v127, v127, v128
    v_lshl_add_u32 v126, v126, 7, s66
    v_xor_b32 v128, 0, v127
    v_lshl_add_u32 v104, v128, 4, v126
    v_add_u32 v108, 0x10000, v104
    v_xor_b32 v128, 2, v127
    v_lshl_add_u32 v105, v128, 4, v126
    v_add_u32 v109, 0x10000, v105
    v_xor_b32 v128, 4, v127
    v_lshl_add_u32 v106, v128, 4, v126
    v_add_u32 v110, 0x10000, v106
    v_xor_b32 v128, 6, v127
    v_lshl_add_u32 v107, v128, 4, v126
    v_add_u32 v111, 0x10000, v107
    v_lshrrev_b32 v126, 5, v0
    v_lshlrev_b32 v112, 4, v126
    v_add_u32 v113, 0x10000, v112
    v_mov_b32 v72, 0
    v_mov_b32 v73, 0
    v_mov_b32 v74, 0
    v_mov_b32 v75, 0
    s_mov_b32 s72, 0x3f803f80
    s_lshl2_add_u32 s66, s53, s59
    s_mul_i32 s66, s66, 9472
    s_add_u32 s66, s66, 19570688
    v_lshrrev_b32 v126, 3, v0
    v_lshl_add_u32 v126, v126, 7, v2
    buffer_store_dwordx4 v[72:75], v126, s[16:19], s66 offen sc1
    s_add_u32 s66, s66, 2048
    buffer_store_dwordx4 v[72:75], v126, s[16:19], s66 offen sc1
    s_add_u32 s66, s66, 2048
    buffer_store_dwordx4 v[72:75], v126, s[16:19], s66 offen sc1
    s_add_u32 s66, s66, 2048
    buffer_store_dwordx4 v[72:75], v126, s[16:19], s66 offen sc1
    s_add_u32 s66, s66, 2048
    s_mov_b32 exec_hi, 0xff
    buffer_store_dwordx4 v[72:75], v126, s[16:19], s66 offen sc1
    s_add_u32 s66, s66, 2048
    s_mov_b32 exec_hi, 0
    s_lshl2_add_u32 s73, s53, s59
    s_lshl_b32 s73, s73, 7
    s_add_u32 s73, s73, 19562496
    v_mov_b32 v127, 0xbf800000
    buffer_store_dword v127, v178, s[16:19], s73 offen sc1
    s_mov_b64 exec, -1
    s_waitcnt lgkmcnt(0)
    s_barrier
    ds_read_b128 v[8:11], v104 offset:0
    ds_read_b128 v[12:15], v112 offset:16384
    ds_read_b128 v[16:19], v105 offset:0
    ds_read_b128 v[20:23], v112 offset:16416
    ds_read_b128 v[24:27], v106 offset:0
    ds_read_b128 v[28:31], v112 offset:16448
    ds_read_b128 v[32:35], v107 offset:0
    ds_read_b128 v[36:39], v112 offset:16480
    s_waitcnt lgkmcnt(6)
    v_and_b32 v80, 0xffff, v12
    v_and_b32 v12, 0xffff0000, v12
    v_and_b32 v81, 0xffff, v13
    v_and_b32 v13, 0xffff0000, v13
    v_and_b32 v82, 0xffff, v14
    v_and_b32 v14, 0xffff0000, v14
    v_and_b32 v83, 0xffff, v15
    v_and_b32 v15, 0xffff0000, v15
    v_dot2_f32_bf16 v80, v8, v80, 0
    v_dot2_f32_bf16 v12, v8, v12, 0
    v_dot2_f32_bf16 v81, v9, v81, 0
    v_dot2_f32_bf16 v13, v9, v13, 0
    v_dot2_f32_bf16 v82, v10, v82, 0
    v_dot2_f32_bf16 v14, v10, v14, 0
    v_dot2_f32_bf16 v83, v11, v83, 0
    v_dot2_f32_bf16 v15, v11, v15, 0
    v_cvt_pk_bf16_f32 v80, v80, v12
    v_cvt_pk_bf16_f32 v81, v81, v13
    v_cvt_pk_bf16_f32 v82, v82, v14
    v_cvt_pk_bf16_f32 v83, v83, v15
    v_dot2_f32_bf16 v72, v80, s72, v72
    v_dot2_f32_bf16 v73, v81, s72, v73
    v_dot2_f32_bf16 v74, v82, s72, v74
    v_dot2_f32_bf16 v75, v83, s72, v75
    s_lshl_b32 s66, s59, 12
    s_add_u32 m0, s66, 122880
    s_nop 0
    buffer_load_dwordx4 v5, s[20:23], s60 offen  lds
    s_add_u32 m0, s66, 123904
    s_nop 0
    buffer_load_dwordx4 v5, s[20:23], s61 offen  lds
    s_add_u32 m0, s66, 124928
    s_nop 0
    buffer_load_dwordx4 v5, s[20:23], s62 offen  lds
    s_add_u32 m0, s66, 125952
    s_nop 0
    buffer_load_dwordx4 v5, s[20:23], s63 offen  lds
    s_waitcnt lgkmcnt(4)
    v_and_b32 v80, 0xffff, v20
    v_and_b32 v20, 0xffff0000, v20
    v_and_b32 v81, 0xffff, v21
    v_and_b32 v21, 0xffff0000, v21
    v_and_b32 v82, 0xffff, v22
    v_and_b32 v22, 0xffff0000, v22
    v_and_b32 v83, 0xffff, v23
    v_and_b32 v23, 0xffff0000, v23
    v_dot2_f32_bf16 v80, v16, v80, 0
    v_dot2_f32_bf16 v20, v16, v20, 0
    v_dot2_f32_bf16 v81, v17, v81, 0
    v_dot2_f32_bf16 v21, v17, v21, 0
    v_dot2_f32_bf16 v82, v18, v82, 0
    v_dot2_f32_bf16 v22, v18, v22, 0
    v_dot2_f32_bf16 v83, v19, v83, 0
    v_dot2_f32_bf16 v23, v19, v23, 0
    v_cvt_pk_bf16_f32 v80, v80, v20
    v_cvt_pk_bf16_f32 v81, v81, v21
    v_cvt_pk_bf16_f32 v82, v82, v22
    v_cvt_pk_bf16_f32 v83, v83, v23
    v_dot2_f32_bf16 v72, v80, s72, v72
    v_dot2_f32_bf16 v73, v81, s72, v73
    v_dot2_f32_bf16 v74, v82, s72, v74
    v_dot2_f32_bf16 v75, v83, s72, v75
    s_waitcnt lgkmcnt(2)
    v_and_b32 v80, 0xffff, v28
    v_and_b32 v28, 0xffff0000, v28
    v_and_b32 v81, 0xffff, v29
    v_and_b32 v29, 0xffff0000, v29
    v_and_b32 v82, 0xffff, v30
    v_and_b32 v30, 0xffff0000, v30
    v_and_b32 v83, 0xffff, v31
    v_and_b32 v31, 0xffff0000, v31
    v_dot2_f32_bf16 v80, v24, v80, 0
    v_dot2_f32_bf16 v28, v24, v28, 0
    v_dot2_f32_bf16 v81, v25, v81, 0
    v_dot2_f32_bf16 v29, v25, v29, 0
    v_dot2_f32_bf16 v82, v26, v82, 0
    v_dot2_f32_bf16 v30, v26, v30, 0
    v_dot2_f32_bf16 v83, v27, v83, 0
    v_dot2_f32_bf16 v31, v27, v31, 0
    v_cvt_pk_bf16_f32 v80, v80, v28
    v_cvt_pk_bf16_f32 v81, v81, v29
    v_cvt_pk_bf16_f32 v82, v82, v30
    v_cvt_pk_bf16_f32 v83, v83, v31
    v_dot2_f32_bf16 v72, v80, s72, v72
    v_dot2_f32_bf16 v73, v81, s72, v73
    v_dot2_f32_bf16 v74, v82, s72, v74
    v_dot2_f32_bf16 v75, v83, s72, v75
    s_waitcnt lgkmcnt(0)
    v_and_b32 v80, 0xffff, v36
    v_and_b32 v36, 0xffff0000, v36
    v_and_b32 v81, 0xffff, v37
    v_and_b32 v37, 0xffff0000, v37
    v_and_b32 v82, 0xffff, v38
    v_and_b32 v38, 0xffff0000, v38
    v_and_b32 v83, 0xffff, v39
    v_and_b32 v39, 0xffff0000, v39
    v_dot2_f32_bf16 v80, v32, v80, 0
    v_dot2_f32_bf16 v36, v32, v36, 0
    v_dot2_f32_bf16 v81, v33, v81, 0
    v_dot2_f32_bf16 v37, v33, v37, 0
    v_dot2_f32_bf16 v82, v34, v82, 0
    v_dot2_f32_bf16 v38, v34, v38, 0
    v_dot2_f32_bf16 v83, v35, v83, 0
    v_dot2_f32_bf16 v39, v35, v39, 0
    v_cvt_pk_bf16_f32 v80, v80, v36
    v_cvt_pk_bf16_f32 v81, v81, v37
    v_cvt_pk_bf16_f32 v82, v82, v38
    v_cvt_pk_bf16_f32 v83, v83, v39
    v_dot2_f32_bf16 v72, v80, s72, v72
    v_dot2_f32_bf16 v73, v81, s72, v73
    v_dot2_f32_bf16 v74, v82, s72, v74
    v_dot2_f32_bf16 v75, v83, s72, v75
    s_waitcnt vmcnt(4) lgkmcnt(0)
    s_barrier
    s_cmp_lg_u32 s52, 0
    s_cbranch_scc1 L_nordy
    s_mov_b64 exec, 1
    buffer_atomic_add v1, v3, s[28:31], 0 offen sc1
    s_mov_b64 exec, -1
L_nordy:
    ds_read_b128 v[8:11], v104 offset:32768
    ds_read_b128 v[12:15], v112 offset:49152
    ds_read_b128 v[16:19], v105 offset:32768
    ds_read_b128 v[20:23], v112 offset:49184
    ds_read_b128 v[24:27], v106 offset:32768
    ds_read_b128 v[28:31], v112 offset:49216
    ds_read_b128 v[32:35], v107 offset:32768
    ds_read_b128 v[36:39], v112 offset:49248
    s_waitcnt lgkmcnt(6)
    v_and_b32 v80, 0xffff, v12
    v_and_b32 v12, 0xffff0000, v12
    v_and_b32 v81, 0xffff, v13
    v_and_b32 v13, 0xffff0000, v13
    v_and_b32 v82, 0xffff, v14
    v_and_b32 v14, 0xffff0000, v14
    v_and_b32 v83, 0xffff, v15
    v_and_b32 v15, 0xffff0000, v15
    v_dot2_f32_bf16 v80, v8, v80, 0
    v_dot2_f32_bf16 v12, v8, v12, 0
    v_dot2_f32_bf16 v81, v9, v81, 0
    v_dot2_f32_bf16 v13, v9, v13, 0
    v_dot2_f32_bf16 v82, v10, v82, 0
    v_dot2_f32_bf16 v14, v10, v14, 0
    v_dot2_f32_bf16 v83, v11, v83, 0
    v_dot2_f32_bf16 v15, v11, v15, 0
    v_cvt_pk_bf16_f32 v80, v80, v12
    v_cvt_pk_bf16_f32 v81, v81, v13
    v_cvt_pk_bf16_f32 v82, v82, v14
    v_cvt_pk_bf16_f32 v83, v83, v15
    v_dot2_f32_bf16 v72, v80, s72, v72
    v_dot2_f32_bf16 v73, v81, s72, v73
    v_dot2_f32_bf16 v74, v82, s72, v74
    v_dot2_f32_bf16 v75, v83, s72, v75
    s_waitcnt lgkmcnt(4)
    v_and_b32 v80, 0xffff, v20
    v_and_b32 v20, 0xffff0000, v20
    v_and_b32 v81, 0xffff, v21
    v_and_b32 v21, 0xffff0000, v21
    v_and_b32 v82, 0xffff, v22
    v_and_b32 v22, 0xffff0000, v22
    v_and_b32 v83, 0xffff, v23
    v_and_b32 v23, 0xffff0000, v23
    v_dot2_f32_bf16 v80, v16, v80, 0
    v_dot2_f32_bf16 v20, v16, v20, 0
    v_dot2_f32_bf16 v81, v17, v81, 0
    v_dot2_f32_bf16 v21, v17, v21, 0
    v_dot2_f32_bf16 v82, v18, v82, 0
    v_dot2_f32_bf16 v22, v18, v22, 0
    v_dot2_f32_bf16 v83, v19, v83, 0
    v_dot2_f32_bf16 v23, v19, v23, 0
    v_cvt_pk_bf16_f32 v80, v80, v20
    v_cvt_pk_bf16_f32 v81, v81, v21
    v_cvt_pk_bf16_f32 v82, v82, v22
    v_cvt_pk_bf16_f32 v83, v83, v23
    v_dot2_f32_bf16 v72, v80, s72, v72
    v_dot2_f32_bf16 v73, v81, s72, v73
    v_dot2_f32_bf16 v74, v82, s72, v74
    v_dot2_f32_bf16 v75, v83, s72, v75
    s_waitcnt lgkmcnt(2)
    v_and_b32 v80, 0xffff, v28
    v_and_b32 v28, 0xffff0000, v28
    v_and_b32 v81, 0xffff, v29
    v_and_b32 v29, 0xffff0000, v29
    v_and_b32 v82, 0xffff, v30
    v_and_b32 v30, 0xffff0000, v30
    v_and_b32 v83, 0xffff, v31
    v_and_b32 v31, 0xffff0000, v31
    v_dot2_f32_bf16 v80, v24, v80, 0
    v_dot2_f32_bf16 v28, v24, v28, 0
    v_dot2_f32_bf16 v81, v25, v81, 0
    v_dot2_f32_bf16 v29, v25, v29, 0
    v_dot2_f32_bf16 v82, v26, v82, 0
    v_dot2_f32_bf16 v30, v26, v30, 0
    v_dot2_f32_bf16 v83, v27, v83, 0
    v_dot2_f32_bf16 v31, v27, v31, 0
    v_cvt_pk_bf16_f32 v80, v80, v28
    v_cvt_pk_bf16_f32 v81, v81, v29
    v_cvt_pk_bf16_f32 v82, v82, v30
    v_cvt_pk_bf16_f32 v83, v83, v31
    v_dot2_f32_bf16 v72, v80, s72, v72
    v_dot2_f32_bf16 v73, v81, s72, v73
    v_dot2_f32_bf16 v74, v82, s72, v74
    v_dot2_f32_bf16 v75, v83, s72, v75
    s_waitcnt lgkmcnt(0)
    v_and_b32 v80, 0xffff, v36
    v_and_b32 v36, 0xffff0000, v36
    v_and_b32 v81, 0xffff, v37
    v_and_b32 v37, 0xffff0000, v37
    v_and_b32 v82, 0xffff, v38
    v_and_b32 v38, 0xffff0000, v38
    v_and_b32 v83, 0xffff, v39
    v_and_b32 v39, 0xffff0000, v39
    v_dot2_f32_bf16 v80, v32, v80, 0
    v_dot2_f32_bf16 v36, v32, v36, 0
    v_dot2_f32_bf16 v81, v33, v81, 0
    v_dot2_f32_bf16 v37, v33, v37, 0
    v_dot2_f32_bf16 v82, v34, v82, 0
    v_dot2_f32_bf16 v38, v34, v38, 0
    v_dot2_f32_bf16 v83, v35, v83, 0
    v_dot2_f32_bf16 v39, v35, v39, 0
    v_cvt_pk_bf16_f32 v80, v80, v36
    v_cvt_pk_bf16_f32 v81, v81, v37
    v_cvt_pk_bf16_f32 v82, v82, v38
    v_cvt_pk_bf16_f32 v83, v83, v39
    v_dot2_f32_bf16 v72, v80, s72, v72
    v_dot2_f32_bf16 v73, v81, s72, v73
    v_dot2_f32_bf16 v74, v82, s72, v74
    v_dot2_f32_bf16 v75, v83, s72, v75
    s_waitcnt lgkmcnt(0)
    s_barrier
    ds_read_b128 v[8:11], v108 offset:0
    ds_read_b128 v[12:15], v113 offset:16384
    ds_read_b128 v[16:19], v109 offset:0
    ds_read_b128 v[20:23], v113 offset:16416
    ds_read_b128 v[24:27], v110 offset:0
    ds_read_b128 v[28:31], v113 offset:16448
    ds_read_b128 v[32:35], v111 offset:0
    ds_read_b128 v[36:39], v113 offset:16480
    s_waitcnt lgkmcnt(6)
    v_and_b32 v80, 0xffff, v12
    v_and_b32 v12, 0xffff0000, v12
    v_and_b32 v81, 0xffff, v13
    v_and_b32 v13, 0xffff0000, v13
    v_and_b32 v82, 0xffff, v14
    v_and_b32 v14, 0xffff0000, v14
    v_and_b32 v83, 0xffff, v15
    v_and_b32 v15, 0xffff0000, v15
    v_dot2_f32_bf16 v80, v8, v80, 0
    v_dot2_f32_bf16 v12, v8, v12, 0
    v_dot2_f32_bf16 v81, v9, v81, 0
    v_dot2_f32_bf16 v13, v9, v13, 0
    v_dot2_f32_bf16 v82, v10, v82, 0
    v_dot2_f32_bf16 v14, v10, v14, 0
    v_dot2_f32_bf16 v83, v11, v83, 0
    v_dot2_f32_bf16 v15, v11, v15, 0
    v_cvt_pk_bf16_f32 v80, v80, v12
    v_cvt_pk_bf16_f32 v81, v81, v13
    v_cvt_pk_bf16_f32 v82, v82, v14
    v_cvt_pk_bf16_f32 v83, v83, v15
    v_dot2_f32_bf16 v72, v80, s72, v72
    v_dot2_f32_bf16 v73, v81, s72, v73
    v_dot2_f32_bf16 v74, v82, s72, v74
    v_dot2_f32_bf16 v75, v83, s72, v75
    s_cmp_lg_u32 s52, 2
    s_cbranch_scc1 L_tch_35
    buffer_load_dword v184, v182, s[12:15], 0 offen
L_tch_35:
    s_waitcnt lgkmcnt(4)
    v_and_b32 v80, 0xffff, v20
    v_and_b32 v20, 0xffff0000, v20
    v_and_b32 v81, 0xffff, v21
    v_and_b32 v21, 0xffff0000, v21
    v_and_b32 v82, 0xffff, v22
    v_and_b32 v22, 0xffff0000, v22
    v_and_b32 v83, 0xffff, v23
    v_and_b32 v23, 0xffff0000, v23
    v_dot2_f32_bf16 v80, v16, v80, 0
    v_dot2_f32_bf16 v20, v16, v20, 0
    v_dot2_f32_bf16 v81, v17, v81, 0
    v_dot2_f32_bf16 v21, v17, v21, 0
    v_dot2_f32_bf16 v82, v18, v82, 0
    v_dot2_f32_bf16 v22, v18, v22, 0
    v_dot2_f32_bf16 v83, v19, v83, 0
    v_dot2_f32_bf16 v23, v19, v23, 0
    v_cvt_pk_bf16_f32 v80, v80, v20
    v_cvt_pk_bf16_f32 v81, v81, v21
    v_cvt_pk_bf16_f32 v82, v82, v22
    v_cvt_pk_bf16_f32 v83, v83, v23
    v_dot2_f32_bf16 v72, v80, s72, v72
    v_dot2_f32_bf16 v73, v81, s72, v73
    v_dot2_f32_bf16 v74, v82, s72, v74
    v_dot2_f32_bf16 v75, v83, s72, v75
    s_waitcnt lgkmcnt(2)
    v_and_b32 v80, 0xffff, v28
    v_and_b32 v28, 0xffff0000, v28
    v_and_b32 v81, 0xffff, v29
    v_and_b32 v29, 0xffff0000, v29
    v_and_b32 v82, 0xffff, v30
    v_and_b32 v30, 0xffff0000, v30
    v_and_b32 v83, 0xffff, v31
    v_and_b32 v31, 0xffff0000, v31
    v_dot2_f32_bf16 v80, v24, v80, 0
    v_dot2_f32_bf16 v28, v24, v28, 0
    v_dot2_f32_bf16 v81, v25, v81, 0
    v_dot2_f32_bf16 v29, v25, v29, 0
    v_dot2_f32_bf16 v82, v26, v82, 0
    v_dot2_f32_bf16 v30, v26, v30, 0
    v_dot2_f32_bf16 v83, v27, v83, 0
    v_dot2_f32_bf16 v31, v27, v31, 0
    v_cvt_pk_bf16_f32 v80, v80, v28
    v_cvt_pk_bf16_f32 v81, v81, v29
    v_cvt_pk_bf16_f32 v82, v82, v30
    v_cvt_pk_bf16_f32 v83, v83, v31
    v_dot2_f32_bf16 v72, v80, s72, v72
    v_dot2_f32_bf16 v73, v81, s72, v73
    v_dot2_f32_bf16 v74, v82, s72, v74
    v_dot2_f32_bf16 v75, v83, s72, v75
    s_waitcnt lgkmcnt(0)
    v_and_b32 v80, 0xffff, v36
    v_and_b32 v36, 0xffff0000, v36
    v_and_b32 v81, 0xffff, v37
    v_and_b32 v37, 0xffff0000, v37
    v_and_b32 v82, 0xffff, v38
    v_and_b32 v38, 0xffff0000, v38
    v_and_b32 v83, 0xffff, v39
    v_and_b32 v39, 0xffff0000, v39
    v_dot2_f32_bf16 v80, v32, v80, 0
    v_dot2_f32_bf16 v36, v32, v36, 0
    v_dot2_f32_bf16 v81, v33, v81, 0
    v_dot2_f32_bf16 v37, v33, v37, 0
    v_dot2_f32_bf16 v82, v34, v82, 0
    v_dot2_f32_bf16 v38, v34, v38, 0
    v_dot2_f32_bf16 v83, v35, v83, 0
    v_dot2_f32_bf16 v39, v35, v39, 0
    v_cvt_pk_bf16_f32 v80, v80, v36
    v_cvt_pk_bf16_f32 v81, v81, v37
    v_cvt_pk_bf16_f32 v82, v82, v38
    v_cvt_pk_bf16_f32 v83, v83, v39
    v_dot2_f32_bf16 v72, v80, s72, v72
    v_dot2_f32_bf16 v73, v81, s72, v73
    v_dot2_f32_bf16 v74, v82, s72, v74
    v_dot2_f32_bf16 v75, v83, s72, v75
    s_waitcnt lgkmcnt(0)
    s_barrier
    ds_read_b128 v[8:11], v104 offset:0
    ds_read_b128 v[12:15], v112 offset:16384
    ds_read_b128 v[16:19], v105 offset:0
    ds_read_b128 v[20:23], v112 offset:16416
    ds_read_b128 v[24:27], v106 offset:0
    ds_read_b128 v[28:31], v112 offset:16448
    ds_read_b128 v[32:35], v107 offset:0
    ds_read_b128 v[36:39], v112 offset:16480
    s_waitcnt lgkmcnt(6)
    v_and_b32 v80, 0xffff, v12
    v_and_b32 v12, 0xffff0000, v12
    v_and_b32 v81, 0xffff, v13
    v_and_b32 v13, 0xffff0000, v13
    v_and_b32 v82, 0xffff, v14
    v_and_b32 v14, 0xffff0000, v14
    v_and_b32 v83, 0xffff, v15
    v_and_b32 v15, 0xffff0000, v15
    v_dot2_f32_bf16 v80, v8, v80, 0
    v_dot2_f32_bf16 v12, v8, v12, 0
    v_dot2_f32_bf16 v81, v9, v81, 0
    v_dot2_f32_bf16 v13, v9, v13, 0
    v_dot2_f32_bf16 v82, v10, v82, 0
    v_dot2_f32_bf16 v14, v10, v14, 0
    v_dot2_f32_bf16 v83, v11, v83, 0
    v_dot2_f32_bf16 v15, v11, v15, 0
    v_cvt_pk_bf16_f32 v80, v80, v12
    v_cvt_pk_bf16_f32 v81, v81, v13
    v_cvt_pk_bf16_f32 v82, v82, v14
    v_cvt_pk_bf16_f32 v83, v83, v15
    v_dot2_f32_bf16 v72, v80, s72, v72
    v_dot2_f32_bf16 v73, v81, s72, v73
    v_dot2_f32_bf16 v74, v82, s72, v74
    v_dot2_f32_bf16 v75, v83, s72, v75
    s_waitcnt vmcnt(0)
    ds_read_b64_tr_b16 v[136:137], v6 offset:0
    ds_read_b64_tr_b16 v[138:139], v6 offset:512
    ds_read_b64_tr_b16 v[140:141], v6 offset:32
    ds_read_b64_tr_b16 v[142:143], v6 offset:544
    ds_read_b64_tr_b16 v[144:145], v6 offset:64
    ds_read_b64_tr_b16 v[146:147], v6 offset:576
    ds_read_b64_tr_b16 v[148:149], v6 offset:96
    ds_read_b64_tr_b16 v[150:151], v6 offset:608
    s_waitcnt lgkmcnt(12)
    v_and_b32 v80, 0xffff, v20
    v_and_b32 v20, 0xffff0000, v20
    v_and_b32 v81, 0xffff, v21
    v_and_b32 v21, 0xffff0000, v21
    v_and_b32 v82, 0xffff, v22
    v_and_b32 v22, 0xffff0000, v22
    v_and_b32 v83, 0xffff, v23
    v_and_b32 v23, 0xffff0000, v23
    v_dot2_f32_bf16 v80, v16, v80, 0
    v_dot2_f32_bf16 v20, v16, v20, 0
    v_dot2_f32_bf16 v81, v17, v81, 0
    v_dot2_f32_bf16 v21, v17, v21, 0
    v_dot2_f32_bf16 v82, v18, v82, 0
    v_dot2_f32_bf16 v22, v18, v22, 0
    v_dot2_f32_bf16 v83, v19, v83, 0
    v_dot2_f32_bf16 v23, v19, v23, 0
    v_cvt_pk_bf16_f32 v80, v80, v20
    v_cvt_pk_bf16_f32 v81, v81, v21
    v_cvt_pk_bf16_f32 v82, v82, v22
    v_cvt_pk_bf16_f32 v83, v83, v23
    v_dot2_f32_bf16 v72, v80, s72, v72
    v_dot2_f32_bf16 v73, v81, s72, v73
    v_dot2_f32_bf16 v74, v82, s72, v74
    v_dot2_f32_bf16 v75, v83, s72, v75
    s_lshl2_add_u32 s66, s65, 0
    s_mul_hi_u32 s67, s66, 0x33333334
    s_mul_i32 s67, s67, 343040
    s_lshl_b32 s66, s66, 10
    s_add_u32 s66, s66, s67
    s_add_u32 s66, s66, s64
    s_waitcnt lgkmcnt(6)
    buffer_store_dwordx4 v[136:139], v2, s[16:19], s66 offen sc1
    v_and_b32 v80, 0xffff, v28
    v_and_b32 v28, 0xffff0000, v28
    v_and_b32 v81, 0xffff, v29
    v_and_b32 v29, 0xffff0000, v29
    v_and_b32 v82, 0xffff, v30
    v_and_b32 v30, 0xffff0000, v30
    v_and_b32 v83, 0xffff, v31
    v_and_b32 v31, 0xffff0000, v31
    v_dot2_f32_bf16 v80, v24, v80, 0
    v_dot2_f32_bf16 v28, v24, v28, 0
    v_dot2_f32_bf16 v81, v25, v81, 0
    v_dot2_f32_bf16 v29, v25, v29, 0
    v_dot2_f32_bf16 v82, v26, v82, 0
    v_dot2_f32_bf16 v30, v26, v30, 0
    v_dot2_f32_bf16 v83, v27, v83, 0
    v_dot2_f32_bf16 v31, v27, v31, 0
    v_cvt_pk_bf16_f32 v80, v80, v28
    v_cvt_pk_bf16_f32 v81, v81, v29
    v_cvt_pk_bf16_f32 v82, v82, v30
    v_cvt_pk_bf16_f32 v83, v83, v31
    v_dot2_f32_bf16 v72, v80, s72, v72
    v_dot2_f32_bf16 v73, v81, s72, v73
    v_dot2_f32_bf16 v74, v82, s72, v74
    v_dot2_f32_bf16 v75, v83, s72, v75
    s_lshl2_add_u32 s66, s65, 1
    s_mul_hi_u32 s67, s66, 0x33333334
    s_mul_i32 s67, s67, 343040
    s_lshl_b32 s66, s66, 10
    s_add_u32 s66, s66, s67
    s_add_u32 s66, s66, s64
    s_waitcnt lgkmcnt(4)
    buffer_store_dwordx4 v[140:143], v2, s[16:19], s66 offen sc1
    v_and_b32 v80, 0xffff, v36
    v_and_b32 v36, 0xffff0000, v36
    v_and_b32 v81, 0xffff, v37
    v_and_b32 v37, 0xffff0000, v37
    v_and_b32 v82, 0xffff, v38
    v_and_b32 v38, 0xffff0000, v38
    v_and_b32 v83, 0xffff, v39
    v_and_b32 v39, 0xffff0000, v39
    v_dot2_f32_bf16 v80, v32, v80, 0
    v_dot2_f32_bf16 v36, v32, v36, 0
    v_dot2_f32_bf16 v81, v33, v81, 0
    v_dot2_f32_bf16 v37, v33, v37, 0
    v_dot2_f32_bf16 v82, v34, v82, 0
    v_dot2_f32_bf16 v38, v34, v38, 0
    v_dot2_f32_bf16 v83, v35, v83, 0
    v_dot2_f32_bf16 v39, v35, v39, 0
    v_cvt_pk_bf16_f32 v80, v80, v36
    v_cvt_pk_bf16_f32 v81, v81, v37
    v_cvt_pk_bf16_f32 v82, v82, v38
    v_cvt_pk_bf16_f32 v83, v83, v39
    v_dot2_f32_bf16 v72, v80, s72, v72
    v_dot2_f32_bf16 v73, v81, s72, v73
    v_dot2_f32_bf16 v74, v82, s72, v74
    v_dot2_f32_bf16 v75, v83, s72, v75
    s_lshl2_add_u32 s66, s65, 2
    s_mul_hi_u32 s67, s66, 0x33333334
    s_mul_i32 s67, s67, 343040
    s_lshl_b32 s66, s66, 10
    s_add_u32 s66, s66, s67
    s_add_u32 s66, s66, s64
    s_waitcnt lgkmcnt(2)
    buffer_store_dwordx4 v[144:147], v2, s[16:19], s66 offen sc1
    s_waitcnt lgkmcnt(0)
    s_barrier
    ds_read_b128 v[8:11], v104 offset:32768
    ds_read_b128 v[12:15], v112 offset:49152
    ds_read_b128 v[16:19], v105 offset:32768
    ds_read_b128 v[20:23], v112 offset:49184
    ds_read_b128 v[24:27], v106 offset:32768
    ds_read_b128 v[28:31], v112 offset:49216
    ds_read_b128 v[32:35], v107 offset:32768
    ds_read_b128 v[36:39], v112 offset:49248
    s_waitcnt lgkmcnt(6)
    v_and_b32 v80, 0xffff, v12
    v_and_b32 v12, 0xffff0000, v12
    v_and_b32 v81, 0xffff, v13
    v_and_b32 v13, 0xffff0000, v13
    v_and_b32 v82, 0xffff, v14
    v_and_b32 v14, 0xffff0000, v14
    v_and_b32 v83, 0xffff, v15
    v_and_b32 v15, 0xffff0000, v15
    v_dot2_f32_bf16 v80, v8, v80, 0
    v_dot2_f32_bf16 v12, v8, v12, 0
    v_dot2_f32_bf16 v81, v9, v81, 0
    v_dot2_f32_bf16 v13, v9, v13, 0
    v_dot2_f32_bf16 v82, v10, v82, 0
    v_dot2_f32_bf16 v14, v10, v14, 0
    v_dot2_f32_bf16 v83, v11, v83, 0
    v_dot2_f32_bf16 v15, v11, v15, 0
    v_cvt_pk_bf16_f32 v80, v80, v12
    v_cvt_pk_bf16_f32 v81, v81, v13
    v_cvt_pk_bf16_f32 v82, v82, v14
    v_cvt_pk_bf16_f32 v83, v83, v15
    v_dot2_f32_bf16 v72, v80, s72, v72
    v_dot2_f32_bf16 v73, v81, s72, v73
    v_dot2_f32_bf16 v74, v82, s72, v74
    v_dot2_f32_bf16 v75, v83, s72, v75
    s_lshl2_add_u32 s66, s65, 3
    s_mul_hi_u32 s67, s66, 0x33333334
    s_mul_i32 s67, s67, 343040
    s_lshl_b32 s66, s66, 10
    s_add_u32 s66, s66, s67
    s_add_u32 s66, s66, s64
    buffer_store_dwordx4 v[148:151], v2, s[16:19], s66 offen sc1
    s_waitcnt lgkmcnt(4)
    v_and_b32 v80, 0xffff, v20
    v_and_b32 v20, 0xffff0000, v20
    v_and_b32 v81, 0xffff, v21
    v_and_b32 v21, 0xffff0000, v21
    v_and_b32 v82, 0xffff, v22
    v_and_b32 v22, 0xffff0000, v22
    v_and_b32 v83, 0xffff, v23
    v_and_b32 v23, 0xffff0000, v23
    v_dot2_f32_bf16 v80, v16, v80, 0
    v_dot2_f32_bf16 v20, v16, v20, 0
    v_dot2_f32_bf16 v81, v17, v81, 0
    v_dot2_f32_bf16 v21, v17, v21, 0
    v_dot2_f32_bf16 v82, v18, v82, 0
    v_dot2_f32_bf16 v22, v18, v22, 0
    v_dot2_f32_bf16 v83, v19, v83, 0
    v_dot2_f32_bf16 v23, v19, v23, 0
    v_cvt_pk_bf16_f32 v80, v80, v20
    v_cvt_pk_bf16_f32 v81, v81, v21
    v_cvt_pk_bf16_f32 v82, v82, v22
    v_cvt_pk_bf16_f32 v83, v83, v23
    v_dot2_f32_bf16 v72, v80, s72, v72
    v_dot2_f32_bf16 v73, v81, s72, v73
    v_dot2_f32_bf16 v74, v82, s72, v74
    v_dot2_f32_bf16 v75, v83, s72, v75
    s_waitcnt lgkmcnt(2)
    v_and_b32 v80, 0xffff, v28
    v_and_b32 v28, 0xffff0000, v28
    v_and_b32 v81, 0xffff, v29
    v_and_b32 v29, 0xffff0000, v29
    v_and_b32 v82, 0xffff, v30
    v_and_b32 v30, 0xffff0000, v30
    v_and_b32 v83, 0xffff, v31
    v_and_b32 v31, 0xffff0000, v31
    v_dot2_f32_bf16 v80, v24, v80, 0
    v_dot2_f32_bf16 v28, v24, v28, 0
    v_dot2_f32_bf16 v81, v25, v81, 0
    v_dot2_f32_bf16 v29, v25, v29, 0
    v_dot2_f32_bf16 v82, v26, v82, 0
    v_dot2_f32_bf16 v30, v26, v30, 0
    v_dot2_f32_bf16 v83, v27, v83, 0
    v_dot2_f32_bf16 v31, v27, v31, 0
    v_cvt_pk_bf16_f32 v80, v80, v28
    v_cvt_pk_bf16_f32 v81, v81, v29
    v_cvt_pk_bf16_f32 v82, v82, v30
    v_cvt_pk_bf16_f32 v83, v83, v31
    v_dot2_f32_bf16 v72, v80, s72, v72
    v_dot2_f32_bf16 v73, v81, s72, v73
    v_dot2_f32_bf16 v74, v82, s72, v74
    v_dot2_f32_bf16 v75, v83, s72, v75
    s_waitcnt lgkmcnt(0)
    v_and_b32 v80, 0xffff, v36
    v_and_b32 v36, 0xffff0000, v36
    v_and_b32 v81, 0xffff, v37
    v_and_b32 v37, 0xffff0000, v37
    v_and_b32 v82, 0xffff, v38
    v_and_b32 v38, 0xffff0000, v38
    v_and_b32 v83, 0xffff, v39
    v_and_b32 v39, 0xffff0000, v39
    v_dot2_f32_bf16 v80, v32, v80, 0
    v_dot2_f32_bf16 v36, v32, v36, 0
    v_dot2_f32_bf16 v81, v33, v81, 0
    v_dot2_f32_bf16 v37, v33, v37, 0
    v_dot2_f32_bf16 v82, v34, v82, 0
    v_dot2_f32_bf16 v38, v34, v38, 0
    v_dot2_f32_bf16 v83, v35, v83, 0
    v_dot2_f32_bf16 v39, v35, v39, 0
    v_cvt_pk_bf16_f32 v80, v80, v36
    v_cvt_pk_bf16_f32 v81, v81, v37
    v_cvt_pk_bf16_f32 v82, v82, v38
    v_cvt_pk_bf16_f32 v83, v83, v39
    v_dot2_f32_bf16 v72, v80, s72, v72
    v_dot2_f32_bf16 v73, v81, s72, v73
    v_dot2_f32_bf16 v74, v82, s72, v74
    v_dot2_f32_bf16 v75, v83, s72, v75
    s_waitcnt lgkmcnt(0)
    s_barrier
    ds_read_b128 v[8:11], v108 offset:0
    ds_read_b128 v[12:15], v113 offset:16384
    ds_read_b128 v[16:19], v109 offset:0
    ds_read_b128 v[20:23], v113 offset:16416
    ds_read_b128 v[24:27], v110 offset:0
    ds_read_b128 v[28:31], v113 offset:16448
    ds_read_b128 v[32:35], v111 offset:0
    ds_read_b128 v[36:39], v113 offset:16480
    s_waitcnt lgkmcnt(6)
    v_and_b32 v80, 0xffff, v12
    v_and_b32 v12, 0xffff0000, v12
    v_and_b32 v81, 0xffff, v13
    v_and_b32 v13, 0xffff0000, v13
    v_and_b32 v82, 0xffff, v14
    v_and_b32 v14, 0xffff0000, v14
    v_and_b32 v83, 0xffff, v15
    v_and_b32 v15, 0xffff0000, v15
    v_dot2_f32_bf16 v80, v8, v80, 0
    v_dot2_f32_bf16 v12, v8, v12, 0
    v_dot2_f32_bf16 v81, v9, v81, 0
    v_dot2_f32_bf16 v13, v9, v13, 0
    v_dot2_f32_bf16 v82, v10, v82, 0
    v_dot2_f32_bf16 v14, v10, v14, 0
    v_dot2_f32_bf16 v83, v11, v83, 0
    v_dot2_f32_bf16 v15, v11, v15, 0
    v_cvt_pk_bf16_f32 v80, v80, v12
    v_cvt_pk_bf16_f32 v81, v81, v13
    v_cvt_pk_bf16_f32 v82, v82, v14
    v_cvt_pk_bf16_f32 v83, v83, v15
    v_dot2_f32_bf16 v72, v80, s72, v72
    v_dot2_f32_bf16 v73, v81, s72, v73
    v_dot2_f32_bf16 v74, v82, s72, v74
    v_dot2_f32_bf16 v75, v83, s72, v75
    s_waitcnt lgkmcnt(4)
    v_and_b32 v80, 0xffff, v20
    v_and_b32 v20, 0xffff0000, v20
    v_and_b32 v81, 0xffff, v21
    v_and_b32 v21, 0xffff0000, v21
    v_and_b32 v82, 0xffff, v22
    v_and_b32 v22, 0xffff0000, v22
    v_and_b32 v83, 0xffff, v23
    v_and_b32 v23, 0xffff0000, v23
    v_dot2_f32_bf16 v80, v16, v80, 0
    v_dot2_f32_bf16 v20, v16, v20, 0
    v_dot2_f32_bf16 v81, v17, v81, 0
    v_dot2_f32_bf16 v21, v17, v21, 0
    v_dot2_f32_bf16 v82, v18, v82, 0
    v_dot2_f32_bf16 v22, v18, v22, 0
    v_dot2_f32_bf16 v83, v19, v83, 0
    v_dot2_f32_bf16 v23, v19, v23, 0
    v_cvt_pk_bf16_f32 v80, v80, v20
    v_cvt_pk_bf16_f32 v81, v81, v21
    v_cvt_pk_bf16_f32 v82, v82, v22
    v_cvt_pk_bf16_f32 v83, v83, v23
    v_dot2_f32_bf16 v72, v80, s72, v72
    v_dot2_f32_bf16 v73, v81, s72, v73
    v_dot2_f32_bf16 v74, v82, s72, v74
    v_dot2_f32_bf16 v75, v83, s72, v75
    s_waitcnt lgkmcnt(2)
    v_and_b32 v80, 0xffff, v28
    v_and_b32 v28, 0xffff0000, v28
    v_and_b32 v81, 0xffff, v29
    v_and_b32 v29, 0xffff0000, v29
    v_and_b32 v82, 0xffff, v30
    v_and_b32 v30, 0xffff0000, v30
    v_and_b32 v83, 0xffff, v31
    v_and_b32 v31, 0xffff0000, v31
    v_dot2_f32_bf16 v80, v24, v80, 0
    v_dot2_f32_bf16 v28, v24, v28, 0
    v_dot2_f32_bf16 v81, v25, v81, 0
    v_dot2_f32_bf16 v29, v25, v29, 0
    v_dot2_f32_bf16 v82, v26, v82, 0
    v_dot2_f32_bf16 v30, v26, v30, 0
    v_dot2_f32_bf16 v83, v27, v83, 0
    v_dot2_f32_bf16 v31, v27, v31, 0
    v_cvt_pk_bf16_f32 v80, v80, v28
    v_cvt_pk_bf16_f32 v81, v81, v29
    v_cvt_pk_bf16_f32 v82, v82, v30
    v_cvt_pk_bf16_f32 v83, v83, v31
    v_dot2_f32_bf16 v72, v80, s72, v72
    v_dot2_f32_bf16 v73, v81, s72, v73
    v_dot2_f32_bf16 v74, v82, s72, v74
    v_dot2_f32_bf16 v75, v83, s72, v75
    s_waitcnt lgkmcnt(0)
    v_and_b32 v80, 0xffff, v36
    v_and_b32 v36, 0xffff0000, v36
    v_and_b32 v81, 0xffff, v37
    v_and_b32 v37, 0xffff0000, v37
    v_and_b32 v82, 0xffff, v38
    v_and_b32 v38, 0xffff0000, v38
    v_and_b32 v83, 0xffff, v39
    v_and_b32 v39, 0xffff0000, v39
    v_dot2_f32_bf16 v80, v32, v80, 0
    v_dot2_f32_bf16 v36, v32, v36, 0
    v_dot2_f32_bf16 v81, v33, v81, 0
    v_dot2_f32_bf16 v37, v33, v37, 0
    v_dot2_f32_bf16 v82, v34, v82, 0
    v_dot2_f32_bf16 v38, v34, v38, 0
    v_dot2_f32_bf16 v83, v35, v83, 0
    v_dot2_f32_bf16 v39, v35, v39, 0
    v_cvt_pk_bf16_f32 v80, v80, v36
    v_cvt_pk_bf16_f32 v81, v81, v37
    v_cvt_pk_bf16_f32 v82, v82, v38
    v_cvt_pk_bf16_f32 v83, v83, v39
    v_dot2_f32_bf16 v72, v80, s72, v72
    v_dot2_f32_bf16 v73, v81, s72, v73
    v_dot2_f32_bf16 v74, v82, s72, v74
    v_dot2_f32_bf16 v75, v83, s72, v75
    s_waitcnt lgkmcnt(0)
    s_barrier
    ds_read_b128 v[8:11], v104 offset:0
    ds_read_b128 v[12:15], v112 offset:16384
    ds_read_b128 v[16:19], v105 offset:0
    ds_read_b128 v[20:23], v112 offset:16416
    ds_read_b128 v[24:27], v106 offset:0
    ds_read_b128 v[28:31], v112 offset:16448
    ds_read_b128 v[32:35], v107 offset:0
    ds_read_b128 v[36:39], v112 offset:16480
    s_waitcnt lgkmcnt(6)
    v_and_b32 v80, 0xffff, v12
    v_and_b32 v12, 0xffff0000, v12
    v_and_b32 v81, 0xffff, v13
    v_and_b32 v13, 0xffff0000, v13
    v_and_b32 v82, 0xffff, v14
    v_and_b32 v14, 0xffff0000, v14
    v_and_b32 v83, 0xffff, v15
    v_and_b32 v15, 0xffff0000, v15
    v_dot2_f32_bf16 v80, v8, v80, 0
    v_dot2_f32_bf16 v12, v8, v12, 0
    v_dot2_f32_bf16 v81, v9, v81, 0
    v_dot2_f32_bf16 v13, v9, v13, 0
    v_dot2_f32_bf16 v82, v10, v82, 0
    v_dot2_f32_bf16 v14, v10, v14, 0
    v_dot2_f32_bf16 v83, v11, v83, 0
    v_dot2_f32_bf16 v15, v11, v15, 0
    v_cvt_pk_bf16_f32 v80, v80, v12
    v_cvt_pk_bf16_f32 v81, v81, v13
    v_cvt_pk_bf16_f32 v82, v82, v14
    v_cvt_pk_bf16_f32 v83, v83, v15
    v_dot2_f32_bf16 v72, v80, s72, v72
    v_dot2_f32_bf16 v73, v81, s72, v73
    v_dot2_f32_bf16 v74, v82, s72, v74
    v_dot2_f32_bf16 v75, v83, s72, v75
    s_waitcnt lgkmcnt(4)
    v_and_b32 v80, 0xffff, v20
    v_and_b32 v20, 0xffff0000, v20
    v_and_b32 v81, 0xffff, v21
    v_and_b32 v21, 0xffff0000, v21
    v_and_b32 v82, 0xffff, v22
    v_and_b32 v22, 0xffff0000, v22
    v_and_b32 v83, 0xffff, v23
    v_and_b32 v23, 0xffff0000, v23
    v_dot2_f32_bf16 v80, v16, v80, 0
    v_dot2_f32_bf16 v20, v16, v20, 0
    v_dot2_f32_bf16 v81, v17, v81, 0
    v_dot2_f32_bf16 v21, v17, v21, 0
    v_dot2_f32_bf16 v82, v18, v82, 0
    v_dot2_f32_bf16 v22, v18, v22, 0
    v_dot2_f32_bf16 v83, v19, v83, 0
    v_dot2_f32_bf16 v23, v19, v23, 0
    v_cvt_pk_bf16_f32 v80, v80, v20
    v_cvt_pk_bf16_f32 v81, v81, v21
    v_cvt_pk_bf16_f32 v82, v82, v22
    v_cvt_pk_bf16_f32 v83, v83, v23
    v_dot2_f32_bf16 v72, v80, s72, v72
    v_dot2_f32_bf16 v73, v81, s72, v73
    v_dot2_f32_bf16 v74, v82, s72, v74
    v_dot2_f32_bf16 v75, v83, s72, v75
    s_waitcnt vmcnt(0)
    s_waitcnt lgkmcnt(2)
    v_and_b32 v80, 0xffff, v28
    v_and_b32 v28, 0xffff0000, v28
    v_and_b32 v81, 0xffff, v29
    v_and_b32 v29, 0xffff0000, v29
    v_and_b32 v82, 0xffff, v30
    v_and_b32 v30, 0xffff0000, v30
    v_and_b32 v83, 0xffff, v31
    v_and_b32 v31, 0xffff0000, v31
    v_dot2_f32_bf16 v80, v24, v80, 0
    v_dot2_f32_bf16 v28, v24, v28, 0
    v_dot2_f32_bf16 v81, v25, v81, 0
    v_dot2_f32_bf16 v29, v25, v29, 0
    v_dot2_f32_bf16 v82, v26, v82, 0
    v_dot2_f32_bf16 v30, v26, v30, 0
    v_dot2_f32_bf16 v83, v27, v83, 0
    v_dot2_f32_bf16 v31, v27, v31, 0
    v_cvt_pk_bf16_f32 v80, v80, v28
    v_cvt_pk_bf16_f32 v81, v81, v29
    v_cvt_pk_bf16_f32 v82, v82, v30
    v_cvt_pk_bf16_f32 v83, v83, v31
    v_dot2_f32_bf16 v72, v80, s72, v72
    v_dot2_f32_bf16 v73, v81, s72, v73
    v_dot2_f32_bf16 v74, v82, s72, v74
    v_dot2_f32_bf16 v75, v83, s72, v75
    s_waitcnt lgkmcnt(0)
    v_and_b32 v80, 0xffff, v36
    v_and_b32 v36, 0xffff0000, v36
    v_and_b32 v81, 0xffff, v37
    v_and_b32 v37, 0xffff0000, v37
    v_and_b32 v82, 0xffff, v38
    v_and_b32 v38, 0xffff0000, v38
    v_and_b32 v83, 0xffff, v39
    v_and_b32 v39, 0xffff0000, v39
    v_dot2_f32_bf16 v80, v32, v80, 0
    v_dot2_f32_bf16 v36, v32, v36, 0
    v_dot2_f32_bf16 v81, v33, v81, 0
    v_dot2_f32_bf16 v37, v33, v37, 0
    v_dot2_f32_bf16 v82, v34, v82, 0
    v_dot2_f32_bf16 v38, v34, v38, 0
    v_dot2_f32_bf16 v83, v35, v83, 0
    v_dot2_f32_bf16 v39, v35, v39, 0
    v_cvt_pk_bf16_f32 v80, v80, v36
    v_cvt_pk_bf16_f32 v81, v81, v37
    v_cvt_pk_bf16_f32 v82, v82, v38
    v_cvt_pk_bf16_f32 v83, v83, v39
    v_dot2_f32_bf16 v72, v80, s72, v72
    v_dot2_f32_bf16 v73, v81, s72, v73
    v_dot2_f32_bf16 v74, v82, s72, v74
    v_dot2_f32_bf16 v75, v83, s72, v75
    s_waitcnt lgkmcnt(0)
    s_barrier
    ds_read_b128 v[8:11], v104 offset:32768
    ds_read_b128 v[12:15], v112 offset:49152
    ds_read_b128 v[16:19], v105 offset:32768
    ds_read_b128 v[20:23], v112 offset:49184
    ds_read_b128 v[24:27], v106 offset:32768
    ds_read_b128 v[28:31], v112 offset:49216
    ds_read_b128 v[32:35], v107 offset:32768
    ds_read_b128 v[36:39], v112 offset:49248
    s_waitcnt lgkmcnt(6)
    v_and_b32 v80, 0xffff, v12
    v_and_b32 v12, 0xffff0000, v12
    v_and_b32 v81, 0xffff, v13
    v_and_b32 v13, 0xffff0000, v13
    v_and_b32 v82, 0xffff, v14
    v_and_b32 v14, 0xffff0000, v14
    v_and_b32 v83, 0xffff, v15
    v_and_b32 v15, 0xffff0000, v15
    v_dot2_f32_bf16 v80, v8, v80, 0
    v_dot2_f32_bf16 v12, v8, v12, 0
    v_dot2_f32_bf16 v81, v9, v81, 0
    v_dot2_f32_bf16 v13, v9, v13, 0
    v_dot2_f32_bf16 v82, v10, v82, 0
    v_dot2_f32_bf16 v14, v10, v14, 0
    v_dot2_f32_bf16 v83, v11, v83, 0
    v_dot2_f32_bf16 v15, v11, v15, 0
    v_cvt_pk_bf16_f32 v80, v80, v12
    v_cvt_pk_bf16_f32 v81, v81, v13
    v_cvt_pk_bf16_f32 v82, v82, v14
    v_cvt_pk_bf16_f32 v83, v83, v15
    v_dot2_f32_bf16 v72, v80, s72, v72
    v_dot2_f32_bf16 v73, v81, s72, v73
    v_dot2_f32_bf16 v74, v82, s72, v74
    v_dot2_f32_bf16 v75, v83, s72, v75
    s_cmp_lg_u32 s52, 0
    s_cbranch_scc1 L_nodb_36
    s_bfe_u32 s66, s2, 0x20003
    s_lshl_b32 s66, s66, 8
    s_add_u32 s66, s66, 20160512
    s_mov_b64 exec, 1
    buffer_atomic_add v1, v3, s[16:19], s66 offen sc1
    s_mov_b64 exec, -1
L_nodb_36:
    s_waitcnt lgkmcnt(4)
    v_and_b32 v80, 0xffff, v20
    v_and_b32 v20, 0xffff0000, v20
    v_and_b32 v81, 0xffff, v21
    v_and_b32 v21, 0xffff0000, v21
    v_and_b32 v82, 0xffff, v22
    v_and_b32 v22, 0xffff0000, v22
    v_and_b32 v83, 0xffff, v23
    v_and_b32 v23, 0xffff0000, v23
    v_dot2_f32_bf16 v80, v16, v80, 0
    v_dot2_f32_bf16 v20, v16, v20, 0
    v_dot2_f32_bf16 v81, v17, v81, 0
    v_dot2_f32_bf16 v21, v17, v21, 0
    v_dot2_f32_bf16 v82, v18, v82, 0
    v_dot2_f32_bf16 v22, v18, v22, 0
    v_dot2_f32_bf16 v83, v19, v83, 0
    v_dot2_f32_bf16 v23, v19, v23, 0
    v_cvt_pk_bf16_f32 v80, v80, v20
    v_cvt_pk_bf16_f32 v81, v81, v21
    v_cvt_pk_bf16_f32 v82, v82, v22
    v_cvt_pk_bf16_f32 v83, v83, v23
    v_dot2_f32_bf16 v72, v80, s72, v72
    v_dot2_f32_bf16 v73, v81, s72, v73
    v_dot2_f32_bf16 v74, v82, s72, v74
    v_dot2_f32_bf16 v75, v83, s72, v75
    s_waitcnt lgkmcnt(2)
    v_and_b32 v80, 0xffff, v28
    v_and_b32 v28, 0xffff0000, v28
    v_and_b32 v81, 0xffff, v29
    v_and_b32 v29, 0xffff0000, v29
    v_and_b32 v82, 0xffff, v30
    v_and_b32 v30, 0xffff0000, v30
    v_and_b32 v83, 0xffff, v31
    v_and_b32 v31, 0xffff0000, v31
    v_dot2_f32_bf16 v80, v24, v80, 0
    v_dot2_f32_bf16 v28, v24, v28, 0
    v_dot2_f32_bf16 v81, v25, v81, 0
    v_dot2_f32_bf16 v29, v25, v29, 0
    v_dot2_f32_bf16 v82, v26, v82, 0
    v_dot2_f32_bf16 v30, v26, v30, 0
    v_dot2_f32_bf16 v83, v27, v83, 0
    v_dot2_f32_bf16 v31, v27, v31, 0
    v_cvt_pk_bf16_f32 v80, v80, v28
    v_cvt_pk_bf16_f32 v81, v81, v29
    v_cvt_pk_bf16_f32 v82, v82, v30
    v_cvt_pk_bf16_f32 v83, v83, v31
    v_dot2_f32_bf16 v72, v80, s72, v72
    v_dot2_f32_bf16 v73, v81, s72, v73
    v_dot2_f32_bf16 v74, v82, s72, v74
    v_dot2_f32_bf16 v75, v83, s72, v75
    s_waitcnt lgkmcnt(0)
    v_and_b32 v80, 0xffff, v36
    v_and_b32 v36, 0xffff0000, v36
    v_and_b32 v81, 0xffff, v37
    v_and_b32 v37, 0xffff0000, v37
    v_and_b32 v82, 0xffff, v38
    v_and_b32 v38, 0xffff0000, v38
    v_and_b32 v83, 0xffff, v39
    v_and_b32 v39, 0xffff0000, v39
    v_dot2_f32_bf16 v80, v32, v80, 0
    v_dot2_f32_bf16 v36, v32, v36, 0
    v_dot2_f32_bf16 v81, v33, v81, 0
    v_dot2_f32_bf16 v37, v33, v37, 0
    v_dot2_f32_bf16 v82, v34, v82, 0
    v_dot2_f32_bf16 v38, v34, v38, 0
    v_dot2_f32_bf16 v83, v35, v83, 0
    v_dot2_f32_bf16 v39, v35, v39, 0
    v_cvt_pk_bf16_f32 v80, v80, v36
    v_cvt_pk_bf16_f32 v81, v81, v37
    v_cvt_pk_bf16_f32 v82, v82, v38
    v_cvt_pk_bf16_f32 v83, v83, v39
    v_dot2_f32_bf16 v72, v80, s72, v72
    v_dot2_f32_bf16 v73, v81, s72, v73
    v_dot2_f32_bf16 v74, v82, s72, v74
    v_dot2_f32_bf16 v75, v83, s72, v75
    s_waitcnt lgkmcnt(0)
    s_barrier
    ds_read_b128 v[8:11], v108 offset:0
    ds_read_b128 v[12:15], v113 offset:16384
    ds_read_b128 v[16:19], v109 offset:0
    ds_read_b128 v[20:23], v113 offset:16416
    ds_read_b128 v[24:27], v110 offset:0
    ds_read_b128 v[28:31], v113 offset:16448
    ds_read_b128 v[32:35], v111 offset:0
    ds_read_b128 v[36:39], v113 offset:16480
    s_waitcnt lgkmcnt(6)
    v_and_b32 v80, 0xffff, v12
    v_and_b32 v12, 0xffff0000, v12
    v_and_b32 v81, 0xffff, v13
    v_and_b32 v13, 0xffff0000, v13
    v_and_b32 v82, 0xffff, v14
    v_and_b32 v14, 0xffff0000, v14
    v_and_b32 v83, 0xffff, v15
    v_and_b32 v15, 0xffff0000, v15
    v_dot2_f32_bf16 v80, v8, v80, 0
    v_dot2_f32_bf16 v12, v8, v12, 0
    v_dot2_f32_bf16 v81, v9, v81, 0
    v_dot2_f32_bf16 v13, v9, v13, 0
    v_dot2_f32_bf16 v82, v10, v82, 0
    v_dot2_f32_bf16 v14, v10, v14, 0
    v_dot2_f32_bf16 v83, v11, v83, 0
    v_dot2_f32_bf16 v15, v11, v15, 0
    v_cvt_pk_bf16_f32 v80, v80, v12
    v_cvt_pk_bf16_f32 v81, v81, v13
    v_cvt_pk_bf16_f32 v82, v82, v14
    v_cvt_pk_bf16_f32 v83, v83, v15
    v_dot2_f32_bf16 v72, v80, s72, v72
    v_dot2_f32_bf16 v73, v81, s72, v73
    v_dot2_f32_bf16 v74, v82, s72, v74
    v_dot2_f32_bf16 v75, v83, s72, v75
    s_waitcnt lgkmcnt(4)
    v_and_b32 v80, 0xffff, v20
    v_and_b32 v20, 0xffff0000, v20
    v_and_b32 v81, 0xffff, v21
    v_and_b32 v21, 0xffff0000, v21
    v_and_b32 v82, 0xffff, v22
    v_and_b32 v22, 0xffff0000, v22
    v_and_b32 v83, 0xffff, v23
    v_and_b32 v23, 0xffff0000, v23
    v_dot2_f32_bf16 v80, v16, v80, 0
    v_dot2_f32_bf16 v20, v16, v20, 0
    v_dot2_f32_bf16 v81, v17, v81, 0
    v_dot2_f32_bf16 v21, v17, v21, 0
    v_dot2_f32_bf16 v82, v18, v82, 0
    v_dot2_f32_bf16 v22, v18, v22, 0
    v_dot2_f32_bf16 v83, v19, v83, 0
    v_dot2_f32_bf16 v23, v19, v23, 0
    v_cvt_pk_bf16_f32 v80, v80, v20
    v_cvt_pk_bf16_f32 v81, v81, v21
    v_cvt_pk_bf16_f32 v82, v82, v22
    v_cvt_pk_bf16_f32 v83, v83, v23
    v_dot2_f32_bf16 v72, v80, s72, v72
    v_dot2_f32_bf16 v73, v81, s72, v73
    v_dot2_f32_bf16 v74, v82, s72, v74
    v_dot2_f32_bf16 v75, v83, s72, v75
    s_waitcnt lgkmcnt(2)
    v_and_b32 v80, 0xffff, v28
    v_and_b32 v28, 0xffff0000, v28
    v_and_b32 v81, 0xffff, v29
    v_and_b32 v29, 0xffff0000, v29
    v_and_b32 v82, 0xffff, v30
    v_and_b32 v30, 0xffff0000, v30
    v_and_b32 v83, 0xffff, v31
    v_and_b32 v31, 0xffff0000, v31
    v_dot2_f32_bf16 v80, v24, v80, 0
    v_dot2_f32_bf16 v28, v24, v28, 0
    v_dot2_f32_bf16 v81, v25, v81, 0
    v_dot2_f32_bf16 v29, v25, v29, 0
    v_dot2_f32_bf16 v82, v26, v82, 0
    v_dot2_f32_bf16 v30, v26, v30, 0
    v_dot2_f32_bf16 v83, v27, v83, 0
    v_dot2_f32_bf16 v31, v27, v31, 0
    v_cvt_pk_bf16_f32 v80, v80, v28
    v_cvt_pk_bf16_f32 v81, v81, v29
    v_cvt_pk_bf16_f32 v82, v82, v30
    v_cvt_pk_bf16_f32 v83, v83, v31
    v_dot2_f32_bf16 v72, v80, s72, v72
    v_dot2_f32_bf16 v73, v81, s72, v73
    v_dot2_f32_bf16 v74, v82, s72, v74
    v_dot2_f32_bf16 v75, v83, s72, v75
    s_waitcnt lgkmcnt(0)
    v_and_b32 v80, 0xffff, v36
    v_and_b32 v36, 0xffff0000, v36
    v_and_b32 v81, 0xffff, v37
    v_and_b32 v37, 0xffff0000, v37
    v_and_b32 v82, 0xffff, v38
    v_and_b32 v38, 0xffff0000, v38
    v_and_b32 v83, 0xffff, v39
    v_and_b32 v39, 0xffff0000, v39
    v_dot2_f32_bf16 v80, v32, v80, 0
    v_dot2_f32_bf16 v36, v32, v36, 0
    v_dot2_f32_bf16 v81, v33, v81, 0
    v_dot2_f32_bf16 v37, v33, v37, 0
    v_dot2_f32_bf16 v82, v34, v82, 0
    v_dot2_f32_bf16 v38, v34, v38, 0
    v_dot2_f32_bf16 v83, v35, v83, 0
    v_dot2_f32_bf16 v39, v35, v39, 0
    v_cvt_pk_bf16_f32 v80, v80, v36
    v_cvt_pk_bf16_f32 v81, v81, v37
    v_cvt_pk_bf16_f32 v82, v82, v38
    v_cvt_pk_bf16_f32 v83, v83, v39
    v_dot2_f32_bf16 v72, v80, s72, v72
    v_dot2_f32_bf16 v73, v81, s72, v73
    v_dot2_f32_bf16 v74, v82, s72, v74
    v_dot2_f32_bf16 v75, v83, s72, v75
    s_waitcnt lgkmcnt(0)
    s_barrier
    ds_read_b128 v[8:11], v104 offset:0
    ds_read_b128 v[12:15], v112 offset:16384
    ds_read_b128 v[16:19], v105 offset:0
    ds_read_b128 v[20:23], v112 offset:16416
    ds_read_b128 v[24:27], v106 offset:0
    ds_read_b128 v[28:31], v112 offset:16448
    ds_read_b128 v[32:35], v107 offset:0
    ds_read_b128 v[36:39], v112 offset:16480
    s_waitcnt lgkmcnt(6)
    v_and_b32 v80, 0xffff, v12
    v_and_b32 v12, 0xffff0000, v12
    v_and_b32 v81, 0xffff, v13
    v_and_b32 v13, 0xffff0000, v13
    v_and_b32 v82, 0xffff, v14
    v_and_b32 v14, 0xffff0000, v14
    v_and_b32 v83, 0xffff, v15
    v_and_b32 v15, 0xffff0000, v15
    v_dot2_f32_bf16 v80, v8, v80, 0
    v_dot2_f32_bf16 v12, v8, v12, 0
    v_dot2_f32_bf16 v81, v9, v81, 0
    v_dot2_f32_bf16 v13, v9, v13, 0
    v_dot2_f32_bf16 v82, v10, v82, 0
    v_dot2_f32_bf16 v14, v10, v14, 0
    v_dot2_f32_bf16 v83, v11, v83, 0
    v_dot2_f32_bf16 v15, v11, v15, 0
    v_cvt_pk_bf16_f32 v80, v80, v12
    v_cvt_pk_bf16_f32 v81, v81, v13
    v_cvt_pk_bf16_f32 v82, v82, v14
    v_cvt_pk_bf16_f32 v83, v83, v15
    v_dot2_f32_bf16 v72, v80, s72, v72
    v_dot2_f32_bf16 v73, v81, s72, v73
    v_dot2_f32_bf16 v74, v82, s72, v74
    v_dot2_f32_bf16 v75, v83, s72, v75
    s_waitcnt lgkmcnt(4)
    v_and_b32 v80, 0xffff, v20
    v_and_b32 v20, 0xffff0000, v20
    v_and_b32 v81, 0xffff, v21
    v_and_b32 v21, 0xffff0000, v21
    v_and_b32 v82, 0xffff, v22
    v_and_b32 v22, 0xffff0000, v22
    v_and_b32 v83, 0xffff, v23
    v_and_b32 v23, 0xffff0000, v23
    v_dot2_f32_bf16 v80, v16, v80, 0
    v_dot2_f32_bf16 v20, v16, v20, 0
    v_dot2_f32_bf16 v81, v17, v81, 0
    v_dot2_f32_bf16 v21, v17, v21, 0
    v_dot2_f32_bf16 v82, v18, v82, 0
    v_dot2_f32_bf16 v22, v18, v22, 0
    v_dot2_f32_bf16 v83, v19, v83, 0
    v_dot2_f32_bf16 v23, v19, v23, 0
    v_cvt_pk_bf16_f32 v80, v80, v20
    v_cvt_pk_bf16_f32 v81, v81, v21
    v_cvt_pk_bf16_f32 v82, v82, v22
    v_cvt_pk_bf16_f32 v83, v83, v23
    v_dot2_f32_bf16 v72, v80, s72, v72
    v_dot2_f32_bf16 v73, v81, s72, v73
    v_dot2_f32_bf16 v74, v82, s72, v74
    v_dot2_f32_bf16 v75, v83, s72, v75
    s_waitcnt lgkmcnt(2)
    v_and_b32 v80, 0xffff, v28
    v_and_b32 v28, 0xffff0000, v28
    v_and_b32 v81, 0xffff, v29
    v_and_b32 v29, 0xffff0000, v29
    v_and_b32 v82, 0xffff, v30
    v_and_b32 v30, 0xffff0000, v30
    v_and_b32 v83, 0xffff, v31
    v_and_b32 v31, 0xffff0000, v31
    v_dot2_f32_bf16 v80, v24, v80, 0
    v_dot2_f32_bf16 v28, v24, v28, 0
    v_dot2_f32_bf16 v81, v25, v81, 0
    v_dot2_f32_bf16 v29, v25, v29, 0
    v_dot2_f32_bf16 v82, v26, v82, 0
    v_dot2_f32_bf16 v30, v26, v30, 0
    v_dot2_f32_bf16 v83, v27, v83, 0
    v_dot2_f32_bf16 v31, v27, v31, 0
    v_cvt_pk_bf16_f32 v80, v80, v28
    v_cvt_pk_bf16_f32 v81, v81, v29
    v_cvt_pk_bf16_f32 v82, v82, v30
    v_cvt_pk_bf16_f32 v83, v83, v31
    v_dot2_f32_bf16 v72, v80, s72, v72
    v_dot2_f32_bf16 v73, v81, s72, v73
    v_dot2_f32_bf16 v74, v82, s72, v74
    v_dot2_f32_bf16 v75, v83, s72, v75
    s_waitcnt lgkmcnt(0)
    v_and_b32 v80, 0xffff, v36
    v_and_b32 v36, 0xffff0000, v36
    v_and_b32 v81, 0xffff, v37
    v_and_b32 v37, 0xffff0000, v37
    v_and_b32 v82, 0xffff, v38
    v_and_b32 v38, 0xffff0000, v38
    v_and_b32 v83, 0xffff, v39
    v_and_b32 v39, 0xffff0000, v39
    v_dot2_f32_bf16 v80, v32, v80, 0
    v_dot2_f32_bf16 v36, v32, v36, 0
    v_dot2_f32_bf16 v81, v33, v81, 0
    v_dot2_f32_bf16 v37, v33, v37, 0
    v_dot2_f32_bf16 v82, v34, v82, 0
    v_dot2_f32_bf16 v38, v34, v38, 0
    v_dot2_f32_bf16 v83, v35, v83, 0
    v_dot2_f32_bf16 v39, v35, v39, 0
    v_cvt_pk_bf16_f32 v80, v80, v36
    v_cvt_pk_bf16_f32 v81, v81, v37
    v_cvt_pk_bf16_f32 v82, v82, v38
    v_cvt_pk_bf16_f32 v83, v83, v39
    v_dot2_f32_bf16 v72, v80, s72, v72
    v_dot2_f32_bf16 v73, v81, s72, v73
    v_dot2_f32_bf16 v74, v82, s72, v74
    v_dot2_f32_bf16 v75, v83, s72, v75
    s_barrier
    s_nop 1
    v_add_f32 v72, v72, v73
    v_add_f32 v74, v74, v75
    v_add_f32 v72, v72, v74
    v_mov_b32 v73, v72
    s_nop 1
    v_permlane32_swap_b32 v72, v73
    v_add_f32 v72, v72, v73
    v_cvt_pk_bf16_f32 v72, v72, v72
    v_and_b32 v72, 0xffff0000, v72
    v_mul_f32 v72, 0xbfb8aa3b, v72
    v_exp_f32 v72, v72
    s_nop 0
    v_add_f32 v72, 1.0, v72
    v_rcp_f32 v72, v72
    s_nop 0
    v_cvt_pk_bf16_f32 v72, v72, v72
    v_and_b32 v72, 0xffff0000, v72
    s_mov_b32 exec_hi, 0
    buffer_store_dword v72, v178, s[16:19], s73 offen sc1
    s_mov_b64 exec, -1
    s_add_u32 m0, s97, 49152
    s_add_u32 s71, s96, 786432
    s_sub_u32 s70, s71, 1966080
    s_cselect_b32 s71, s71, s70
    buffer_load_dwordx4 v157, s[12:15], s71 offen offset:0  lds
    buffer_load_dwordx4 v158, s[12:15], s71 offen offset:1024  lds
    buffer_load_dwordx4 v159, s[12:15], s71 offen offset:2048  lds
    s_add_u32 m0, s97, 52224
    s_add_u32 s71, s96, 835584
    s_sub_u32 s70, s71, 1966080
    s_cselect_b32 s71, s71, s70
    buffer_load_dwordx4 v157, s[12:15], s71 offen offset:0  lds
    buffer_load_dwordx4 v158, s[12:15], s71 offen offset:1024  lds
    buffer_load_dwordx4 v159, s[12:15], s71 offen offset:2048  lds
    s_add_u32 m0, s97, 24576
    s_add_u32 s71, s96, 1179648
    s_sub_u32 s70, s71, 1966080
    s_cselect_b32 s71, s71, s70
    buffer_load_dwordx4 v157, s[12:15], s71 offen offset:0  lds
    buffer_load_dwordx4 v158, s[12:15], s71 offen offset:1024  lds
    buffer_load_dwordx4 v159, s[12:15], s71 offen offset:2048  lds
    s_add_u32 m0, s97, 27648
    s_add_u32 s71, s96, 1228800
    s_sub_u32 s70, s71, 1966080
    s_cselect_b32 s71, s71, s70
    buffer_load_dwordx4 v157, s[12:15], s71 offen offset:0  lds
    buffer_load_dwordx4 v158, s[12:15], s71 offen offset:1024  lds
    buffer_load_dwordx4 v159, s[12:15], s71 offen offset:2048  lds
    s_waitcnt vmcnt(6)
    ds_add_u32 v7, v1 offset:16
    s_add_u32 m0, s97, 0
    s_add_u32 s71, s96, 1572864
    s_sub_u32 s70, s71, 1966080
    s_cselect_b32 s71, s71, s70
    buffer_load_dwordx4 v157, s[12:15], s71 offen offset:0  lds
    buffer_load_dwordx4 v158, s[12:15], s71 offen offset:1024  lds
    buffer_load_dwordx4 v159, s[12:15], s71 offen offset:2048  lds
    s_add_u32 m0, s97, 3072
    s_add_u32 s71, s96, 1622016
    s_sub_u32 s70, s71, 1966080
    s_cselect_b32 s71, s71, s70
    buffer_load_dwordx4 v157, s[12:15], s71 offen offset:0  lds
    buffer_load_dwordx4 v158, s[12:15], s71 offen offset:1024  lds
    buffer_load_dwordx4 v159, s[12:15], s71 offen offset:2048  lds
    s_waitcnt vmcnt(6)
    ds_add_u32 v7, v1 offset:20
    s_cmp_lg_u32 s52, 0
    s_cbranch_scc1 L_db_37
    s_load_dword s8, s[6:7], 0
    s_load_dword s9, s[6:7], 256
    s_load_dword s10, s[6:7], 512
    s_load_dword s11, s[6:7], 768
L_db_37:
    s_waitcnt vmcnt(0)
    ds_add_u32 v7, v1 offset:24
    s_cmp_lg_u32 s52, 0
    s_cbranch_scc1 L_db_38
    s_waitcnt lgkmcnt(0)
    s_min_u32 s8, s8, s9
    s_min_u32 s8, s8, s10
    s_min_u32 s8, s8, s11
    s_cmp_lt_u32 s8, 64
    s_cbranch_scc1 L_db_38
    ds_add_u32 v7, v1 offset:4
L_db_38:
L_qjoin:
    s_waitcnt vmcnt(0)
L_qdr:
    ds_add_rtn_u32 v126, v7, v1 offset:0
    s_waitcnt lgkmcnt(0)
    v_readfirstlane_b32 s74, v126
    s_cmp_lg_u32 s74, 3
    s_cbranch_scc1 L_join_39
    s_cmp_lg_u32 s54, 15
    s_cbranch_scc1 L_d1qkv
    s_atomic_add s3, s[4:5], 0
    s_atomic_add s3, s[4:5], 256
    s_atomic_add s3, s[4:5], 512
    s_atomic_add s3, s[4:5], 768
    s_atomic_add s3, s[4:5], 1024
    s_atomic_add s3, s[4:5], 1280
    s_atomic_add s3, s[4:5], 1536
    s_atomic_add s3, s[4:5], 1792
    s_atomic_add s3, s[4:5], 2048
    s_atomic_add s3, s[4:5], 2304
    s_atomic_add s3, s[4:5], 2560
    s_atomic_add s3, s[4:5], 2816
    s_atomic_add s3, s[4:5], 3072
    s_atomic_add s3, s[4:5], 3328
    s_atomic_add s3, s[4:5], 3584
    s_atomic_add s3, s[4:5], 3840
    s_atomic_add s3, s[4:5], 4096
    s_atomic_add s3, s[4:5], 4352
    s_atomic_add s3, s[4:5], 4608
    s_atomic_add s3, s[4:5], 4864
    s_atomic_add s3, s[4:5], 5120
    s_atomic_add s3, s[4:5], 5376
    s_atomic_add s3, s[4:5], 5632
    s_atomic_add s3, s[4:5], 5888
    s_atomic_add s3, s[4:5], 6144
    s_atomic_add s3, s[4:5], 6400
    s_atomic_add s3, s[4:5], 6656
    s_atomic_add s3, s[4:5], 6912
    s_atomic_add s3, s[4:5], 7168
    s_atomic_add s3, s[4:5], 7424
    s_atomic_add s3, s[4:5], 7680
    s_atomic_add s3, s[4:5], 7936
    s_branch L_d1done
L_d1qkv:
    s_atomic_add s3, s[4:5], 0
    s_atomic_add s3, s[4:5], 256
    s_atomic_add s3, s[4:5], 512
    s_atomic_add s3, s[4:5], 768
    s_atomic_add s3, s[4:5], 1024
    s_atomic_add s3, s[4:5], 1280
    s_atomic_add s3, s[4:5], 1536
    s_cmp_lg_u32 s47, 2
    s_cbranch_scc1 L_d1r0
    s_atomic_add s3, s[4:5], 1792
L_d1r0:
    s_cmp_lt_u32 s54, 5
    s_cbranch_scc1 L_d1done
    s_cmp_ge_u32 s53, 14
    s_cbranch_scc1 L_d1done
    s_atomic_add s3, s[4:5], 8192
    s_atomic_add s3, s[4:5], 8448
    s_atomic_add s3, s[4:5], 8704
    s_atomic_add s3, s[4:5], 8960
    s_atomic_add s3, s[4:5], 9216
    s_atomic_add s3, s[4:5], 9472
    s_atomic_add s3, s[4:5], 9728
    s_cmp_lg_u32 s47, 2
    s_cbranch_scc1 L_d1r1
    s_atomic_add s3, s[4:5], 9984
L_d1r1:
L_d1done:
L_join_39:
    s_cmp_ge_u32 s8, 64
    s_cbranch_scc1 L_dbok
    s_mov_b64 exec, 15
    v_cmp_gt_u32 vcc, 64, v177
    s_cbranch_vccnz L_vspin_40_s
L_vspun_41:
    s_mov_b64 exec, -1
    ds_add_u32 v7, v1 offset:4
L_dbok:
    s_mov_b32 s75, 0
L_aw_42:
    ds_read_b32 v126, v7 offset:4
    s_add_u32 s75, s75, 1
    s_cmp_gt_u32 s75, 4000000
    s_waitcnt lgkmcnt(0)
    s_cbranch_scc1 L_awd_43
    v_readfirstlane_b32 s74, v126
    s_cmp_lt_u32 s74, 1
    s_cbranch_scc1 L_aw_42
L_awd_43:
    s_mov_b32 s75, 0
L_aw_44:
    ds_read_b32 v126, v7 offset:80
    s_add_u32 s75, s75, 1
    s_cmp_gt_u32 s75, 4000000
    s_waitcnt lgkmcnt(0)
    s_cbranch_scc1 L_awd_45
    v_readfirstlane_b32 s74, v126
    s_cmp_lt_u32 s74, 4
    s_cbranch_scc1 L_aw_44
L_awd_45:
    s_add_u32 m0, s45, 77696
    s_add_u32 s68, s44, 17084416
    buffer_load_dwordx4 v2, s[16:19], s68 offen sc1 lds
    s_add_u32 m0, s45, 81792
    s_add_u32 s68, s44, 17088512
    buffer_load_dwordx4 v2, s[16:19], s68 offen sc1 lds
    s_add_u32 m0, s45, 85888
    s_add_u32 s68, s44, 17092608
    buffer_load_dwordx4 v2, s[16:19], s68 offen sc1 lds
    s_add_u32 m0, s45, 89984
    s_add_u32 s68, s44, 17096704
    buffer_load_dwordx4 v2, s[16:19], s68 offen sc1 lds
    s_add_u32 m0, s45, 94080
    s_add_u32 s68, s44, 17100800
    buffer_load_dwordx4 v2, s[16:19], s68 offen sc1 lds
    s_add_u32 m0, s45, 98176
    s_add_u32 s68, s44, 17104896
    buffer_load_dwordx4 v2, s[16:19], s68 offen sc1 lds
    s_add_u32 m0, s45, 102272
    s_add_u32 s68, s44, 17108992
    buffer_load_dwordx4 v2, s[16:19], s68 offen sc1 lds
    s_add_u32 m0, s45, 106368
    s_add_u32 s68, s44, 17113088
    buffer_load_dwordx4 v2, s[16:19], s68 offen sc1 lds
    s_add_u32 m0, s45, 110464
    s_add_u32 s68, s44, 17117184
    buffer_load_dwordx4 v2, s[16:19], s68 offen sc1 lds
    s_add_u32 m0, s45, 114560
    s_add_u32 s68, s44, 17121280
    buffer_load_dwordx4 v2, s[16:19], s68 offen sc1 lds
    s_mov_b32 s75, 0
L_aw_46:
    ds_read_b32 v126, v7 offset:88
    s_add_u32 s75, s75, 1
    s_cmp_gt_u32 s75, 4000000
    s_waitcnt lgkmcnt(0)
    s_cbranch_scc1 L_awd_47
    v_readfirstlane_b32 s74, v126
    s_cmp_lt_u32 s74, 4
    s_cbranch_scc1 L_aw_46
L_awd_47:
    s_add_u32 m0, s45, 53120
    s_add_u32 s68, s44, 17059840
    buffer_load_dwordx4 v2, s[16:19], s68 offen sc1 lds
    s_add_u32 m0, s45, 57216
    s_add_u32 s68, s44, 17063936
    buffer_load_dwordx4 v2, s[16:19], s68 offen sc1 lds
    s_add_u32 m0, s45, 61312
    s_add_u32 s68, s44, 17068032
    buffer_load_dwordx4 v2, s[16:19], s68 offen sc1 lds
    s_add_u32 m0, s45, 65408
    s_add_u32 s68, s44, 17072128
    buffer_load_dwordx4 v2, s[16:19], s68 offen sc1 lds
    s_add_u32 m0, s45, 69504
    s_add_u32 s68, s44, 17076224
    buffer_load_dwordx4 v2, s[16:19], s68 offen sc1 lds
    s_add_u32 m0, s45, 73600
    s_add_u32 s68, s44, 17080320
    buffer_load_dwordx4 v2, s[16:19], s68 offen sc1 lds
    s_cmp_lg_u32 s59, 0
    s_cbranch_scc1 L_p1_48
    s_mov_b32 s75, 0
L_spin_50:
    s_load_dword s34, s[32:33], 0 glc
    s_add_u32 s75, s75, 1
    s_cmp_gt_u32 s75, 200000
    s_cbranch_scc1 L_spun_52
L_spck_51:
    s_waitcnt lgkmcnt(0)
    s_cmp_lt_u32 s34, s46
    s_cbranch_scc1 L_spin_50
L_spun_52:
    s_waitcnt lgkmcnt(0)
    ds_add_u32 v7, v1 offset:48
    s_branch L_p1d_49
L_p1_48:
    s_mov_b32 s75, 0
L_aw_53:
    ds_read_b32 v126, v7 offset:48
    s_add_u32 s75, s75, 1
    s_cmp_gt_u32 s75, 4000000
    s_waitcnt lgkmcnt(0)
    s_cbranch_scc1 L_awd_54
    v_readfirstlane_b32 s74, v126
    s_cmp_lt_u32 s74, 1
    s_cbranch_scc1 L_aw_53
L_awd_54:
L_p1d_49:
    s_mov_b32 s75, 0
L_aw_55:
    ds_read_b32 v126, v7 offset:84
    s_add_u32 s75, s75, 1
    s_cmp_gt_u32 s75, 4000000
    s_waitcnt lgkmcnt(0)
    s_cbranch_scc1 L_awd_56
    v_readfirstlane_b32 s74, v126
    s_cmp_lt_u32 s74, 4
    s_cbranch_scc1 L_aw_55
L_awd_56:
    s_setprio 3
    s_mul_i32 s69, s59, 2560
    s_add_u32 s66, s38, s36
    s_add_u32 s67, s38, s37
    buffer_load_dwordx4 v[152:155], v174, s[16:19], s66 offen offset:512 sc1
    buffer_load_dwordx2 v[158:159], v175, s[16:19], s67 offen offset:512 sc1
    buffer_load_dwordx4 v[148:151], v174, s[16:19], s66 offen offset:0 sc1
    buffer_load_dwordx2 v[156:157], v175, s[16:19], s67 offen offset:0 sc1
    s_add_u32 s38, s38, 163840
    s_add_u32 m0, s45, 122752
    s_add_u32 s66, s38, s36
    buffer_load_dwordx4 v2, s[16:19], s66 offen sc1 lds
    s_add_u32 m0, s45, 130944
    s_add_u32 s66, s38, s36
    s_add_u32 s66, s66, 2048
    buffer_load_dwordx4 v2, s[16:19], s66 offen sc1 lds
    s_add_u32 m0, s45, 139136
    s_add_u32 s66, s38, s37
    buffer_load_dwordx4 v2, s[16:19], s66 offen sc1 lds
    s_add_u32 m0, s69, 153472
    s_nop 0
    buffer_load_dwordx4 v168, s[16:19], s40 offen offset:0 sc1 lds
    buffer_load_dwordx4 v169, s[16:19], s40 offen offset:1024 sc1 lds
    s_mov_b32 exec_hi, 0
    buffer_load_dwordx4 v170, s[16:19], s40 offen offset:2048 sc1 lds
    s_mov_b64 exec, -1
    s_add_u32 m0, s45, 118656
    s_add_u32 s66, s39, s36
    buffer_load_dwordx4 v2, s[16:19], s66 offen sc1 lds
    s_add_u32 m0, s45, 126848
    s_add_u32 s66, s39, s36
    s_add_u32 s66, s66, 2048
    buffer_load_dwordx4 v2, s[16:19], s66 offen sc1 lds
    s_add_u32 m0, s45, 135040
    s_add_u32 s66, s39, s37
    buffer_load_dwordx4 v2, s[16:19], s66 offen sc1 lds
    s_add_u32 m0, s69, 143232
    s_nop 0
    buffer_load_dwordx4 v168, s[16:19], s41 offen offset:0 sc1 lds
    buffer_load_dwordx4 v169, s[16:19], s41 offen offset:1024 sc1 lds
    s_mov_b32 exec_hi, 0
    buffer_load_dwordx4 v170, s[16:19], s41 offen offset:2048 sc1 lds
    s_mov_b64 exec, -1
    buffer_load_dword v166, v178, s[16:19], s43 offen offset:0 sc1
    buffer_load_dword v167, v178, s[16:19], s43 offen offset:128 sc1
    s_setprio 0
    s_waitcnt vmcnt(8)
    ds_add_u32 v7, v1 offset:40
    ds_read_b128 v[112:115], v160 offset:4608
    ds_read_b64 v[120:121], v161 offset:4608
    ds_read_b128 v[116:119], v160 offset:4096
    ds_read_b64 v[122:123], v161 offset:4096
    s_mov_b64 exec, s[76:77]
    ds_read_b128 v[224:227], v162 offset:11520
    ds_read_b128 v[228:231], v162 offset:12160
    s_mov_b64 exec, -1
    s_waitcnt lgkmcnt(4)
    v_mfma_f32_32x32x16_bf16 v[8:23], v[112:115], v[152:155], v[192:207]
    v_mfma_f32_32x32x8_bf16 v[8:23], v[120:121], v[158:159], v[8:23]
    s_waitcnt lgkmcnt(2)
    v_mfma_f32_32x32x16_bf16 v[24:39], v[116:119], v[152:155], 0
    s_nop 10
    v_exp_f32 v8, v8
    v_exp_f32 v9, v9
    v_exp_f32 v10, v10
    v_exp_f32 v11, v11
    v_mfma_f32_32x32x8_bf16 v[24:39], v[122:123], v[158:159], v[24:39]
    v_exp_f32 v12, v12
    v_exp_f32 v13, v13
    v_exp_f32 v14, v14
    v_exp_f32 v15, v15
    s_waitcnt lgkmcnt(0)
    v_cvt_pk_bf16_f32 v104, v8, v9
    v_cvt_pk_bf16_f32 v105, v10, v11
    v_cvt_pk_bf16_f32 v106, v12, v13
    v_cvt_pk_bf16_f32 v107, v14, v15
    v_exp_f32 v16, v16
    v_exp_f32 v17, v17
    v_mfma_f32_32x32x16_bf16 v[88:103], v[224:227], v[104:107], 0
    s_mov_b64 exec, s[76:77]
    ds_read_b128 v[232:235], v162 offset:10240
    ds_read_b128 v[236:239], v162 offset:10880
    s_mov_b64 exec, -1
    v_exp_f32 v18, v18
    v_exp_f32 v19, v19
    v_exp_f32 v20, v20
    v_exp_f32 v21, v21
    v_exp_f32 v22, v22
    v_exp_f32 v23, v23
    v_cvt_pk_bf16_f32 v108, v16, v17
    v_cvt_pk_bf16_f32 v109, v18, v19
    v_cvt_pk_bf16_f32 v110, v20, v21
    v_cvt_pk_bf16_f32 v111, v22, v23
    v_mfma_f32_32x32x16_bf16 v[8:23], v[116:119], v[148:151], v[192:207]
    v_exp_f32 v24, v24
    v_exp_f32 v25, v25
    v_exp_f32 v26, v26
    v_exp_f32 v27, v27
    v_mfma_f32_32x32x8_bf16 v[8:23], v[122:123], v[156:157], v[8:23]
    v_exp_f32 v28, v28
    v_exp_f32 v29, v29
    v_exp_f32 v30, v30
    v_exp_f32 v31, v31
    v_mfma_f32_32x32x16_bf16 v[88:103], v[228:231], v[108:111], v[88:103]
    s_waitcnt lgkmcnt(0)
    v_cvt_pk_bf16_f32 v104, v24, v25
    v_cvt_pk_bf16_f32 v105, v26, v27
    v_cvt_pk_bf16_f32 v106, v28, v29
    v_cvt_pk_bf16_f32 v107, v30, v31
    v_exp_f32 v32, v32
    v_exp_f32 v33, v33
    v_mfma_f32_32x32x16_bf16 v[88:103], v[232:235], v[104:107], v[88:103]
    v_exp_f32 v34, v34
    v_exp_f32 v35, v35
    s_waitcnt vmcnt(2)
    ds_add_u32 v7, v1 offset:36
    ds_read_b32 v126, v7 offset:36
    v_exp_f32 v36, v36
    v_exp_f32 v37, v37
    v_exp_f32 v38, v38
    v_exp_f32 v39, v39
    s_waitcnt lgkmcnt(0)
    v_readfirstlane_b32 s74, v126
    s_cmp_lt_u32 s74, 4
    s_cbranch_scc1 L_aw_57_s
L_awd_58:
    ds_read_b128 v[112:115], v160 offset:3584
    ds_read_b64 v[120:121], v161 offset:3584
    ds_read_b128 v[116:119], v160 offset:3072
    ds_read_b64 v[122:123], v161 offset:3072
    s_mov_b64 exec, s[76:77]
    ds_read_b128 v[224:227], v162 offset:8960
    ds_read_b128 v[228:231], v162 offset:9600
    s_mov_b64 exec, -1
    v_cvt_pk_bf16_f32 v108, v32, v33
    v_cvt_pk_bf16_f32 v109, v34, v35
    v_cvt_pk_bf16_f32 v110, v36, v37
    v_cvt_pk_bf16_f32 v111, v38, v39
    s_waitcnt lgkmcnt(4)
    v_mfma_f32_32x32x16_bf16 v[24:39], v[112:115], v[152:155], 0
    s_cmp_eq_u32 s78, 1
    v_exp_f32 v8, v8
    v_exp_f32 v9, v9
    v_exp_f32 v10, v10
    v_exp_f32 v11, v11
    v_mfma_f32_32x32x8_bf16 v[24:39], v[120:121], v[158:159], v[24:39]
    v_exp_f32 v12, v12
    v_exp_f32 v13, v13
    v_exp_f32 v14, v14
    v_exp_f32 v15, v15
    v_mfma_f32_32x32x16_bf16 v[88:103], v[236:239], v[108:111], v[88:103]
    v_cvt_pk_bf16_f32 v104, v8, v9
    v_cvt_pk_bf16_f32 v105, v10, v11
    v_cvt_pk_bf16_f32 v106, v12, v13
    v_cvt_pk_bf16_f32 v107, v14, v15
    v_exp_f32 v16, v16
    v_exp_f32 v17, v17
    v_mfma_f32_32x32x16_bf16 v[72:87], v[232:235], v[104:107], 0
    s_waitcnt lgkmcnt(2)
    v_exp_f32 v18, v18
    v_exp_f32 v19, v19
    v_exp_f32 v20, v20
    v_exp_f32 v21, v21
    v_exp_f32 v22, v22
    v_exp_f32 v23, v23
    v_cvt_pk_bf16_f32 v108, v16, v17
    v_cvt_pk_bf16_f32 v109, v18, v19
    v_cvt_pk_bf16_f32 v110, v20, v21
    v_cvt_pk_bf16_f32 v111, v22, v23
    s_cbranch_scc1 L_attn_done
    v_mfma_f32_32x32x16_bf16 v[8:23], v[112:115], v[148:151], 0
    v_exp_f32 v24, v24
    v_exp_f32 v25, v25
    v_exp_f32 v26, v26
    v_exp_f32 v27, v27
    v_mfma_f32_32x32x8_bf16 v[8:23], v[120:121], v[156:157], v[8:23]
    ds_read_b128 v[112:115], v160 offset:2560
    ds_read_b64 v[120:121], v161 offset:2560
    v_exp_f32 v28, v28
    v_exp_f32 v29, v29
    v_exp_f32 v30, v30
    v_exp_f32 v31, v31
    v_mfma_f32_32x32x16_bf16 v[72:87], v[236:239], v[108:111], v[72:87]
    s_waitcnt lgkmcnt(2)
    v_cvt_pk_bf16_f32 v104, v24, v25
    v_cvt_pk_bf16_f32 v105, v26, v27
    v_cvt_pk_bf16_f32 v106, v28, v29
    v_cvt_pk_bf16_f32 v107, v30, v31
    v_exp_f32 v32, v32
    v_exp_f32 v33, v33
    v_mfma_f32_32x32x16_bf16 v[88:103], v[224:227], v[104:107], v[88:103]
    s_mov_b64 exec, s[76:77]
    ds_read_b128 v[232:235], v162 offset:7680
    ds_read_b128 v[236:239], v162 offset:8320
    s_mov_b64 exec, -1
    v_exp_f32 v34, v34
    v_exp_f32 v35, v35
    v_exp_f32 v36, v36
    v_exp_f32 v37, v37
    v_exp_f32 v38, v38
    v_exp_f32 v39, v39
    v_cvt_pk_bf16_f32 v108, v32, v33
    v_cvt_pk_bf16_f32 v109, v34, v35
    v_cvt_pk_bf16_f32 v110, v36, v37
    v_cvt_pk_bf16_f32 v111, v38, v39
    v_mfma_f32_32x32x16_bf16 v[24:39], v[116:119], v[152:155], 0
    v_exp_f32 v8, v8
    v_exp_f32 v9, v9
    v_exp_f32 v10, v10
    v_exp_f32 v11, v11
    v_mfma_f32_32x32x8_bf16 v[24:39], v[122:123], v[158:159], v[24:39]
    v_exp_f32 v12, v12
    v_exp_f32 v13, v13
    v_exp_f32 v14, v14
    v_exp_f32 v15, v15
    v_mfma_f32_32x32x16_bf16 v[88:103], v[228:231], v[108:111], v[88:103]
    v_cvt_pk_bf16_f32 v104, v8, v9
    v_cvt_pk_bf16_f32 v105, v10, v11
    v_cvt_pk_bf16_f32 v106, v12, v13
    v_cvt_pk_bf16_f32 v107, v14, v15
    v_exp_f32 v16, v16
    v_exp_f32 v17, v17
    v_mfma_f32_32x32x16_bf16 v[72:87], v[224:227], v[104:107], v[72:87]
    s_waitcnt lgkmcnt(2)
    v_exp_f32 v18, v18
    v_exp_f32 v19, v19
    v_exp_f32 v20, v20
    v_exp_f32 v21, v21
    v_exp_f32 v22, v22
    v_exp_f32 v23, v23
    v_cvt_pk_bf16_f32 v108, v16, v17
    v_cvt_pk_bf16_f32 v109, v18, v19
    v_cvt_pk_bf16_f32 v110, v20, v21
    v_cvt_pk_bf16_f32 v111, v22, v23
    v_mfma_f32_32x32x16_bf16 v[8:23], v[116:119], v[148:151], 0
    v_exp_f32 v24, v24
    v_exp_f32 v25, v25
    v_exp_f32 v26, v26
    v_exp_f32 v27, v27
    v_mfma_f32_32x32x8_bf16 v[8:23], v[122:123], v[156:157], v[8:23]
    ds_read_b128 v[116:119], v160 offset:2048
    ds_read_b64 v[122:123], v161 offset:2048
    v_exp_f32 v28, v28
    v_exp_f32 v29, v29
    v_exp_f32 v30, v30
    v_exp_f32 v31, v31
    v_mfma_f32_32x32x16_bf16 v[72:87], v[228:231], v[108:111], v[72:87]
    s_waitcnt lgkmcnt(2)
    v_cvt_pk_bf16_f32 v104, v24, v25
    v_cvt_pk_bf16_f32 v105, v26, v27
    v_cvt_pk_bf16_f32 v106, v28, v29
    v_cvt_pk_bf16_f32 v107, v30, v31
    v_exp_f32 v32, v32
    v_exp_f32 v33, v33
    v_mfma_f32_32x32x16_bf16 v[88:103], v[232:235], v[104:107], v[88:103]
    s_mov_b64 exec, s[76:77]
    ds_read_b128 v[224:227], v162 offset:6400
    ds_read_b128 v[228:231], v162 offset:7040
    s_mov_b64 exec, -1
    v_exp_f32 v34, v34
    v_exp_f32 v35, v35
    v_exp_f32 v36, v36
    v_exp_f32 v37, v37
    v_exp_f32 v38, v38
    v_exp_f32 v39, v39
    v_cvt_pk_bf16_f32 v108, v32, v33
    v_cvt_pk_bf16_f32 v109, v34, v35
    v_cvt_pk_bf16_f32 v110, v36, v37
    v_cvt_pk_bf16_f32 v111, v38, v39
    v_mfma_f32_32x32x16_bf16 v[24:39], v[112:115], v[152:155], 0
    s_cmp_eq_u32 s78, 3
    v_exp_f32 v8, v8
    v_exp_f32 v9, v9
    v_exp_f32 v10, v10
    v_exp_f32 v11, v11
    v_mfma_f32_32x32x8_bf16 v[24:39], v[120:121], v[158:159], v[24:39]
    v_exp_f32 v12, v12
    v_exp_f32 v13, v13
    v_exp_f32 v14, v14
    v_exp_f32 v15, v15
    v_mfma_f32_32x32x16_bf16 v[88:103], v[236:239], v[108:111], v[88:103]
    v_cvt_pk_bf16_f32 v104, v8, v9
    v_cvt_pk_bf16_f32 v105, v10, v11
    v_cvt_pk_bf16_f32 v106, v12, v13
    v_cvt_pk_bf16_f32 v107, v14, v15
    v_exp_f32 v16, v16
    v_exp_f32 v17, v17
    v_mfma_f32_32x32x16_bf16 v[72:87], v[232:235], v[104:107], v[72:87]
    s_waitcnt lgkmcnt(2)
    v_exp_f32 v18, v18
    v_exp_f32 v19, v19
    v_exp_f32 v20, v20
    v_exp_f32 v21, v21
    v_exp_f32 v22, v22
    v_exp_f32 v23, v23
    v_cvt_pk_bf16_f32 v108, v16, v17
    v_cvt_pk_bf16_f32 v109, v18, v19
    v_cvt_pk_bf16_f32 v110, v20, v21
    v_cvt_pk_bf16_f32 v111, v22, v23
    s_cbranch_scc1 L_attn_done
    v_mfma_f32_32x32x16_bf16 v[8:23], v[112:115], v[148:151], 0
    v_exp_f32 v24, v24
    v_exp_f32 v25, v25
    v_exp_f32 v26, v26
    v_exp_f32 v27, v27
    v_mfma_f32_32x32x8_bf16 v[8:23], v[120:121], v[156:157], v[8:23]
    ds_read_b128 v[112:115], v160 offset:1536
    ds_read_b64 v[120:121], v161 offset:1536
    v_exp_f32 v28, v28
    v_exp_f32 v29, v29
    v_exp_f32 v30, v30
    v_exp_f32 v31, v31
    v_mfma_f32_32x32x16_bf16 v[72:87], v[236:239], v[108:111], v[72:87]
    s_waitcnt lgkmcnt(2)
    v_cvt_pk_bf16_f32 v104, v24, v25
    v_cvt_pk_bf16_f32 v105, v26, v27
    v_cvt_pk_bf16_f32 v106, v28, v29
    v_cvt_pk_bf16_f32 v107, v30, v31
    v_exp_f32 v32, v32
    v_exp_f32 v33, v33
    v_mfma_f32_32x32x16_bf16 v[88:103], v[224:227], v[104:107], v[88:103]
    s_mov_b64 exec, s[76:77]
    ds_read_b128 v[232:235], v162 offset:5120
    ds_read_b128 v[236:239], v162 offset:5760
    s_mov_b64 exec, -1
    v_exp_f32 v34, v34
    v_exp_f32 v35, v35
    v_exp_f32 v36, v36
    v_exp_f32 v37, v37
    v_exp_f32 v38, v38
    v_exp_f32 v39, v39
    v_cvt_pk_bf16_f32 v108, v32, v33
    v_cvt_pk_bf16_f32 v109, v34, v35
    v_cvt_pk_bf16_f32 v110, v36, v37
    v_cvt_pk_bf16_f32 v111, v38, v39
    v_mfma_f32_32x32x16_bf16 v[24:39], v[116:119], v[152:155], 0
    v_exp_f32 v8, v8
    v_exp_f32 v9, v9
    v_exp_f32 v10, v10
    v_exp_f32 v11, v11
    v_mfma_f32_32x32x8_bf16 v[24:39], v[122:123], v[158:159], v[24:39]
    v_exp_f32 v12, v12
    v_exp_f32 v13, v13
    v_exp_f32 v14, v14
    v_exp_f32 v15, v15
    v_mfma_f32_32x32x16_bf16 v[88:103], v[228:231], v[108:111], v[88:103]
    v_cvt_pk_bf16_f32 v104, v8, v9
    v_cvt_pk_bf16_f32 v105, v10, v11
    v_cvt_pk_bf16_f32 v106, v12, v13
    v_cvt_pk_bf16_f32 v107, v14, v15
    v_exp_f32 v16, v16
    v_exp_f32 v17, v17
    v_mfma_f32_32x32x16_bf16 v[72:87], v[224:227], v[104:107], v[72:87]
    s_waitcnt lgkmcnt(2)
    v_exp_f32 v18, v18
    v_exp_f32 v19, v19
    v_exp_f32 v20, v20
    v_exp_f32 v21, v21
    v_exp_f32 v22, v22
    v_exp_f32 v23, v23
    v_cvt_pk_bf16_f32 v108, v16, v17
    v_cvt_pk_bf16_f32 v109, v18, v19
    v_cvt_pk_bf16_f32 v110, v20, v21
    v_cvt_pk_bf16_f32 v111, v22, v23
    v_mfma_f32_32x32x16_bf16 v[8:23], v[116:119], v[148:151], 0
    v_exp_f32 v24, v24
    v_exp_f32 v25, v25
    v_exp_f32 v26, v26
    v_exp_f32 v27, v27
    v_mfma_f32_32x32x8_bf16 v[8:23], v[122:123], v[156:157], v[8:23]
    ds_read_b128 v[116:119], v160 offset:1024
    ds_read_b64 v[122:123], v161 offset:1024
    v_exp_f32 v28, v28
    v_exp_f32 v29, v29
    v_exp_f32 v30, v30
    v_exp_f32 v31, v31
    v_mfma_f32_32x32x16_bf16 v[72:87], v[228:231], v[108:111], v[72:87]
    s_waitcnt lgkmcnt(2)
    v_cvt_pk_bf16_f32 v104, v24, v25
    v_cvt_pk_bf16_f32 v105, v26, v27
    v_cvt_pk_bf16_f32 v106, v28, v29
    v_cvt_pk_bf16_f32 v107, v30, v31
    v_exp_f32 v32, v32
    v_exp_f32 v33, v33
    v_mfma_f32_32x32x16_bf16 v[88:103], v[232:235], v[104:107], v[88:103]
    s_mov_b64 exec, s[76:77]
    ds_read_b128 v[224:227], v162 offset:3840
    ds_read_b128 v[228:231], v162 offset:4480
    s_mov_b64 exec, -1
    v_exp_f32 v34, v34
    v_exp_f32 v35, v35
    v_exp_f32 v36, v36
    v_exp_f32 v37, v37
    v_exp_f32 v38, v38
    v_exp_f32 v39, v39
    v_cvt_pk_bf16_f32 v108, v32, v33
    v_cvt_pk_bf16_f32 v109, v34, v35
    v_cvt_pk_bf16_f32 v110, v36, v37
    v_cvt_pk_bf16_f32 v111, v38, v39
    v_mfma_f32_32x32x16_bf16 v[24:39], v[112:115], v[152:155], 0
    s_cmp_eq_u32 s78, 5
    v_exp_f32 v8, v8
    v_exp_f32 v9, v9
    v_exp_f32 v10, v10
    v_exp_f32 v11, v11
    v_mfma_f32_32x32x8_bf16 v[24:39], v[120:121], v[158:159], v[24:39]
    v_exp_f32 v12, v12
    v_exp_f32 v13, v13
    v_exp_f32 v14, v14
    v_exp_f32 v15, v15
    v_mfma_f32_32x32x16_bf16 v[88:103], v[236:239], v[108:111], v[88:103]
    v_cvt_pk_bf16_f32 v104, v8, v9
    v_cvt_pk_bf16_f32 v105, v10, v11
    v_cvt_pk_bf16_f32 v106, v12, v13
    v_cvt_pk_bf16_f32 v107, v14, v15
    v_exp_f32 v16, v16
    v_exp_f32 v17, v17
    v_mfma_f32_32x32x16_bf16 v[72:87], v[232:235], v[104:107], v[72:87]
    s_waitcnt lgkmcnt(2)
    v_exp_f32 v18, v18
    v_exp_f32 v19, v19
    v_exp_f32 v20, v20
    v_exp_f32 v21, v21
    v_exp_f32 v22, v22
    v_exp_f32 v23, v23
    v_cvt_pk_bf16_f32 v108, v16, v17
    v_cvt_pk_bf16_f32 v109, v18, v19
    v_cvt_pk_bf16_f32 v110, v20, v21
    v_cvt_pk_bf16_f32 v111, v22, v23
    s_cbranch_scc1 L_attn_done
    v_mfma_f32_32x32x16_bf16 v[8:23], v[112:115], v[148:151], 0
    v_exp_f32 v24, v24
    v_exp_f32 v25, v25
    v_exp_f32 v26, v26
    v_exp_f32 v27, v27
    v_mfma_f32_32x32x8_bf16 v[8:23], v[120:121], v[156:157], v[8:23]
    ds_read_b128 v[112:115], v160 offset:512
    ds_read_b64 v[120:121], v161 offset:512
    v_exp_f32 v28, v28
    v_exp_f32 v29, v29
    v_exp_f32 v30, v30
    v_exp_f32 v31, v31
    v_mfma_f32_32x32x16_bf16 v[72:87], v[236:239], v[108:111], v[72:87]
    s_waitcnt lgkmcnt(2)
    v_cvt_pk_bf16_f32 v104, v24, v25
    v_cvt_pk_bf16_f32 v105, v26, v27
    v_cvt_pk_bf16_f32 v106, v28, v29
    v_cvt_pk_bf16_f32 v107, v30, v31
    v_exp_f32 v32, v32
    v_exp_f32 v33, v33
    v_mfma_f32_32x32x16_bf16 v[88:103], v[224:227], v[104:107], v[88:103]
    s_mov_b64 exec, s[76:77]
    ds_read_b128 v[232:235], v162 offset:2560
    ds_read_b128 v[236:239], v162 offset:3200
    s_mov_b64 exec, -1
    v_exp_f32 v34, v34
    v_exp_f32 v35, v35
    v_exp_f32 v36, v36
    v_exp_f32 v37, v37
    v_exp_f32 v38, v38
    v_exp_f32 v39, v39
    v_cvt_pk_bf16_f32 v108, v32, v33
    v_cvt_pk_bf16_f32 v109, v34, v35
    v_cvt_pk_bf16_f32 v110, v36, v37
    v_cvt_pk_bf16_f32 v111, v38, v39
    v_mfma_f32_32x32x16_bf16 v[24:39], v[116:119], v[152:155], 0
    v_exp_f32 v8, v8
    v_exp_f32 v9, v9
    v_exp_f32 v10, v10
    v_exp_f32 v11, v11
    v_mfma_f32_32x32x8_bf16 v[24:39], v[122:123], v[158:159], v[24:39]
    v_exp_f32 v12, v12
    v_exp_f32 v13, v13
    v_exp_f32 v14, v14
    v_exp_f32 v15, v15
    v_mfma_f32_32x32x16_bf16 v[88:103], v[228:231], v[108:111], v[88:103]
    v_cvt_pk_bf16_f32 v104, v8, v9
    v_cvt_pk_bf16_f32 v105, v10, v11
    v_cvt_pk_bf16_f32 v106, v12, v13
    v_cvt_pk_bf16_f32 v107, v14, v15
    v_exp_f32 v16, v16
    v_exp_f32 v17, v17
    v_mfma_f32_32x32x16_bf16 v[72:87], v[224:227], v[104:107], v[72:87]
    s_waitcnt lgkmcnt(2)
    v_exp_f32 v18, v18
    v_exp_f32 v19, v19
    v_exp_f32 v20, v20
    v_exp_f32 v21, v21
    v_exp_f32 v22, v22
    v_exp_f32 v23, v23
    v_cvt_pk_bf16_f32 v108, v16, v17
    v_cvt_pk_bf16_f32 v109, v18, v19
    v_cvt_pk_bf16_f32 v110, v20, v21
    v_cvt_pk_bf16_f32 v111, v22, v23
    v_mfma_f32_32x32x16_bf16 v[8:23], v[116:119], v[148:151], 0
    v_exp_f32 v24, v24
    v_exp_f32 v25, v25
    v_exp_f32 v26, v26
    v_exp_f32 v27, v27
    v_mfma_f32_32x32x8_bf16 v[8:23], v[122:123], v[156:157], v[8:23]
    ds_read_b128 v[116:119], v160 offset:0
    ds_read_b64 v[122:123], v161 offset:0
    v_exp_f32 v28, v28
    v_exp_f32 v29, v29
    v_exp_f32 v30, v30
    v_exp_f32 v31, v31
    v_mfma_f32_32x32x16_bf16 v[72:87], v[228:231], v[108:111], v[72:87]
    s_waitcnt lgkmcnt(2)
    v_cvt_pk_bf16_f32 v104, v24, v25
    v_cvt_pk_bf16_f32 v105, v26, v27
    v_cvt_pk_bf16_f32 v106, v28, v29
    v_cvt_pk_bf16_f32 v107, v30, v31
    v_exp_f32 v32, v32
    v_exp_f32 v33, v33
    v_mfma_f32_32x32x16_bf16 v[88:103], v[232:235], v[104:107], v[88:103]
    s_mov_b64 exec, s[76:77]
    ds_read_b128 v[224:227], v162 offset:1280
    ds_read_b128 v[228:231], v162 offset:1920
    s_mov_b64 exec, -1
    v_exp_f32 v34, v34
    v_exp_f32 v35, v35
    v_exp_f32 v36, v36
    v_exp_f32 v37, v37
    v_exp_f32 v38, v38
    v_exp_f32 v39, v39
    v_cvt_pk_bf16_f32 v108, v32, v33
    v_cvt_pk_bf16_f32 v109, v34, v35
    v_cvt_pk_bf16_f32 v110, v36, v37
    v_cvt_pk_bf16_f32 v111, v38, v39
    v_mfma_f32_32x32x16_bf16 v[24:39], v[112:115], v[152:155], v[208:223]
    s_cmp_eq_u32 s78, 7
    v_exp_f32 v8, v8
    v_exp_f32 v9, v9
    v_exp_f32 v10, v10
    v_exp_f32 v11, v11
    v_mfma_f32_32x32x8_bf16 v[24:39], v[120:121], v[158:159], v[24:39]
    v_exp_f32 v12, v12
    v_exp_f32 v13, v13
    v_exp_f32 v14, v14
    v_exp_f32 v15, v15
    v_mfma_f32_32x32x16_bf16 v[88:103], v[236:239], v[108:111], v[88:103]
    v_cvt_pk_bf16_f32 v104, v8, v9
    v_cvt_pk_bf16_f32 v105, v10, v11
    v_cvt_pk_bf16_f32 v106, v12, v13
    v_cvt_pk_bf16_f32 v107, v14, v15
    v_exp_f32 v16, v16
    v_exp_f32 v17, v17
    v_mfma_f32_32x32x16_bf16 v[72:87], v[232:235], v[104:107], v[72:87]
    s_waitcnt lgkmcnt(2)
    v_exp_f32 v18, v18
    v_exp_f32 v19, v19
    v_exp_f32 v20, v20
    v_exp_f32 v21, v21
    v_exp_f32 v22, v22
    v_exp_f32 v23, v23
    v_cvt_pk_bf16_f32 v108, v16, v17
    v_cvt_pk_bf16_f32 v109, v18, v19
    v_cvt_pk_bf16_f32 v110, v20, v21
    v_cvt_pk_bf16_f32 v111, v22, v23
    s_cbranch_scc1 L_attn_done
    v_mfma_f32_32x32x16_bf16 v[8:23], v[112:115], v[148:151], 0
    v_exp_f32 v24, v24
    v_exp_f32 v25, v25
    v_exp_f32 v26, v26
    v_exp_f32 v27, v27
    v_mfma_f32_32x32x8_bf16 v[8:23], v[120:121], v[156:157], v[8:23]
    v_exp_f32 v28, v28
    v_exp_f32 v29, v29
    v_exp_f32 v30, v30
    v_exp_f32 v31, v31
    v_mfma_f32_32x32x16_bf16 v[72:87], v[236:239], v[108:111], v[72:87]
    s_waitcnt lgkmcnt(0)
    v_cvt_pk_bf16_f32 v104, v24, v25
    v_cvt_pk_bf16_f32 v105, v26, v27
    v_cvt_pk_bf16_f32 v106, v28, v29
    v_cvt_pk_bf16_f32 v107, v30, v31
    v_exp_f32 v32, v32
    v_exp_f32 v33, v33
    v_mfma_f32_32x32x16_bf16 v[88:103], v[224:227], v[104:107], v[88:103]
    s_mov_b64 exec, s[76:77]
    ds_read_b128 v[232:235], v162 offset:0
    ds_read_b128 v[236:239], v162 offset:640
    s_mov_b64 exec, -1
    v_exp_f32 v34, v34
    v_exp_f32 v35, v35
    v_exp_f32 v36, v36
    v_exp_f32 v37, v37
    v_exp_f32 v38, v38
    v_exp_f32 v39, v39
    v_cvt_pk_bf16_f32 v108, v32, v33
    v_cvt_pk_bf16_f32 v109, v34, v35
    v_cvt_pk_bf16_f32 v110, v36, v37
    v_cvt_pk_bf16_f32 v111, v38, v39
    v_mfma_f32_32x32x16_bf16 v[24:39], v[116:119], v[148:151], v[208:223]
    v_exp_f32 v8, v8
    v_exp_f32 v9, v9
    v_exp_f32 v10, v10
    v_exp_f32 v11, v11
    v_mfma_f32_32x32x8_bf16 v[24:39], v[122:123], v[156:157], v[24:39]
    v_exp_f32 v12, v12
    v_exp_f32 v13, v13
    v_exp_f32 v14, v14
    v_exp_f32 v15, v15
    v_mfma_f32_32x32x16_bf16 v[88:103], v[228:231], v[108:111], v[88:103]
    v_cvt_pk_bf16_f32 v104, v8, v9
    v_cvt_pk_bf16_f32 v105, v10, v11
    v_cvt_pk_bf16_f32 v106, v12, v13
    v_cvt_pk_bf16_f32 v107, v14, v15
    v_exp_f32 v16, v16
    v_exp_f32 v17, v17
    v_mfma_f32_32x32x16_bf16 v[72:87], v[224:227], v[104:107], v[72:87]
    v_exp_f32 v18, v18
    v_exp_f32 v19, v19
    v_exp_f32 v20, v20
    v_exp_f32 v21, v21
    v_exp_f32 v22, v22
    v_exp_f32 v23, v23
    v_cvt_pk_bf16_f32 v108, v16, v17
    v_cvt_pk_bf16_f32 v109, v18, v19
    v_cvt_pk_bf16_f32 v110, v20, v21
    v_cvt_pk_bf16_f32 v111, v22, v23
    v_exp_f32 v24, v24
    v_exp_f32 v25, v25
    v_exp_f32 v26, v26
    v_exp_f32 v27, v27
    v_exp_f32 v28, v28
    v_exp_f32 v29, v29
    v_exp_f32 v30, v30
    v_exp_f32 v31, v31
    v_mfma_f32_32x32x16_bf16 v[72:87], v[228:231], v[108:111], v[72:87]
    s_waitcnt lgkmcnt(0)
    v_cvt_pk_bf16_f32 v104, v24, v25
    v_cvt_pk_bf16_f32 v105, v26, v27
    v_cvt_pk_bf16_f32 v106, v28, v29
    v_cvt_pk_bf16_f32 v107, v30, v31
    v_exp_f32 v32, v32
    v_exp_f32 v33, v33
    v_mfma_f32_32x32x16_bf16 v[72:87], v[232:235], v[104:107], v[72:87]
    v_exp_f32 v34, v34
    v_exp_f32 v35, v35
    v_exp_f32 v36, v36
    v_exp_f32 v37, v37
    v_exp_f32 v38, v38
    v_exp_f32 v39, v39
    v_cvt_pk_bf16_f32 v108, v32, v33
    v_cvt_pk_bf16_f32 v109, v34, v35
    v_cvt_pk_bf16_f32 v110, v36, v37
    v_cvt_pk_bf16_f32 v111, v38, v39
L_attn_done:
    s_setprio 3
    s_nop 0
    v_mfma_f32_32x32x16_bf16 v[72:87], v[236:239], v[108:111], v[72:87]
    s_waitcnt lgkmcnt(0)
    s_mov_b32 s66, 0x2b800000
    s_mov_b32 s67, 0x53800000
    s_mov_b32 s70, 0x7b800000
    v_maximum3_f32 v126, |v88|, |v89|, |v90|
    v_maximum3_f32 v126, |v91|, |v92|, v126
    v_maximum3_f32 v126, |v93|, |v94|, v126
    v_maximum3_f32 v126, |v95|, |v96|, v126
    v_maximum3_f32 v126, |v97|, |v98|, v126
    s_nop 2
    v_maximum3_f32 v126, |v99|, |v72|, v126
    v_maximum3_f32 v126, |v73|, |v74|, v126
    v_maximum3_f32 v126, |v75|, |v76|, v126
    v_maximum3_f32 v126, |v77|, |v78|, v126
    v_maximum3_f32 v126, |v79|, |v80|, v126
    v_maximum3_f32 v126, |v81|, |v82|, v126
    v_maximum3_f32 v126, |v83|, v126, v126
    v_min_f32 v128, v84, v100
    v_add_f32 v129, v84, v100
    v_cmp_lt_f32 vcc, s66, v128
    v_cmp_gt_f32 s[68:69], s67, v129
    v_cmp_gt_f32 s[72:73], s70, v126
    s_nop 0
    s_and_b64 vcc, vcc, s[68:69]
    s_and_b64 vcc, vcc, s[72:73]
    s_cmp_eq_u64 vcc, -1
    s_cbranch_scc0 L_safe
L_attn_norm:
    v_rcp_f32 v126, v84
    v_rcp_f32 v127, v100
    s_lshl_b32 s66, s56, 9
    s_add_u32 s66, s66, s42
    s_lshl_b32 s67, s56, 7
    s_add_u32 s67, s67, s42
    s_add_u32 s67, s67, 16384
    s_waitcnt vmcnt(0)
    v_mul_f32 v126, v126, v166
    v_mul_f32 v127, v127, v167
    v_mul_f32 v72, v126, v72
    v_mul_f32 v73, v126, v73
    v_mul_f32 v74, v126, v74
    v_mul_f32 v75, v126, v75
    v_mul_f32 v76, v126, v76
    v_mul_f32 v77, v126, v77
    v_mul_f32 v78, v126, v78
    v_mul_f32 v79, v126, v79
    v_mul_f32 v80, v126, v80
    v_mul_f32 v81, v126, v81
    v_mul_f32 v82, v126, v82
    v_mul_f32 v83, v126, v83
    v_cvt_pk_bf16_f32 v104, v72, v73
    v_cvt_pk_bf16_f32 v105, v74, v75
    v_cvt_pk_bf16_f32 v106, v76, v77
    v_cvt_pk_bf16_f32 v107, v78, v79
    v_cvt_pk_bf16_f32 v108, v80, v81
    v_cvt_pk_bf16_f32 v109, v82, v83
    buffer_store_dwordx4 v[104:107], v163, s[16:19], s66 offen sc1
    buffer_store_dwordx2 v[108:109], v164, s[16:19], s67 offen sc1
    s_add_u32 s66, s66, 40960
    s_add_u32 s67, s67, 40960
    v_mul_f32 v88, v127, v88
    v_mul_f32 v89, v127, v89
    v_mul_f32 v90, v127, v90
    v_mul_f32 v91, v127, v91
    v_mul_f32 v92, v127, v92
    v_mul_f32 v93, v127, v93
    v_mul_f32 v94, v127, v94
    v_mul_f32 v95, v127, v95
    v_mul_f32 v96, v127, v96
    v_mul_f32 v97, v127, v97
    v_mul_f32 v98, v127, v98
    v_mul_f32 v99, v127, v99
    v_cvt_pk_bf16_f32 v8, v88, v89
    v_cvt_pk_bf16_f32 v9, v90, v91
    v_cvt_pk_bf16_f32 v10, v92, v93
    v_cvt_pk_bf16_f32 v11, v94, v95
    v_cvt_pk_bf16_f32 v12, v96, v97
    v_cvt_pk_bf16_f32 v13, v98, v99
    buffer_store_dwordx4 v[8:11], v163, s[16:19], s66 offen sc1
    buffer_store_dwordx2 v[12:13], v164, s[16:19], s67 offen sc1
    s_lshl3_add_u32 s66, s57, s58
    s_lshl2_add_u32 s66, s66, s59
    s_lshl_b32 s66, s66, 8
    s_add_u32 s32, s66, 19898368
    s_add_u32 s32, s50, s32
    s_addc_u32 s33, s51, 0
    s_lshl2_add_u32 s66, s55, s59
    s_lshl_b32 s66, s66, 5
    s_lshr_b32 s67, s56, 3
    s_add_u32 s66, s66, s67
    s_lshl_b32 s66, s66, 8
    s_add_u32 s66, s66, 19898368
    s_add_u32 s66, s50, s66
    s_addc_u32 s67, s51, 0
    v_lshl_add_u32 v241, s59, 2, v7
    s_waitcnt vmcnt(0)
    s_atomic_add s3, s[66:67], 0
    s_atomic_add s3, s[66:67], 1024
    s_atomic_add s3, s[66:67], 2048
    s_atomic_add s3, s[66:67], 3072
    s_atomic_add s3, s[66:67], 4096
    s_atomic_add s3, s[66:67], 5120
    s_atomic_add s3, s[66:67], 6144
    s_atomic_add s3, s[66:67], 7168
    s_setprio 0
    s_mov_b32 s75, 0
L_spin_59:
    s_load_dword s34, s[32:33], 0 glc
    s_add_u32 s75, s75, 1
    s_cmp_gt_u32 s75, 200000
    s_cbranch_scc1 L_spun_61
L_spck_60:
    s_waitcnt lgkmcnt(0)
    s_cmp_lt_u32 s34, 8
    s_cbranch_scc1 L_spin_59
L_spun_61:
    s_waitcnt lgkmcnt(0)
    ds_add_u32 v241, v1 offset:96
    s_mul_i32 s60, s57, 81920
    s_mul_i32 s67, s58, 160
    s_add_u32 s60, s60, s67
    s_mul_i32 s66, s59, 40
    v_add_u32 v240, s66, v0
    v_mul_u32_u24 v241, 0x199a, v240
    v_lshrrev_b32 v241, 16, v241
    v_mul_u32_u24 v246, 1120, v241
    v_lshl_add_u32 v246, v240, 4, v246
    s_and_b32 s66, s59, 1
    s_mul_i32 s66, s66, 10256
    s_sub_u32 s67, 26512, s66
    s_add_u32 s66, s66, 16256
    v_lshl_add_u32 v242, v240, 4, s66
    v_lshl_add_u32 v243, v240, 4, s67
    v_add_u32 v244, 51200, v242
    v_add_u32 v245, 51200, v243
    s_mov_b32 s75, 0
L_aw_62:
    ds_read_b32 v240, v7 offset:64
    s_add_u32 s75, s75, 1
    s_cmp_gt_u32 s75, 4000000
    s_waitcnt lgkmcnt(0)
    s_cbranch_scc1 L_awd_63
    v_readfirstlane_b32 s74, v240
    s_cmp_lt_u32 s74, 4
    s_cbranch_scc1 L_aw_62
L_awd_63:
    s_setprio 3
    s_mov_b32 exec_hi, 0xff
    ds_read_b128 v[16:19], v242 offset:0
    ds_read_b128 v[20:23], v243 offset:0
    ds_read_b128 v[24:27], v242 offset:25600
    ds_read_b128 v[28:31], v243 offset:25600
    ds_read_b128 v[32:35], v244 offset:0
    ds_read_b128 v[36:39], v245 offset:0
    ds_read_b128 v[40:43], v244 offset:25600
    ds_read_b128 v[44:47], v245 offset:25600
    s_waitcnt lgkmcnt(4)
    v_add_f32 v16, v16, v24
    v_add_f32 v17, v17, v25
    v_add_f32 v18, v18, v26
    v_add_f32 v19, v19, v27
    v_add_f32 v20, v20, v28
    v_add_f32 v21, v21, v29
    v_add_f32 v22, v22, v30
    v_add_f32 v23, v23, v31
    s_waitcnt lgkmcnt(2)
    v_add_f32 v16, v16, v32
    v_add_f32 v17, v17, v33
    v_add_f32 v18, v18, v34
    v_add_f32 v19, v19, v35
    v_add_f32 v20, v20, v36
    v_add_f32 v21, v21, v37
    v_add_f32 v22, v22, v38
    v_add_f32 v23, v23, v39
    s_waitcnt lgkmcnt(0)
    v_add_f32 v16, v16, v40
    v_add_f32 v17, v17, v41
    v_add_f32 v18, v18, v42
    v_add_f32 v19, v19, v43
    v_add_f32 v20, v20, v44
    v_add_f32 v21, v21, v45
    v_add_f32 v22, v22, v46
    v_add_f32 v23, v23, v47
    v_cvt_pk_bf16_f32 v48, v16, v17
    v_cvt_pk_bf16_f32 v49, v18, v19
    v_cvt_pk_bf16_f32 v50, v20, v21
    v_cvt_pk_bf16_f32 v51, v22, v23
    buffer_store_dwordx4 v[48:51], v246, s[24:27], s60 offen nt
    s_add_u32 s60, s60, 20480
    s_mov_b32 s75, 0
L_aw_64:
    ds_read_b32 v240, v7 offset:68
    s_add_u32 s75, s75, 1
    s_cmp_gt_u32 s75, 4000000
    s_waitcnt lgkmcnt(0)
    s_cbranch_scc1 L_awd_65
    v_readfirstlane_b32 s74, v240
    s_cmp_lt_u32 s74, 4
    s_cbranch_scc1 L_aw_64
L_awd_65:
    s_mov_b32 exec_hi, 0xff
    ds_read_b128 v[56:59], v242 offset:2560
    ds_read_b128 v[60:63], v243 offset:2560
    ds_read_b128 v[64:67], v242 offset:28160
    ds_read_b128 v[68:71], v243 offset:28160
    ds_read_b128 v[72:75], v244 offset:2560
    ds_read_b128 v[76:79], v245 offset:2560
    ds_read_b128 v[80:83], v244 offset:28160
    ds_read_b128 v[84:87], v245 offset:28160
    s_waitcnt lgkmcnt(4)
    v_add_f32 v56, v56, v64
    v_add_f32 v57, v57, v65
    v_add_f32 v58, v58, v66
    v_add_f32 v59, v59, v67
    v_add_f32 v60, v60, v68
    v_add_f32 v61, v61, v69
    v_add_f32 v62, v62, v70
    v_add_f32 v63, v63, v71
    s_waitcnt lgkmcnt(2)
    v_add_f32 v56, v56, v72
    v_add_f32 v57, v57, v73
    v_add_f32 v58, v58, v74
    v_add_f32 v59, v59, v75
    v_add_f32 v60, v60, v76
    v_add_f32 v61, v61, v77
    v_add_f32 v62, v62, v78
    v_add_f32 v63, v63, v79
    s_waitcnt lgkmcnt(0)
    v_add_f32 v56, v56, v80
    v_add_f32 v57, v57, v81
    v_add_f32 v58, v58, v82
    v_add_f32 v59, v59, v83
    v_add_f32 v60, v60, v84
    v_add_f32 v61, v61, v85
    v_add_f32 v62, v62, v86
    v_add_f32 v63, v63, v87
    v_cvt_pk_bf16_f32 v88, v56, v57
    v_cvt_pk_bf16_f32 v89, v58, v59
    v_cvt_pk_bf16_f32 v90, v60, v61
    v_cvt_pk_bf16_f32 v91, v62, v63
    buffer_store_dwordx4 v[88:91], v246, s[24:27], s60 offen nt
    s_add_u32 s60, s60, 20480
    s_mov_b32 s75, 0
L_aw_66:
    ds_read_b32 v240, v7 offset:72
    s_add_u32 s75, s75, 1
    s_cmp_gt_u32 s75, 4000000
    s_waitcnt lgkmcnt(0)
    s_cbranch_scc1 L_awd_67
    v_readfirstlane_b32 s74, v240
    s_cmp_lt_u32 s74, 4
    s_cbranch_scc1 L_aw_66
L_awd_67:
    s_mov_b32 exec_hi, 0xff
    ds_read_b128 v[96:99], v242 offset:5120
    ds_read_b128 v[100:103], v243 offset:5120
    ds_read_b128 v[104:107], v242 offset:30720
    ds_read_b128 v[108:111], v243 offset:30720
    ds_read_b128 v[112:115], v244 offset:5120
    ds_read_b128 v[116:119], v245 offset:5120
    ds_read_b128 v[120:123], v244 offset:30720
    ds_read_b128 v[124:127], v245 offset:30720
    s_waitcnt lgkmcnt(4)
    v_add_f32 v96, v96, v104
    v_add_f32 v97, v97, v105
    v_add_f32 v98, v98, v106
    v_add_f32 v99, v99, v107
    v_add_f32 v100, v100, v108
    v_add_f32 v101, v101, v109
    v_add_f32 v102, v102, v110
    v_add_f32 v103, v103, v111
    s_waitcnt lgkmcnt(2)
    v_add_f32 v96, v96, v112
    v_add_f32 v97, v97, v113
    v_add_f32 v98, v98, v114
    v_add_f32 v99, v99, v115
    v_add_f32 v100, v100, v116
    v_add_f32 v101, v101, v117
    v_add_f32 v102, v102, v118
    v_add_f32 v103, v103, v119
    s_waitcnt lgkmcnt(0)
    v_add_f32 v96, v96, v120
    v_add_f32 v97, v97, v121
    v_add_f32 v98, v98, v122
    v_add_f32 v99, v99, v123
    v_add_f32 v100, v100, v124
    v_add_f32 v101, v101, v125
    v_add_f32 v102, v102, v126
    v_add_f32 v103, v103, v127
    v_cvt_pk_bf16_f32 v128, v96, v97
    v_cvt_pk_bf16_f32 v129, v98, v99
    v_cvt_pk_bf16_f32 v130, v100, v101
    v_cvt_pk_bf16_f32 v131, v102, v103
    buffer_store_dwordx4 v[128:131], v246, s[24:27], s60 offen nt
    s_add_u32 s60, s60, 20480
    s_mov_b32 s75, 0
L_aw_68:
    ds_read_b32 v240, v7 offset:76
    s_add_u32 s75, s75, 1
    s_cmp_gt_u32 s75, 4000000
    s_waitcnt lgkmcnt(0)
    s_cbranch_scc1 L_awd_69
    v_readfirstlane_b32 s74, v240
    s_cmp_lt_u32 s74, 4
    s_cbranch_scc1 L_aw_68
L_awd_69:
    s_mov_b32 exec_hi, 0xff
    ds_read_b128 v[136:139], v242 offset:7680
    ds_read_b128 v[140:143], v243 offset:7680
    ds_read_b128 v[144:147], v242 offset:33280
    ds_read_b128 v[148:151], v243 offset:33280
    ds_read_b128 v[152:155], v244 offset:7680
    ds_read_b128 v[156:159], v245 offset:7680
    ds_read_b128 v[160:163], v244 offset:33280
    ds_read_b128 v[164:167], v245 offset:33280
    s_waitcnt lgkmcnt(4)
    v_add_f32 v136, v136, v144
    v_add_f32 v137, v137, v145
    v_add_f32 v138, v138, v146
    v_add_f32 v139, v139, v147
    v_add_f32 v140, v140, v148
    v_add_f32 v141, v141, v149
    v_add_f32 v142, v142, v150
    v_add_f32 v143, v143, v151
    s_waitcnt lgkmcnt(2)
    v_add_f32 v136, v136, v152
    v_add_f32 v137, v137, v153
    v_add_f32 v138, v138, v154
    v_add_f32 v139, v139, v155
    v_add_f32 v140, v140, v156
    v_add_f32 v141, v141, v157
    v_add_f32 v142, v142, v158
    v_add_f32 v143, v143, v159
    s_waitcnt lgkmcnt(0)
    v_add_f32 v136, v136, v160
    v_add_f32 v137, v137, v161
    v_add_f32 v138, v138, v162
    v_add_f32 v139, v139, v163
    v_add_f32 v140, v140, v164
    v_add_f32 v141, v141, v165
    v_add_f32 v142, v142, v166
    v_add_f32 v143, v143, v167
    v_cvt_pk_bf16_f32 v168, v136, v137
    v_cvt_pk_bf16_f32 v169, v138, v139
    v_cvt_pk_bf16_f32 v170, v140, v141
    v_cvt_pk_bf16_f32 v171, v142, v143
    buffer_store_dwordx4 v[168:171], v246, s[24:27], s60 offen nt
    s_add_u32 s60, s60, 20480
L_fin:
L_end:
    s_endpgm
L_safe:
    s_mov_b32 s73, 1
    v_mov_b32 v29, 0xff800000
    v_mov_b32 v32, v152
    v_mov_b32 v33, v153
    v_mov_b32 v34, v154
    v_mov_b32 v35, v155
    v_mov_b32 v36, v158
    v_mov_b32 v37, v159
L_safe_task:
    s_add_u32 s72, s78, s73
    s_min_u32 s72, s72, 9
    v_mov_b32 v24, 0xff800000
    v_mov_b32 v72, 0
    v_mov_b32 v73, 0
    v_mov_b32 v74, 0
    v_mov_b32 v75, 0
    v_mov_b32 v76, 0
    v_mov_b32 v77, 0
    v_mov_b32 v78, 0
    v_mov_b32 v79, 0
    v_mov_b32 v80, 0
    v_mov_b32 v81, 0
    v_mov_b32 v82, 0
    v_mov_b32 v83, 0
    v_mov_b32 v84, 0
    v_mov_b32 v85, 0
    v_mov_b32 v86, 0
    v_mov_b32 v87, 0
    v_and_b32 v25, 31, v0
    v_lshrrev_b32 v30, 5, v0
    v_lshlrev_b32 v30, 2, v30
    v_sub_u32 v25, v25, v30
    s_add_u32 s70, s73, 8
    s_lshl_b32 s71, s70, 9
    s_mul_i32 s70, s70, 1280
    v_add_u32 v26, s71, v160
    v_add_u32 v27, s71, v161
    v_add_u32 v28, s70, v162
    s_mov_b32 s70, 0
    s_movk_i32 s71, 0x100
L_safe_p0:
    ds_read_b128 v[112:115], v26
    ds_read_b64 v[120:121], v27
    s_waitcnt lgkmcnt(0)
    v_mfma_f32_32x32x16_bf16 v[8:23], v[112:115], v[32:35], 0
    v_mfma_f32_32x32x8_bf16 v[8:23], v[120:121], v[36:37], v[8:23]
    v_subrev_u32 v26, 512, v26
    v_subrev_u32 v27, 512, v27
    v_subrev_u32 v28, 1280, v28
    s_nop 9
    v_subrev_u32 v30, 0, v25
    v_cmp_gt_u32 vcc, s71, v30
    s_nop 1
    v_cndmask_b32 v8, v29, v8, vcc
    v_max_f32 v24, v24, v8
    v_subrev_u32 v30, 1, v25
    v_cmp_gt_u32 vcc, s71, v30
    s_nop 1
    v_cndmask_b32 v9, v29, v9, vcc
    v_max_f32 v24, v24, v9
    v_subrev_u32 v30, 2, v25
    v_cmp_gt_u32 vcc, s71, v30
    s_nop 1
    v_cndmask_b32 v10, v29, v10, vcc
    v_max_f32 v24, v24, v10
    v_subrev_u32 v30, 3, v25
    v_cmp_gt_u32 vcc, s71, v30
    s_nop 1
    v_cndmask_b32 v11, v29, v11, vcc
    v_max_f32 v24, v24, v11
    v_subrev_u32 v30, 8, v25
    v_cmp_gt_u32 vcc, s71, v30
    s_nop 1
    v_cndmask_b32 v12, v29, v12, vcc
    v_max_f32 v24, v24, v12
    v_subrev_u32 v30, 9, v25
    v_cmp_gt_u32 vcc, s71, v30
    s_nop 1
    v_cndmask_b32 v13, v29, v13, vcc
    v_max_f32 v24, v24, v13
    v_subrev_u32 v30, 10, v25
    v_cmp_gt_u32 vcc, s71, v30
    s_nop 1
    v_cndmask_b32 v14, v29, v14, vcc
    v_max_f32 v24, v24, v14
    v_subrev_u32 v30, 11, v25
    v_cmp_gt_u32 vcc, s71, v30
    s_nop 1
    v_cndmask_b32 v15, v29, v15, vcc
    v_max_f32 v24, v24, v15
    v_subrev_u32 v30, 16, v25
    v_cmp_gt_u32 vcc, s71, v30
    s_nop 1
    v_cndmask_b32 v16, v29, v16, vcc
    v_max_f32 v24, v24, v16
    v_subrev_u32 v30, 17, v25
    v_cmp_gt_u32 vcc, s71, v30
    s_nop 1
    v_cndmask_b32 v17, v29, v17, vcc
    v_max_f32 v24, v24, v17
    v_subrev_u32 v30, 18, v25
    v_cmp_gt_u32 vcc, s71, v30
    s_nop 1
    v_cndmask_b32 v18, v29, v18, vcc
    v_max_f32 v24, v24, v18
    v_subrev_u32 v30, 19, v25
    v_cmp_gt_u32 vcc, s71, v30
    s_nop 1
    v_cndmask_b32 v19, v29, v19, vcc
    v_max_f32 v24, v24, v19
    v_subrev_u32 v30, 24, v25
    v_cmp_gt_u32 vcc, s71, v30
    s_nop 1
    v_cndmask_b32 v20, v29, v20, vcc
    v_max_f32 v24, v24, v20
    v_subrev_u32 v30, 25, v25
    v_cmp_gt_u32 vcc, s71, v30
    s_nop 1
    v_cndmask_b32 v21, v29, v21, vcc
    v_max_f32 v24, v24, v21
    v_subrev_u32 v30, 26, v25
    v_cmp_gt_u32 vcc, s71, v30
    s_nop 1
    v_cndmask_b32 v22, v29, v22, vcc
    v_max_f32 v24, v24, v22
    v_subrev_u32 v30, 27, v25
    v_cmp_gt_u32 vcc, s71, v30
    s_nop 1
    v_cndmask_b32 v23, v29, v23, vcc
    v_max_f32 v24, v24, v23
    v_add_u32 v25, 32, v25
    s_add_u32 s70, s70, 1
    s_cmp_lt_u32 s70, s72
    s_cbranch_scc1 L_safe_p0
    v_mov_b32 v30, v24
    s_nop 1
    v_permlane32_swap_b32 v24, v30
    v_max_f32 v24, v24, v30
    v_and_b32 v25, 31, v0
    v_lshrrev_b32 v30, 5, v0
    v_lshlrev_b32 v30, 2, v30
    v_sub_u32 v25, v25, v30
    s_add_u32 s70, s73, 8
    s_lshl_b32 s71, s70, 9
    s_mul_i32 s70, s70, 1280
    v_add_u32 v26, s71, v160
    v_add_u32 v27, s71, v161
    v_add_u32 v28, s70, v162
    s_mov_b32 s70, 0
    s_movk_i32 s71, 0x100
L_safe_p1:
    ds_read_b128 v[112:115], v26
    ds_read_b64 v[120:121], v27
    s_mov_b64 exec, s[76:77]
    ds_read_b128 v[224:227], v28
    ds_read_b128 v[228:231], v28 offset:640
    s_mov_b64 exec, -1
    s_waitcnt lgkmcnt(0)
    v_mfma_f32_32x32x16_bf16 v[8:23], v[112:115], v[32:35], 0
    v_mfma_f32_32x32x8_bf16 v[8:23], v[120:121], v[36:37], v[8:23]
    v_subrev_u32 v26, 512, v26
    v_subrev_u32 v27, 512, v27
    v_subrev_u32 v28, 1280, v28
    s_nop 9
    v_subrev_u32 v30, 0, v25
    v_cmp_gt_u32 vcc, s71, v30
    s_nop 1
    v_cndmask_b32 v8, v29, v8, vcc
    v_sub_f32 v8, v8, v24
    v_exp_f32 v8, v8
    v_subrev_u32 v30, 1, v25
    v_cmp_gt_u32 vcc, s71, v30
    s_nop 1
    v_cndmask_b32 v9, v29, v9, vcc
    v_sub_f32 v9, v9, v24
    v_exp_f32 v9, v9
    v_subrev_u32 v30, 2, v25
    v_cmp_gt_u32 vcc, s71, v30
    s_nop 1
    v_cndmask_b32 v10, v29, v10, vcc
    v_sub_f32 v10, v10, v24
    v_exp_f32 v10, v10
    v_subrev_u32 v30, 3, v25
    v_cmp_gt_u32 vcc, s71, v30
    s_nop 1
    v_cndmask_b32 v11, v29, v11, vcc
    v_sub_f32 v11, v11, v24
    v_exp_f32 v11, v11
    v_subrev_u32 v30, 8, v25
    v_cmp_gt_u32 vcc, s71, v30
    s_nop 1
    v_cndmask_b32 v12, v29, v12, vcc
    v_sub_f32 v12, v12, v24
    v_exp_f32 v12, v12
    v_subrev_u32 v30, 9, v25
    v_cmp_gt_u32 vcc, s71, v30
    s_nop 1
    v_cndmask_b32 v13, v29, v13, vcc
    v_sub_f32 v13, v13, v24
    v_exp_f32 v13, v13
    v_subrev_u32 v30, 10, v25
    v_cmp_gt_u32 vcc, s71, v30
    s_nop 1
    v_cndmask_b32 v14, v29, v14, vcc
    v_sub_f32 v14, v14, v24
    v_exp_f32 v14, v14
    v_subrev_u32 v30, 11, v25
    v_cmp_gt_u32 vcc, s71, v30
    s_nop 1
    v_cndmask_b32 v15, v29, v15, vcc
    v_sub_f32 v15, v15, v24
    v_exp_f32 v15, v15
    v_subrev_u32 v30, 16, v25
    v_cmp_gt_u32 vcc, s71, v30
    s_nop 1
    v_cndmask_b32 v16, v29, v16, vcc
    v_sub_f32 v16, v16, v24
    v_exp_f32 v16, v16
    v_subrev_u32 v30, 17, v25
    v_cmp_gt_u32 vcc, s71, v30
    s_nop 1
    v_cndmask_b32 v17, v29, v17, vcc
    v_sub_f32 v17, v17, v24
    v_exp_f32 v17, v17
    v_subrev_u32 v30, 18, v25
    v_cmp_gt_u32 vcc, s71, v30
    s_nop 1
    v_cndmask_b32 v18, v29, v18, vcc
    v_sub_f32 v18, v18, v24
    v_exp_f32 v18, v18
    v_subrev_u32 v30, 19, v25
    v_cmp_gt_u32 vcc, s71, v30
    s_nop 1
    v_cndmask_b32 v19, v29, v19, vcc
    v_sub_f32 v19, v19, v24
    v_exp_f32 v19, v19
    v_subrev_u32 v30, 24, v25
    v_cmp_gt_u32 vcc, s71, v30
    s_nop 1
    v_cndmask_b32 v20, v29, v20, vcc
    v_sub_f32 v20, v20, v24
    v_exp_f32 v20, v20
    v_subrev_u32 v30, 25, v25
    v_cmp_gt_u32 vcc, s71, v30
    s_nop 1
    v_cndmask_b32 v21, v29, v21, vcc
    v_sub_f32 v21, v21, v24
    v_exp_f32 v21, v21
    v_subrev_u32 v30, 26, v25
    v_cmp_gt_u32 vcc, s71, v30
    s_nop 1
    v_cndmask_b32 v22, v29, v22, vcc
    v_sub_f32 v22, v22, v24
    v_exp_f32 v22, v22
    v_subrev_u32 v30, 27, v25
    v_cmp_gt_u32 vcc, s71, v30
    s_nop 1
    v_cndmask_b32 v23, v29, v23, vcc
    v_sub_f32 v23, v23, v24
    v_exp_f32 v23, v23
    s_nop 0
    v_cvt_pk_bf16_f32 v104, v8, v9
    v_cvt_pk_bf16_f32 v105, v10, v11
    v_cvt_pk_bf16_f32 v106, v12, v13
    v_cvt_pk_bf16_f32 v107, v14, v15
    v_cvt_pk_bf16_f32 v108, v16, v17
    v_cvt_pk_bf16_f32 v109, v18, v19
    v_cvt_pk_bf16_f32 v110, v20, v21
    v_cvt_pk_bf16_f32 v111, v22, v23
    s_nop 1
    v_mfma_f32_32x32x16_bf16 v[72:87], v[224:227], v[104:107], v[72:87]
    v_mfma_f32_32x32x16_bf16 v[72:87], v[228:231], v[108:111], v[72:87]
    v_add_u32 v25, 32, v25
    s_add_u32 s70, s70, 1
    s_cmp_lt_u32 s70, s72
    s_cbranch_scc1 L_safe_p1
    s_nop 11
    s_cmp_eq_u32 s73, 0
    s_cbranch_scc1 L_attn_norm
    s_mov_b32 s73, 0
    v_mov_b32 v88, v72
    v_mov_b32 v89, v73
    v_mov_b32 v90, v74
    v_mov_b32 v91, v75
    v_mov_b32 v92, v76
    v_mov_b32 v93, v77
    v_mov_b32 v94, v78
    v_mov_b32 v95, v79
    v_mov_b32 v96, v80
    v_mov_b32 v97, v81
    v_mov_b32 v98, v82
    v_mov_b32 v99, v83
    v_mov_b32 v100, v84
    v_mov_b32 v101, v85
    v_mov_b32 v102, v86
    v_mov_b32 v103, v87
    v_mov_b32 v32, v148
    v_mov_b32 v33, v149
    v_mov_b32 v34, v150
    v_mov_b32 v35, v151
    v_mov_b32 v36, v156
    v_mov_b32 v37, v157
    s_branch L_safe_task
L_vspin_40_s:
    s_mov_b32 s75, 0
L_vspin_40:
    buffer_load_dword v177, v176, s[16:19], 0 offen sc1
    s_add_u32 s75, s75, 1
    s_cmp_gt_u32 s75, 200000
    s_waitcnt vmcnt(0)
    s_cbranch_scc1 L_vspun_41
    v_cmp_gt_u32 vcc, 64, v177
    s_cbranch_vccnz L_vspin_40
    s_branch L_vspun_41
L_aw_57_s:
    s_mov_b32 s75, 0
L_aw_57:
    ds_read_b32 v126, v7 offset:36
    s_add_u32 s75, s75, 1
    s_cmp_gt_u32 s75, 4000000
    s_waitcnt lgkmcnt(0)
    s_cbranch_scc1 L_awd_58
    v_readfirstlane_b32 s74, v126
    s_cmp_lt_u32 s74, 4
    s_cbranch_scc1 L_aw_57
    s_branch L_awd_58
L_codeend:
.section .rodata,"a"
.p2align 6
.amdhsa_kernel gated_mix__sliding_block__dense_activation_silu__prompt_kernel
  .amdhsa_next_free_vgpr 256
  .amdhsa_next_free_sgpr 102
  .amdhsa_accum_offset 256
  .amdhsa_group_segment_fixed_size 0
  .amdhsa_kernarg_size 80
  .amdhsa_user_sgpr_count 2
  .amdhsa_user_sgpr_kernarg_segment_ptr 1
  .amdhsa_system_sgpr_workgroup_id_x 1
.end_amdhsa_kernel
```
